```python
import torch

def _softmax(x, axis=-1):
    return torch.softmax(x, dim=axis)
def _gelu(x):
    return torch.nn.functional.gelu(x, approximate="tanh")
def _silu(x):
    return torch.nn.functional.silu(x)
def _sigmoid(x):
    return torch.sigmoid(x)
def _layernorm(x, axis=-1, eps=1e-5):
    m = x.mean(dim=axis, keepdim=True)
    v = x.var(dim=axis, keepdim=True, unbiased=False)
    return (x - m) / torch.sqrt(v + eps)
def _scatter_add(tgt, idx, src, axis=0):
    return tgt.clone().index_add_(axis, idx, src)
def _segment_sum(src, seg, n):
    out = torch.zeros((n,) + src.shape[1:], dtype=src.dtype)
    return out.index_add_(0, seg, src)
def _pad(x, pw):
    flat = tuple(v for pair in reversed(pw) for v in pair)
    return torch.nn.functional.pad(x, flat)

kernel_name = 'interleave_layers__ssm_conv_h3__glu_gated_bilinear__prompt'

def setup_inputs():

    _w = (lambda a: (lambda t: t.to(torch.bfloat16) if t.is_floating_point() else t)(torch.as_tensor(a)))
    def _A_setup():
        B, S, D = 1, 2048, 1024
        ks = 4
        return {
            "q": _w((lambda *s: torch.randn(*s, dtype=torch.bfloat16) * 0.05)(B, S, D)),
            "k": _w((lambda *s: torch.randn(*s, dtype=torch.bfloat16) * 0.2)(B, S, D)),
            "v": _w((lambda *s: torch.randn(*s, dtype=torch.bfloat16) * 0.2)(B, S, D)),
            "shift_k": _w((lambda *s: torch.randn(*s, dtype=torch.bfloat16) * 0.2)(D, ks) * 0.5),
            "ssm_k": _w((lambda *s: torch.randn(*s, dtype=torch.bfloat16) * 0.4)(D, S) * (1.0 / S ** 0.5)),
            "ssm_D": _w((lambda *s: torch.randn(*s, dtype=torch.bfloat16) * 0.2)(D)),
        }
    _A_in = _A_setup()

    def _B_setup():
        B, S, D, F = 1, 2048, 1024, 3584
        return {
            "x": _w((lambda *s: torch.randn(*s, dtype=torch.bfloat16) * 0.05)(B, S, D)),
            "w_gate": _w((lambda *s: torch.randn(*s, dtype=torch.bfloat16) * 0.4)(D, F) * (D ** -0.5)),
            "w_up": _w((lambda *s: torch.randn(*s, dtype=torch.bfloat16) * 0.4)(D, F) * (D ** -0.5)),
            "w_down": _w((lambda *s: torch.randn(*s, dtype=torch.bfloat16) * 0.4)(F, D) * (F ** -0.5)),
        }
    _B_in = _B_setup()

    return {
        "A_q": _A_in["q"],
        "A_k": _A_in["k"],
        "A_v": _A_in["v"],
        "A_shift_k": _A_in["shift_k"],
        "A_ssm_k": _A_in["ssm_k"],
        "A_ssm_D": _A_in["ssm_D"],
        "B_x": _B_in["x"],
        "B_w_gate": _B_in["w_gate"],
        "B_w_up": _B_in["w_up"],
        "B_w_down": _B_in["w_down"],
    }

def reference(A_q, A_k, A_v, A_shift_k, A_ssm_k, A_ssm_D, B_x, B_w_gate, B_w_up, B_w_down):
    def _A_ref(q, k, v, shift_k, ssm_k, ssm_D):
        B, S, D = q.shape
        ks = shift_k.shape[-1]
        k_pad = _pad(k, ((0, 0), (ks - 1, 0), (0, 0)))
        k_shift = torch.zeros_like(k)
        for t in range(ks):
            k_shift = k_shift + k_pad[:, t:t + S, :] * shift_k[:, ks - 1 - t][None, None, :]
        kv = k_shift * v
        L = 2 * S
        kv_pad = _pad(kv, ((0, 0), (0, S), (0, 0)))
        kf_pad = _pad(ssm_k, ((0, 0), (0, S)))
        kv_f = (lambda x, axes=(-2,-1): torch.fft.rfft2(x.float(), dim=axes))(kv_pad[:, None, :, :], axes=(1, 2))
        kf_f = (lambda x, axes=(-2,-1): torch.fft.rfft2(x.float(), dim=axes))(kf_pad[:, None, :], axes=(1, 2))
        kf_f = (lambda x, *d: x.permute(*d))(kf_f, 1, 2, 0)
        y_f = kv_f * kf_f[None, :, :, :]
        y = (lambda x, s, axes=(-2,-1): torch.fft.irfft2(x, s=s, dim=axes).to(torch.bfloat16))(y_f, (1, L), axes=(1, 2))[:, 0, :S, :]
        y = y + kv * ssm_D[None, None, :]
        return q * y

    def _B_ref(x, w_gate, w_up, w_down):
        g = torch.einsum("bsd,df->bsf", x, w_gate)
        u = torch.einsum("bsd,df->bsf", x, w_up)
        h = g * u
        return torch.einsum("bsf,fd->bsd", h, w_down)

    x = A_q
    x = x + _A_ref(_layernorm(x, axis=-1), A_k, A_v, A_shift_k, A_ssm_k, A_ssm_D)
    x = x + _B_ref(_layernorm(x, axis=-1), B_w_gate, B_w_up, B_w_down)
    x = x + _A_ref(_layernorm(x, axis=-1), A_k, A_v, A_shift_k, A_ssm_k, A_ssm_D)
    x = x + _B_ref(_layernorm(x, axis=-1), B_w_gate, B_w_up, B_w_down)
    return x
```

```asm
; @launch grid=(256,1,1) block=(256,1,1) lds=161792
.amdgcn_target "amdgcn-amd-amdhsa--gfx950"
.text
.globl interleave_layers__ssm_conv_h3__glu_gated_bilinear__prompt_kernel
.p2align 8
.type interleave_layers__ssm_conv_h3__glu_gated_bilinear__prompt_kernel,@function
interleave_layers__ssm_conv_h3__glu_gated_bilinear__prompt_kernel:
    s_cmp_ge_u32 s2, 256
    s_cbranch_scc1 interleave_layers__ssm_conv_h3__glu_gated_bilinear__prompt_kernel_end
    s_load_dwordx16 s[64:79], s[0:1], 0
    s_load_dwordx8 s[80:87], s[0:1], 64
    s_load_dwordx2 s[12:13], s[0:1], 96
    v_lshrrev_b32 v1, 6, v0
    v_and_b32 v2, 63, v0
    v_readfirstlane_b32 s3, v1
    v_lshlrev_b32 v3, 4, v2
    s_lshr_b32 s37, s2, 3
    s_lshl_b32 s37, s37, 2
    s_add_u32 s37, s37, s3
    s_mul_i32 s37, s37, 3
    v_min_u32 v4, 2, v2
    v_add_u32 v4, s37, v4
    v_lshlrev_b32 v4, 7, v4
    s_getpc_b64 s[50:51]
interl_pc1:
    s_sub_u32 s50, s50, interl_pc1-interleave_layers__ssm_conv_h3__glu_gated_bilinear__prompt_kernel
    s_subb_u32 s51, s51, 0
    v_min_u32 v4, interleave_layers__ssm_conv_h3__glu_gated_bilinear__prompt_kernel_last-interleave_layers__ssm_conv_h3__glu_gated_bilinear__prompt_kernel, v4
    v_mov_b32 v5, s51
    v_add_co_u32 v4, vcc, s50, v4
    s_nop 1
    v_addc_co_u32 v5, vcc, 0, v5, vcc
    global_load_dword v251, v[4:5], off
    s_mov_b32 s14, 84934656
    s_mov_b32 s15, 0x20000
    s_mov_b32 s61, 0xffff0000
    v_and_b32 v4, 7, v0
    v_lshrrev_b32 v5, 3, v0
    s_and_b32 s33, s2, 7
    s_lshr_b32 s34, s2, 3
    s_lshr_b32 s35, s34, 4
    s_and_b32 s34, s34, 15
    s_lshl_b32 s33, s33, 1
    s_add_u32 s33, s33, s35
    s_add_u32 s33, s33, s34
    s_and_b32 s33, s33, 15
    s_lshl_b32 s35, s33, 18
    s_lshl_b32 s36, s34, 7
    s_add_u32 s35, s35, s36
    v_lshlrev_b32 v6, 13, v5
    v_lshl_add_u32 v6, v4, 4, v6
    v_add_u32 v11, s35, v6
    v_add_u32 v12, 4096, v11
    v_lshrrev_b32 v7, 3, v2
    v_lshlrev_b32 v6, 11, v7
    v_lshl_add_u32 v6, v4, 4, v6
    s_lshl_b32 s36, s3, 16
    s_add_u32 s35, s35, s36
    v_add_u32 v9, s35, v6
    v_cmp_lt_u32 vcc, 4, v7
    v_subrev_u32 v8, 16384, v9
    v_bfrev_b32 v6, 1
    s_mul_i32 s52, s3, 33024
    v_cndmask_b32 v8, v6, v8, vcc
    s_add_u32 s52, s52, 16384
    s_mov_b32 m0, s52
    s_mov_b32 s53, 15360
    s_mov_b32 s54, 30720
    s_mov_b32 s55, 46080
    s_lshl_b32 s36, s34, 9
    v_add_u32 v10, s36, v3
    v_mov_b64 v[16:17], 0
    v_mov_b64 v[18:19], 0
    s_mov_b32 s90, 8192
    s_mov_b32 s91, 0x20000
    s_mov_b32 s26, 4194304
    s_mov_b32 s27, 0x20000
    s_mov_b32 s30, 4194304
    s_mov_b32 s31, 0x20000
    s_lshl_b32 s46, s34, 10
    s_add_u32 s46, s46, 16777216
    s_add_u32 s47, s46, 16384
    s_or_b32 s48, s33, s3
    s_waitcnt lgkmcnt(0)
    s_mov_b64 s[88:89], s[70:71]
    s_mov_b64 s[24:25], s[66:67]
    s_mov_b64 s[28:29], s[68:69]
    s_cbranch_scc1 interl_nz2
    buffer_store_dwordx4 v[16:19], v3, s[12:15], s46 offen sc1
    buffer_store_dwordx4 v[16:19], v3, s[12:15], s47 offen sc1
interl_nz2:
    buffer_load_dwordx4 v10, s[88:91], 0 offen lds
    s_add_u32 m0, s52, 1024
    s_lshl_b32 s49, s34, 2
    buffer_load_dwordx4 v8, s[24:27], 0 offen nt lds
    s_add_u32 m0, s52, 2048
    s_add_u32 s49, s49, 64
    buffer_load_dwordx4 v9, s[24:27], 0 offen offset:0 nt lds
    buffer_load_dwordx4 v9, s[24:27], s53 offen offset:1024 nt lds
    buffer_load_dwordx4 v9, s[24:27], s54 offen offset:2048 nt lds
    buffer_load_dwordx4 v9, s[24:27], s55 offen offset:3072 nt lds
    s_barrier
    buffer_load_dwordx4 v[60:63], v11, s[28:31], 0 offen offset:0 nt
    buffer_load_dwordx4 v[64:67], v11, s[28:31], 0 offen offset:2048 nt
    buffer_load_dwordx4 v[68:71], v12, s[28:31], 0 offen offset:0 nt
    buffer_load_dwordx4 v[72:75], v12, s[28:31], 0 offen offset:2048 nt
    s_mov_b64 s[88:89], s[86:87]
    s_mov_b32 s90, 256
    s_cmp_lg_u32 s48, 0
    s_cbranch_scc1 interl_nz3
    v_mov_b32 v20, 1
    s_waitcnt vmcnt(10)
    s_mov_b64 exec, 1
    buffer_store_dword v20, v16, s[88:91], s49 offen sc1
    s_mov_b64 exec, -1
interl_nz3:
    s_lshl_b32 s41, s34, 4
    s_add_u32 s41, s41, s33
    s_lshl_b32 s42, s41, 2
    s_add_u32 s42, s42, s3
    s_lshr_b32 s44, s42, 1
    s_lshl_b32 s44, s44, 2
    s_load_dword s45, s[74:75], s44
    s_mul_i32 s47, s3, 33024
    s_mov_b64 s[24:25], s[72:73]
    s_mov_b64 s[28:29], s[64:65]
    s_andn2_b32 s40, 1, s2
    s_lshl_b32 s40, s40, 2
    s_bfe_u32 s4, s2, 0x20003
    s_add_u32 s4, s4, s40
    s_bfe_u32 s40, s2, 0x20001
    s_lshl_b32 s40, s40, 3
    s_lshr_b32 s5, s2, 5
    s_add_u32 s5, s5, s40
    s_lshl_b32 s60, s4, 5
    s_bfe_u32 s40, s5, 0x10003
    s_lshl_b32 s40, s40, 4
    s_add_u32 s60, s60, s40
    s_lshr_b32 s40, s5, 4
    s_lshl_b32 s40, s40, 3
    s_add_u32 s60, s60, s40
    s_and_b32 s40, s5, 7
    s_add_u32 s60, s60, s40
    s_and_b32 s40, s5, 0
    s_lshl_b32 s40, s40, 1
    s_add_u32 s60, s60, s40
    s_mov_b32 s6, 0
    s_mov_b32 s7, 18874368
    s_mov_b32 s63, 0
    s_mov_b32 s95, 16777216
    s_lshl_b32 s94, s2, 7
    s_add_u32 s94, s94, s95
    s_cmp_lt_u32 s3, 2
    s_cselect_b32 s8, s78, s80
    s_cselect_b32 s9, s79, s81
    s_mov_b32 s10, 7340032
    s_mov_b32 s11, 0x20000
    s_mov_b32 s16, s82
    s_mov_b32 s17, s83
    s_mov_b32 s18, 7340032
    s_mov_b32 s19, 0x20000
    s_mov_b32 s20, s84
    s_mov_b32 s21, s85
    s_mov_b32 s22, 4194304
    s_mov_b32 s23, 0x20000
    s_lshl_b32 s84, s42, 12
    v_lshrrev_b32 v7, 3, v2
    v_lshlrev_b32 v7, 9, v7
    v_lshl_add_u32 v7, v4, 4, v7
    v_add_u32 v10, s52, v7
    v_lshl_add_u32 v21, v4, 6, s52
    v_mul_u32_u24 v6, 2064, v4
    v_sub_u32 v7, 31, v5
    v_lshl_add_u32 v6, v7, 3, v6
    v_add_u32 v13, 133120, v6
    v_lshrrev_b32 v7, 7, v0
    v_add_u32 v7, v7, v0
    v_lshlrev_b32 v7, 4, v7
    v_add_u32 v14, 133120, v7
    v_lshrrev_b32 v6, 4, v0
    v_and_b32 v7, 15, v0
    v_lshl_add_u32 v249, v7, 2, 64
    v_lshlrev_b32 v7, 4, v7
    v_lshl_add_u32 v15, v6, 12, v7
    s_lshl_b32 s36, s34, 18
    s_sub_u32 s37, 15, s33
    s_lshl_b32 s37, s37, 8
    s_add_u32 s36, s36, s37
    s_add_u32 s36, s36, 0
    v_lshrrev_b32 v5, 3, v2
    v_lshl_add_u32 v6, v5, 7, v4
    v_lshlrev_b32 v6, 7, v6
    s_lshl_b32 s37, s34, 10
    v_add_u32 v28, s37, v6
    v_lshrrev_b32 v6, 1, v2
    v_and_b32 v7, 16, v3
    v_lshl_add_u32 v6, v6, 10, v7
    v_add_u32 v250, 64, v6
    s_lshr_b32 s85, s2, 3
    s_lshl_b32 s85, s85, 10
    s_and_b32 s37, s2, 7
    s_lshl_b32 s37, s37, 2
    s_add_u32 s85, s85, s37
    s_add_u32 s85, s85, 16777280
    v_and_b32 v6, 3, v5
    v_lshlrev_b32 v7, 5, v4
    v_lshl_or_b32 v6, v6, 1, v7
    s_and_b32 s37, s2, 0x19
    v_or_b32 v6, s37, v6
    v_lshlrev_b32 v0, 7, v6
    v_lshlrev_b32 v6, 4, v5
    v_lshl_add_u32 v29, v4, 11, v6
    s_lshl_b32 s56, s60, 14
    s_lshl_b32 s38, s3, 9
    s_add_u32 s56, s56, s38
    v_lshlrev_b32 v6, 4, v4
    v_lshl_add_u32 v214, v5, 15, v6
    s_lshl_b32 s57, s3, 19
    s_lshl_b32 s38, s41, 7
    s_add_u32 s57, s57, s38
    s_add_u32 s57, s57, 4194304
    v_bfe_u32 v6, v2, 1, 2
    v_mul_u32_u24 v6, 160, v6
    v_lshl_add_u32 v6, v5, 3, v6
    v_and_b32 v7, 1, v2
    v_lshl_add_u32 v6, v7, 2, v6
    s_mul_i32 s37, s3, 640
    v_add_u32 v213, s37, v6
    v_add_u32 v229, 66048, v213
    v_min_u32 v6, 33, v2
    v_lshlrev_b32 v6, 4, v6
    v_cmp_lt_u32 vcc, 1, v2
    v_mov_b32 v7, 4128
    v_mov_b32 v5, 12352
    v_cndmask_b32 v7, 0, v7, vcc
    v_cmp_lt_u32 vcc, 3, v2
    v_add_u32 v27, s47, v3
    v_and_b32 v4, 15, v2
    v_cndmask_b32 v7, v7, v5, vcc
    v_add3_u32 v6, v6, v7, s47
    ds_write_b128 v6, v[16:19]
    v_lshrrev_b32 v5, 4, v2
    v_add_u32 v6, 1, v4
    v_lshrrev_b32 v6, 1, v6
    v_lshl_add_u32 v6, v5, 2, v6
    v_lshlrev_b32 v6, 2, v6
    v_and_b32 v7, 1, v4
    v_xor_b32 v7, 1, v7
    v_mul_u32_u24 v7, 4164, v7
    v_add3_u32 v225, v6, v7, s47
    v_add_u32 v226, 1024, v225
    v_add_u32 v227, 2048, v225
    v_add_u32 v228, 3072, v225
    v_lshlrev_b32 v6, 5, v4
    v_lshlrev_b32 v7, 4, v5
    v_sub_u32 v6, v7, v6
    s_add_u32 s37, s47, 8800
    v_add_u32 v26, s37, v6
    v_mul_u32_u24 v6, 160, v5
    v_lshl_add_u32 v6, v4, 3, v6
    v_add_u32 v212, s47, v6
    s_lshl_b32 s58, s2, 1
    s_and_b32 s38, s3, 1
    s_add_u32 s58, s58, s38
    s_mul_i32 s58, s58, 896
    v_min_u32 v6, 6, v2
    v_lshlrev_b32 v224, 7, v6
    v_lshl_add_u32 v6, v5, 3, v4
    v_sub_u32 v6, 15, v6
    v_and_b32 v7, 1, v6
    v_lshlrev_b32 v7, 4, v7
    v_ashrrev_i32 v6, 1, v6
    s_and_b32 s37, s42, 1
    s_lshl_b32 s37, s37, 4
    s_waitcnt lgkmcnt(0)
    s_lshr_b32 s45, s45, s37
    s_and_b32 s45, s45, 0xffff
    v_lshlrev_b32 v7, v7, s45
    v_cmp_eq_u32 vcc, 0, v6
    s_nop 1
    v_cndmask_b32 v252, 0, v7, vcc
    v_cmp_eq_u32 vcc, 1, v6
    s_nop 1
    v_cndmask_b32 v253, 0, v7, vcc
    v_cmp_eq_u32 vcc, 2, v6
    s_nop 1
    v_cndmask_b32 v254, 0, v7, vcc
    v_cmp_eq_u32 vcc, 3, v6
    s_nop 1
    v_cndmask_b32 v255, 0, v7, vcc
    s_cmp_lg_u32 s3, 0
    s_cbranch_scc1 iw_fret
    s_mov_b64 exec, 0
    s_branch iw_f0
iw_fret:
    s_mov_b64 exec, -1
    s_waitcnt vmcnt(9)
    ds_read_b128 v[76:79], v21 offset:0
    ds_read_b128 v[80:83], v21 offset:16
    ds_read_b128 v[84:87], v21 offset:32
    ds_read_b128 v[88:91], v21 offset:48
    s_waitcnt lgkmcnt(3)
    v_lshlrev_b32 v148, 16, v76
    v_and_b32 v156, s61, v76
    v_lshlrev_b32 v164, 16, v77
    v_and_b32 v172, s61, v77
    v_lshlrev_b32 v149, 16, v78
    v_and_b32 v157, s61, v78
    v_lshlrev_b32 v165, 16, v79
    v_and_b32 v173, s61, v79
    s_waitcnt lgkmcnt(2)
    v_lshlrev_b32 v150, 16, v80
    v_and_b32 v158, s61, v80
    v_lshlrev_b32 v166, 16, v81
    v_and_b32 v174, s61, v81
    v_lshlrev_b32 v151, 16, v82
    v_and_b32 v159, s61, v82
    v_lshlrev_b32 v167, 16, v83
    v_and_b32 v175, s61, v83
    s_waitcnt lgkmcnt(1)
    v_lshlrev_b32 v152, 16, v84
    v_and_b32 v160, s61, v84
    v_lshlrev_b32 v168, 16, v85
    v_and_b32 v176, s61, v85
    v_lshlrev_b32 v153, 16, v86
    v_and_b32 v161, s61, v86
    v_lshlrev_b32 v169, 16, v87
    v_and_b32 v177, s61, v87
    s_waitcnt lgkmcnt(0)
    v_lshlrev_b32 v154, 16, v88
    v_and_b32 v162, s61, v88
    v_lshlrev_b32 v170, 16, v89
    v_and_b32 v178, s61, v89
    v_lshlrev_b32 v155, 16, v90
    v_and_b32 v163, s61, v90
    v_lshlrev_b32 v171, 16, v91
    v_and_b32 v179, s61, v91
    s_waitcnt vmcnt(4)
    ds_read_b128 v[32:35], v10 offset:1664
    ds_read_b128 v[36:39], v10 offset:1792
    ds_read_b128 v[40:43], v10 offset:1920
    ds_read_b128 v[44:47], v10 offset:2048
    ds_read_b128 v[48:51], v10 offset:2176
    ds_read_b128 v[52:55], v10 offset:2304
    ds_read_b128 v[56:59], v10 offset:2432
    s_waitcnt lgkmcnt(6)
    v_lshlrev_b32 v92, 16, v32
    v_and_b32 v93, s61, v32
    v_lshlrev_b32 v94, 16, v33
    v_and_b32 v95, s61, v33
    v_lshlrev_b32 v96, 16, v34
    v_and_b32 v97, s61, v34
    v_lshlrev_b32 v98, 16, v35
    v_and_b32 v99, s61, v35
    s_waitcnt lgkmcnt(5)
    v_lshlrev_b32 v100, 16, v36
    v_and_b32 v101, s61, v36
    v_lshlrev_b32 v102, 16, v37
    v_and_b32 v103, s61, v37
    v_lshlrev_b32 v104, 16, v38
    v_and_b32 v105, s61, v38
    v_lshlrev_b32 v106, 16, v39
    v_and_b32 v107, s61, v39
    s_waitcnt lgkmcnt(4)
    v_lshlrev_b32 v108, 16, v40
    v_and_b32 v109, s61, v40
    v_lshlrev_b32 v110, 16, v41
    v_and_b32 v111, s61, v41
    v_lshlrev_b32 v112, 16, v42
    v_and_b32 v113, s61, v42
    v_lshlrev_b32 v114, 16, v43
    v_and_b32 v115, s61, v43
    s_waitcnt lgkmcnt(3)
    v_lshlrev_b32 v116, 16, v44
    v_and_b32 v117, s61, v44
    v_lshlrev_b32 v118, 16, v45
    v_and_b32 v119, s61, v45
    v_lshlrev_b32 v120, 16, v46
    v_and_b32 v121, s61, v46
    v_lshlrev_b32 v122, 16, v47
    v_and_b32 v123, s61, v47
    s_waitcnt lgkmcnt(2)
    v_lshlrev_b32 v124, 16, v48
    v_and_b32 v125, s61, v48
    v_lshlrev_b32 v126, 16, v49
    v_and_b32 v127, s61, v49
    v_lshlrev_b32 v128, 16, v50
    v_and_b32 v129, s61, v50
    v_lshlrev_b32 v130, 16, v51
    v_and_b32 v131, s61, v51
    s_waitcnt lgkmcnt(1)
    v_lshlrev_b32 v132, 16, v52
    v_and_b32 v133, s61, v52
    v_lshlrev_b32 v134, 16, v53
    v_and_b32 v135, s61, v53
    v_lshlrev_b32 v136, 16, v54
    v_and_b32 v137, s61, v54
    v_lshlrev_b32 v138, 16, v55
    v_and_b32 v139, s61, v55
    s_waitcnt lgkmcnt(0)
    v_lshlrev_b32 v140, 16, v56
    v_and_b32 v141, s61, v56
    v_lshlrev_b32 v142, 16, v57
    v_and_b32 v143, s61, v57
    v_lshlrev_b32 v144, 16, v58
    v_and_b32 v145, s61, v58
    v_lshlrev_b32 v146, 16, v59
    v_and_b32 v147, s61, v59
    v_pk_mul_f32 v[180:181], v[116:117], v[148:149]
    v_pk_mul_f32 v[182:183], v[118:119], v[150:151]
    v_pk_mul_f32 v[184:185], v[120:121], v[152:153]
    v_pk_mul_f32 v[186:187], v[122:123], v[154:155]
    v_pk_fma_f32 v[180:181], v[108:109], v[156:157], v[180:181]
    v_pk_fma_f32 v[182:183], v[110:111], v[158:159], v[182:183]
    v_pk_fma_f32 v[184:185], v[112:113], v[160:161], v[184:185]
    v_pk_fma_f32 v[186:187], v[114:115], v[162:163], v[186:187]
    v_pk_fma_f32 v[180:181], v[100:101], v[164:165], v[180:181]
    v_pk_fma_f32 v[182:183], v[102:103], v[166:167], v[182:183]
    v_pk_fma_f32 v[184:185], v[104:105], v[168:169], v[184:185]
    v_pk_fma_f32 v[186:187], v[106:107], v[170:171], v[186:187]
    v_pk_fma_f32 v[180:181], v[92:93], v[172:173], v[180:181]
    v_pk_fma_f32 v[182:183], v[94:95], v[174:175], v[182:183]
    v_pk_fma_f32 v[184:185], v[96:97], v[176:177], v[184:185]
    v_pk_fma_f32 v[186:187], v[98:99], v[178:179], v[186:187]
    v_pk_mul_f32 v[188:189], v[124:125], v[148:149]
    v_pk_mul_f32 v[190:191], v[126:127], v[150:151]
    v_pk_mul_f32 v[192:193], v[128:129], v[152:153]
    v_pk_mul_f32 v[194:195], v[130:131], v[154:155]
    v_pk_fma_f32 v[188:189], v[116:117], v[156:157], v[188:189]
    v_pk_fma_f32 v[190:191], v[118:119], v[158:159], v[190:191]
    v_pk_fma_f32 v[192:193], v[120:121], v[160:161], v[192:193]
    v_pk_fma_f32 v[194:195], v[122:123], v[162:163], v[194:195]
    v_pk_fma_f32 v[188:189], v[108:109], v[164:165], v[188:189]
    v_pk_fma_f32 v[190:191], v[110:111], v[166:167], v[190:191]
    v_pk_fma_f32 v[192:193], v[112:113], v[168:169], v[192:193]
    v_pk_fma_f32 v[194:195], v[114:115], v[170:171], v[194:195]
    v_pk_fma_f32 v[188:189], v[100:101], v[172:173], v[188:189]
    v_pk_fma_f32 v[190:191], v[102:103], v[174:175], v[190:191]
    v_pk_fma_f32 v[192:193], v[104:105], v[176:177], v[192:193]
    v_pk_fma_f32 v[194:195], v[106:107], v[178:179], v[194:195]
    v_pk_mul_f32 v[196:197], v[132:133], v[148:149]
    v_pk_mul_f32 v[198:199], v[134:135], v[150:151]
    v_pk_mul_f32 v[200:201], v[136:137], v[152:153]
    v_pk_mul_f32 v[202:203], v[138:139], v[154:155]
    v_pk_fma_f32 v[196:197], v[124:125], v[156:157], v[196:197]
    v_pk_fma_f32 v[198:199], v[126:127], v[158:159], v[198:199]
    v_pk_fma_f32 v[200:201], v[128:129], v[160:161], v[200:201]
    v_pk_fma_f32 v[202:203], v[130:131], v[162:163], v[202:203]
    v_pk_fma_f32 v[196:197], v[116:117], v[164:165], v[196:197]
    v_pk_fma_f32 v[198:199], v[118:119], v[166:167], v[198:199]
    v_pk_fma_f32 v[200:201], v[120:121], v[168:169], v[200:201]
    v_pk_fma_f32 v[202:203], v[122:123], v[170:171], v[202:203]
    v_pk_fma_f32 v[196:197], v[108:109], v[172:173], v[196:197]
    v_pk_fma_f32 v[198:199], v[110:111], v[174:175], v[198:199]
    v_pk_fma_f32 v[200:201], v[112:113], v[176:177], v[200:201]
    v_pk_fma_f32 v[202:203], v[114:115], v[178:179], v[202:203]
    v_pk_mul_f32 v[204:205], v[140:141], v[148:149]
    v_pk_mul_f32 v[206:207], v[142:143], v[150:151]
    v_pk_mul_f32 v[208:209], v[144:145], v[152:153]
    v_pk_mul_f32 v[210:211], v[146:147], v[154:155]
    v_pk_fma_f32 v[204:205], v[132:133], v[156:157], v[204:205]
    v_pk_fma_f32 v[206:207], v[134:135], v[158:159], v[206:207]
    v_pk_fma_f32 v[208:209], v[136:137], v[160:161], v[208:209]
    v_pk_fma_f32 v[210:211], v[138:139], v[162:163], v[210:211]
    v_pk_fma_f32 v[204:205], v[124:125], v[164:165], v[204:205]
    v_pk_fma_f32 v[206:207], v[126:127], v[166:167], v[206:207]
    v_pk_fma_f32 v[208:209], v[128:129], v[168:169], v[208:209]
    v_pk_fma_f32 v[210:211], v[130:131], v[170:171], v[210:211]
    v_pk_fma_f32 v[204:205], v[116:117], v[172:173], v[204:205]
    v_pk_fma_f32 v[206:207], v[118:119], v[174:175], v[206:207]
    v_pk_fma_f32 v[208:209], v[120:121], v[176:177], v[208:209]
    v_pk_fma_f32 v[210:211], v[122:123], v[178:179], v[210:211]
    s_waitcnt vmcnt(3)
    v_lshlrev_b32 v92, 16, v60
    v_and_b32 v93, s61, v60
    v_lshlrev_b32 v94, 16, v61
    v_and_b32 v95, s61, v61
    v_lshlrev_b32 v96, 16, v62
    v_and_b32 v97, s61, v62
    v_lshlrev_b32 v98, 16, v63
    v_and_b32 v99, s61, v63
    v_pk_mul_f32 v[180:181], v[180:181], v[92:93]
    v_pk_mul_f32 v[182:183], v[182:183], v[94:95]
    v_pk_mul_f32 v[184:185], v[184:185], v[96:97]
    v_pk_mul_f32 v[186:187], v[186:187], v[98:99]
    s_waitcnt vmcnt(2)
    v_lshlrev_b32 v92, 16, v64
    v_and_b32 v93, s61, v64
    v_lshlrev_b32 v94, 16, v65
    v_and_b32 v95, s61, v65
    v_lshlrev_b32 v96, 16, v66
    v_and_b32 v97, s61, v66
    v_lshlrev_b32 v98, 16, v67
    v_and_b32 v99, s61, v67
    v_pk_mul_f32 v[188:189], v[188:189], v[92:93]
    v_pk_mul_f32 v[190:191], v[190:191], v[94:95]
    v_pk_mul_f32 v[192:193], v[192:193], v[96:97]
    v_pk_mul_f32 v[194:195], v[194:195], v[98:99]
    s_waitcnt vmcnt(1)
    v_lshlrev_b32 v92, 16, v68
    v_and_b32 v93, s61, v68
    v_lshlrev_b32 v94, 16, v69
    v_and_b32 v95, s61, v69
    v_lshlrev_b32 v96, 16, v70
    v_and_b32 v97, s61, v70
    v_lshlrev_b32 v98, 16, v71
    v_and_b32 v99, s61, v71
    v_pk_mul_f32 v[196:197], v[196:197], v[92:93]
    v_pk_mul_f32 v[198:199], v[198:199], v[94:95]
    v_pk_mul_f32 v[200:201], v[200:201], v[96:97]
    v_pk_mul_f32 v[202:203], v[202:203], v[98:99]
    s_waitcnt vmcnt(0)
    s_add_u32 m0, s47, 32
    s_nop 0
    buffer_load_dwordx4 v3, s[24:27], s84 offen offset:0 nt lds
    buffer_load_dwordx4 v3, s[24:27], s84 offen offset:1024 nt lds
    buffer_load_dwordx4 v3, s[24:27], s84 offen offset:2048 nt lds
    buffer_load_dwordx4 v3, s[24:27], s84 offen offset:3072 nt lds
    v_lshlrev_b32 v92, 16, v72
    v_and_b32 v93, s61, v72
    v_lshlrev_b32 v94, 16, v73
    v_and_b32 v95, s61, v73
    v_lshlrev_b32 v96, 16, v74
    v_and_b32 v97, s61, v74
    v_lshlrev_b32 v98, 16, v75
    v_and_b32 v99, s61, v75
    v_pk_mul_f32 v[204:205], v[204:205], v[92:93]
    v_pk_mul_f32 v[206:207], v[206:207], v[94:95]
    v_pk_mul_f32 v[208:209], v[208:209], v[96:97]
    v_pk_mul_f32 v[210:211], v[210:211], v[98:99]
    v_cvt_pk_bf16_f32 v108, v204, v196
    v_cvt_pk_bf16_f32 v109, v188, v180
    ds_write_b64 v13, v[108:109] offset:0
    v_cvt_pk_bf16_f32 v110, v205, v197
    v_cvt_pk_bf16_f32 v111, v189, v181
    ds_write_b64 v13, v[110:111] offset:256
    v_cvt_pk_bf16_f32 v112, v206, v198
    v_cvt_pk_bf16_f32 v113, v190, v182
    ds_write_b64 v13, v[112:113] offset:512
    v_cvt_pk_bf16_f32 v114, v207, v199
    v_cvt_pk_bf16_f32 v115, v191, v183
    ds_write_b64 v13, v[114:115] offset:768
    v_cvt_pk_bf16_f32 v116, v208, v200
    v_cvt_pk_bf16_f32 v117, v192, v184
    ds_write_b64 v13, v[116:117] offset:1024
    v_cvt_pk_bf16_f32 v118, v209, v201
    v_cvt_pk_bf16_f32 v119, v193, v185
    ds_write_b64 v13, v[118:119] offset:1280
    v_cvt_pk_bf16_f32 v120, v210, v202
    v_cvt_pk_bf16_f32 v121, v194, v186
    ds_write_b64 v13, v[120:121] offset:1536
    v_cvt_pk_bf16_f32 v122, v211, v203
    v_cvt_pk_bf16_f32 v123, v195, v187
    ds_write_b64 v13, v[122:123] offset:1792
    s_waitcnt lgkmcnt(0)
    s_barrier
    ds_read_b128 v[32:35], v14 offset:0
    ds_read_b128 v[36:39], v14 offset:4128
    ds_read_b128 v[40:43], v14 offset:8256
    ds_read_b128 v[44:47], v14 offset:12384
    s_waitcnt lgkmcnt(3)
    buffer_store_dwordx4 v[32:35], v15, s[12:15], s36 offen sc1
    s_add_u32 s36, s36, 65536
    s_waitcnt lgkmcnt(2)
    buffer_store_dwordx4 v[36:39], v15, s[12:15], s36 offen sc1
    s_add_u32 s36, s36, 65536
    s_waitcnt lgkmcnt(1)
    buffer_store_dwordx4 v[40:43], v15, s[12:15], s36 offen sc1
    s_add_u32 s36, s36, 65536
    s_waitcnt lgkmcnt(0)
    buffer_store_dwordx4 v[44:47], v15, s[12:15], s36 offen sc1
    s_add_u32 s36, s36, 65536
    buffer_load_dword v20, v16, s[88:91], s49 offen sc1
    s_waitcnt vmcnt(5)
    ds_read_b128 v[96:99], v27 offset:32
    ds_read_b32 v112, v27 offset:28
    ds_read_b128 v[100:103], v27 offset:1056
    ds_read_b32 v113, v27 offset:1052
    ds_read_b128 v[104:107], v27 offset:2080
    ds_read_b32 v114, v27 offset:2076
    ds_read_b128 v[108:111], v27 offset:3104
    ds_read_b32 v115, v27 offset:3100
    s_waitcnt lgkmcnt(6)
    v_alignbit_b32 v160, v96, v112, 16
    v_alignbit_b32 v161, v97, v96, 16
    v_alignbit_b32 v162, v98, v97, 16
    v_alignbit_b32 v163, v99, v98, 16
    ds_write_b128 v27, v[160:163] offset:4192
    s_waitcnt lgkmcnt(5)
    v_alignbit_b32 v164, v100, v113, 16
    v_alignbit_b32 v165, v101, v100, 16
    v_alignbit_b32 v166, v102, v101, 16
    v_alignbit_b32 v167, v103, v102, 16
    ds_write_b128 v27, v[164:167] offset:5216
    s_waitcnt lgkmcnt(4)
    v_alignbit_b32 v168, v104, v114, 16
    v_alignbit_b32 v169, v105, v104, 16
iw_f0:
    s_cbranch_execz iw_f1
    v_alignbit_b32 v170, v106, v105, 16
    v_alignbit_b32 v171, v107, v106, 16
    ds_write_b128 v27, v[168:171] offset:6240
    s_waitcnt lgkmcnt(3)
    v_alignbit_b32 v172, v108, v115, 16
    v_alignbit_b32 v173, v109, v108, 16
    v_alignbit_b32 v174, v110, v109, 16
    v_alignbit_b32 v175, v111, v110, 16
    ds_write_b128 v27, v[172:175] offset:7264
    s_add_u32 s63, s63, 1
    v_mov_b32 v4, 0
    v_mov_b32 v5, s63
    s_cmp_lg_u32 s3, 0
    s_waitcnt vmcnt(0)
    s_barrier
    s_cbranch_scc1 interl_sig7
    v_cmp_ne_u32 vcc, 0, v20
    s_cbranch_vccnz interl_boot4
    s_mov_b32 s62, 4000000
interl_poll5:
    buffer_load_dword v7, v4, s[88:91], s49 offen sc1
    s_sub_u32 s62, s62, 1
    s_cbranch_scc1 interl_pd6
    s_waitcnt vmcnt(0)
    v_cmp_gt_u32 vcc, 1, v7
    s_cbranch_vccnz interl_poll5
interl_pd6:
    s_mov_b64 exec, -1
interl_boot4:
    s_mov_b64 exec, 1
    buffer_store_dword v5, v4, s[12:15], s94 offen sc1
    s_mov_b64 exec, -1
interl_sig7:
    buffer_load_dword v251, v224, s[8:11], s58 offen
    s_add_u32 s58, s58, 458752
    buffer_load_dword v251, v224, s[8:11], s58 offen
    s_add_u32 s58, s58, 458752
    s_and_b32 s37, s2, 7
    ds_read2_b32 a[0:1], v225 offset0:0 offset1:1
    s_lshl_b32 s37, s37, 1
    s_lshr_b32 s38, s2, 7
    ds_read2_b32 a[2:3], v225 offset0:2 offset1:3
    s_add_u32 s37, s37, s38
    s_mul_i32 s38, s37, 458752
    ds_read2_b32 a[4:5], v225 offset0:128 offset1:129
    s_lshr_b32 s59, s37, 3
    s_mul_i32 s59, s59, 458752
    ds_read2_b32 a[6:7], v225 offset0:130 offset1:131
    s_and_b32 s32, s37, 7
    s_lshl_b32 s39, s3, 10
    ds_read2_b32 a[8:9], v226 offset0:0 offset1:1
    s_add_u32 s59, s59, s39
    s_add_u32 s59, s59, 77594624
    ds_read2_b32 a[10:11], v226 offset0:2 offset1:3
    s_and_b32 s35, s3, 1
    s_lshr_b32 s37, s3, 1
    ds_read2_b32 a[12:13], v226 offset0:128 offset1:129
    s_lshl_b32 s39, s3, 13
    s_add_u32 s64, s39, s38
    ds_read2_b32 a[14:15], v226 offset0:130 offset1:131
    s_add_u32 s65, s64, 131072
    s_add_u32 s66, s64, 229376
    ds_read2_b32 a[16:17], v225 offset0:16 offset1:17
    s_add_u32 s67, s64, 360448
    s_lshl_b32 s39, s37, 17
    ds_read2_b32 a[18:19], v225 offset0:18 offset1:19
    s_lshl_b32 s68, s35, 13
    s_add_u32 s39, s39, s68
    ds_read2_b32 a[20:21], v225 offset0:144 offset1:145
    s_add_u32 s39, s39, s38
    s_add_u32 s68, s39, 65536
    ds_read2_b32 a[22:23], v225 offset0:146 offset1:147
    s_add_u32 s69, s39, 294912
    s_mul_i32 s39, s37, 229376
    ds_read2_b32 a[24:25], v226 offset0:16 offset1:17
    s_lshl_b32 s70, s35, 14
    s_add_u32 s39, s39, s70
    ds_read2_b32 a[26:27], v226 offset0:18 offset1:19
    s_add_u32 s39, s39, s38
    s_add_u32 s70, s39, 98304
    ds_read2_b32 a[28:29], v226 offset0:144 offset1:145
    s_lshr_b32 s38, s2, 3
    s_and_b32 s39, s38, 15
    ds_read2_b32 a[30:31], v226 offset0:146 offset1:147
    s_lshl_b32 s39, s39, 7
    s_add_u32 s64, s64, s39
    ds_read2_b32 a[32:33], v225 offset0:32 offset1:33
    s_bfe_u32 s39, s38, 0x30001
    s_mul_i32 s39, s39, 917504
    ds_read2_b32 a[34:35], v225 offset0:34 offset1:35
    s_add_u32 s76, s59, s39
    s_and_b32 s39, s38, 1
    ds_read2_b32 a[36:37], v225 offset0:160 offset1:161
    s_lshl_b32 s39, s39, 12
    s_add_u32 s76, s76, s39
    ds_read2_b32 a[38:39], v225 offset0:162 offset1:163
    s_lshl_b32 s39, s32, 15
    s_add_u32 s39, s39, 0
    ds_read2_b32 a[40:41], v226 offset0:32 offset1:33
    s_add_u32 s76, s76, s39
    s_add_u32 s38, s38, 1
    ds_read2_b32 a[42:43], v226 offset0:34 offset1:35
    s_and_b32 s39, s38, 15
    s_lshl_b32 s39, s39, 7
    ds_read2_b32 a[44:45], v226 offset0:160 offset1:161
    s_add_u32 s65, s65, s39
    s_bfe_u32 s39, s38, 0x30001
    ds_read2_b32 a[46:47], v226 offset0:162 offset1:163
    s_mul_i32 s39, s39, 917504
    s_add_u32 s77, s59, s39
    ds_read2_b32 a[48:49], v225 offset0:48 offset1:49
    s_and_b32 s39, s38, 1
    s_lshl_b32 s39, s39, 12
    ds_read2_b32 a[50:51], v225 offset0:50 offset1:51
    s_add_u32 s77, s77, s39
    s_lshl_b32 s39, s32, 15
    ds_read2_b32 a[52:53], v225 offset0:176 offset1:177
    s_add_u32 s39, s39, 8192
    s_add_u32 s77, s77, s39
    ds_read2_b32 a[54:55], v225 offset0:178 offset1:179
    s_add_u32 s38, s38, 1
    s_and_b32 s39, s38, 15
    ds_read2_b32 a[56:57], v226 offset0:48 offset1:49
    s_lshl_b32 s39, s39, 7
    s_add_u32 s66, s66, s39
    ds_read2_b32 a[58:59], v226 offset0:50 offset1:51
    s_bfe_u32 s39, s38, 0x30001
    s_mul_i32 s39, s39, 917504
    ds_read2_b32 a[60:61], v226 offset0:176 offset1:177
    s_add_u32 s78, s59, s39
    s_and_b32 s39, s38, 1
    ds_read2_b32 a[62:63], v226 offset0:178 offset1:179
    s_lshl_b32 s39, s39, 12
    s_add_u32 s78, s78, s39
    ds_read2_b32 a[64:65], v225 offset0:64 offset1:65
    s_lshl_b32 s39, s32, 15
    s_add_u32 s39, s39, 16384
    ds_read2_b32 a[66:67], v225 offset0:66 offset1:67
    s_add_u32 s78, s78, s39
    s_add_u32 s38, s38, 1
    ds_read2_b32 a[68:69], v225 offset0:192 offset1:193
    s_and_b32 s39, s38, 15
    s_lshl_b32 s39, s39, 7
    ds_read2_b32 a[70:71], v225 offset0:194 offset1:195
    s_add_u32 s67, s67, s39
    s_bfe_u32 s39, s38, 0x30001
    ds_read2_b32 a[72:73], v226 offset0:64 offset1:65
    s_mul_i32 s39, s39, 917504
    s_add_u32 s79, s59, s39
    ds_read2_b32 a[74:75], v226 offset0:66 offset1:67
    s_and_b32 s39, s38, 1
    s_lshl_b32 s39, s39, 12
    ds_read2_b32 a[76:77], v226 offset0:192 offset1:193
    s_add_u32 s79, s79, s39
    s_lshl_b32 s39, s32, 15
    ds_read2_b32 a[78:79], v226 offset0:194 offset1:195
    s_add_u32 s39, s39, 24576
    s_add_u32 s79, s79, s39
    ds_read2_b32 a[80:81], v225 offset0:80 offset1:81
    s_add_u32 s38, s38, 1
    s_and_b32 s39, s38, 15
    ds_read2_b32 a[82:83], v225 offset0:82 offset1:83
    s_lshl_b32 s39, s39, 7
    s_add_u32 s68, s68, s39
    ds_read2_b32 a[84:85], v225 offset0:208 offset1:209
    s_bfe_u32 s39, s38, 0x30001
    s_mul_i32 s39, s39, 917504
    ds_read2_b32 a[86:87], v225 offset0:210 offset1:211
    s_add_u32 s80, s59, s39
    s_and_b32 s39, s38, 1
    ds_read2_b32 a[88:89], v226 offset0:80 offset1:81
    s_lshl_b32 s39, s39, 12
    s_add_u32 s80, s80, s39
    ds_read2_b32 a[90:91], v226 offset0:82 offset1:83
    s_lshl_b32 s39, s32, 14
    s_add_u32 s39, s39, 262144
    ds_read2_b32 a[92:93], v226 offset0:208 offset1:209
    s_add_u32 s80, s80, s39
    s_add_u32 s38, s38, 1
    ds_read2_b32 a[94:95], v226 offset0:210 offset1:211
    s_and_b32 s39, s38, 15
    s_lshl_b32 s39, s39, 7
    ds_read2_b32 a[96:97], v225 offset0:96 offset1:97
    s_add_u32 s69, s69, s39
    s_bfe_u32 s39, s38, 0x30001
    ds_read2_b32 a[98:99], v225 offset0:98 offset1:99
    s_mul_i32 s39, s39, 917504
    s_add_u32 s81, s59, s39
    ds_read2_b32 a[100:101], v225 offset0:224 offset1:225
    s_and_b32 s39, s38, 1
    s_lshl_b32 s39, s39, 12
    ds_read2_b32 a[102:103], v225 offset0:226 offset1:227
    s_add_u32 s81, s81, s39
    s_lshl_b32 s39, s32, 14
    ds_read2_b32 a[104:105], v226 offset0:96 offset1:97
    s_add_u32 s39, s39, 270336
    s_add_u32 s81, s81, s39
    ds_read2_b32 a[106:107], v226 offset0:98 offset1:99
    s_add_u32 s38, s38, 1
    s_and_b32 s39, s38, 15
    ds_read2_b32 a[108:109], v226 offset0:224 offset1:225
    s_lshl_b32 s39, s39, 7
    s_add_u32 s70, s70, s39
    ds_read2_b32 a[110:111], v226 offset0:226 offset1:227
    s_bfe_u32 s39, s38, 0x30001
    s_mul_i32 s39, s39, 917504
    ds_read2_b32 a[112:113], v225 offset0:112 offset1:113
    s_add_u32 s82, s59, s39
    s_and_b32 s39, s38, 1
    ds_read2_b32 a[114:115], v225 offset0:114 offset1:115
    s_lshl_b32 s39, s39, 12
    s_add_u32 s82, s82, s39
    ds_read2_b32 a[116:117], v225 offset0:240 offset1:241
    s_lshl_b32 s39, s32, 13
    s_add_u32 s39, s39, 393216
    ds_read2_b32 a[118:119], v225 offset0:242 offset1:243
    s_add_u32 s82, s82, s39
    s_add_u32 s38, s38, 1
    ds_read2_b32 a[120:121], v226 offset0:112 offset1:113
    s_lshl_b32 s71, s3, 10
    s_add_u32 s71, s71, 133120
    ds_read2_b32 a[122:123], v226 offset0:114 offset1:115
    v_lshrrev_b32 v6, 5, v2
    v_bfe_u32 v7, v2, 3, 2
    ds_read2_b32 a[124:125], v226 offset0:240 offset1:241
    v_and_b32 v216, 0x70, v3
    v_lshl_add_u32 v7, v7, 11, v216
    ds_read2_b32 a[126:127], v226 offset0:242 offset1:243
    v_lshl_add_u32 v216, v6, 15, v7
    v_lshl_add_u32 v217, v6, 14, v7
    v_lshl_add_u32 v218, v6, 13, v7
    v_bfe_u32 v6, v2, 2, 2
    v_lshrrev_b32 v5, 4, v2
    v_lshl_add_u32 v6, v5, 3, v6
    v_and_b32 v7, 0x30, v3
    v_lshl_add_u32 v6, v6, 7, v7
    s_lshl_b32 s37, s37, 6
    s_lshl_b32 s35, s35, 3
    s_add_u32 s37, s37, s35
    s_add_u32 s37, s37, 133120
    v_add_u32 v219, s37, v6
    s_add_u32 s64, s64, 15
    s_add_u32 s65, s65, 15
    s_add_u32 s66, s66, 15
    s_add_u32 s67, s67, 15
    s_add_u32 s68, s68, 14
    s_add_u32 s69, s69, 14
    s_add_u32 s70, s70, 13
    s_mov_b32 s72, s71
    s_mov_b32 s83, 0
    s_mov_b32 s71, 0
    s_mov_b64 s[74:75], 0
    s_and_b32 s44, s3, 1
    s_lshr_b32 s45, s3, 1
    s_and_b32 s46, s5, 1
    s_mul_i32 s41, s44, 114688
    s_mul_i32 s33, s5, 224
    s_add_u32 s41, s41, s33
    s_lshl_b32 s33, s46, 5
    s_sub_u32 s41, s41, s33
    s_mov_b32 s92, s41
    s_mul_i32 s43, s45, 8208
    s_lshl_b32 s33, s44, 12
    s_add_u32 s43, s43, s33
    s_add_u32 s43, s43, 16384
    v_lshrrev_b32 v1, 4, v2
    v_bfe_u32 v4, v2, 1, 3
    v_xor_b32 v4, v4, v1
    v_and_b32 v5, 1, v2
    v_lshlrev_b32 v5, 4, v5
    v_mul_u32_u24 v6, 7168, v1
    v_add_u32 v6, v6, v5
    v_lshl_add_u32 v19, v4, 5, v6
    v_xor_b32 v4, 4, v4
    v_lshl_add_u32 v21, v4, 5, v6
    v_add_u32 v20, 27648, v19
    v_add_u32 v22, 82944, v21
    v_add_u32 v21, 55296, v21
    s_add_u32 s84, s84, 0
    s_lshl_b32 s37, s3, 29
    v_mov_b32 v230, s37
    v_mov_b32 v231, 2
    s_cmp_eq_u32 s3, 0
    s_cbranch_scc1 iw_ret
    s_mov_b64 exec, 0
    s_cmp_eq_u32 s3, 1
    s_cbranch_scc1 iw_c0
    s_cmp_eq_u32 s3, 2
    s_cbranch_scc1 iw_c1
    s_branch iw_c2
iw_ret:
    s_mov_b64 exec, -1
    s_cmp_lg_u32 s3, 0
    s_cbranch_scc1 interl_wt8
    s_mov_b64 exec, 0xffff
    s_mov_b32 s62, 4000000
interl_poll9:
    buffer_load_dword v7, v28, s[12:15], s95 offen sc1
    s_sub_u32 s62, s62, 1
    s_cbranch_scc1 interl_pd10
    s_waitcnt vmcnt(0)
    v_cmp_gt_u32 vcc, s63, v7
    s_cbranch_vccnz interl_poll9
interl_pd10:
    s_mov_b64 exec, -1
interl_wt8:
    s_barrier
    s_add_u32 m0, s47, 8320
    s_mov_b32 s38, 0x05040100
    buffer_load_dwordx4 v3, s[12:15], s84 offen offset:3072 sc1 lds
    buffer_load_dwordx4 v3, s[12:15], s84 offen offset:2048 sc1 lds
    buffer_load_dwordx4 v3, s[12:15], s84 offen offset:1024 sc1 lds
    buffer_load_dwordx4 v3, s[12:15], s84 offen offset:0 sc1 lds
    s_mov_b32 s39, 0x07060302
    s_waitcnt vmcnt(3)
    ds_read_b128 a[128:131], v26 offset:3584
    ds_read_b128 a[132:135], v26 offset:3072
    s_waitcnt vmcnt(2)
    ds_read_b128 a[136:139], v26 offset:2560
    ds_read_b128 a[140:143], v26 offset:2048
    ds_read_b128 a[144:147], v26 offset:3648
    ds_read_b128 a[148:151], v26 offset:3136
    ds_read_b128 a[152:155], v26 offset:2624
    ds_read_b128 a[156:159], v26 offset:2112
    s_waitcnt lgkmcnt(7)
    v_mfma_f32_16x16x32_bf16 v[32:35], v[252:255], a[128:131], 0
    s_waitcnt lgkmcnt(6)
    v_mfma_f32_16x16x32_bf16 v[36:39], v[252:255], a[132:135], 0
    s_waitcnt lgkmcnt(5)
    v_mfma_f32_16x16x32_bf16 v[40:43], v[252:255], a[136:139], 0
    s_waitcnt lgkmcnt(4)
    v_mfma_f32_16x16x32_bf16 v[44:47], v[252:255], a[140:143], 0
    v_mfma_f32_16x16x32_bf16 v[32:35], a[0:3], a[128:131], v[32:35]
    ds_read_b128 a[160:163], v26 offset:3712
    v_mfma_f32_16x16x32_bf16 v[36:39], a[0:3], a[132:135], v[36:39]
    ds_read_b128 a[164:167], v26 offset:3200
    v_mfma_f32_16x16x32_bf16 v[36:39], a[4:7], a[128:131], v[36:39]
    ds_read_b128 a[168:171], v26 offset:2688
    v_mfma_f32_16x16x32_bf16 v[40:43], a[0:3], a[136:139], v[40:43]
    ds_read_b128 a[172:175], v26 offset:2176
    v_mfma_f32_16x16x32_bf16 v[40:43], a[4:7], a[132:135], v[40:43]
    v_mfma_f32_16x16x32_bf16 v[40:43], a[8:11], a[128:131], v[40:43]
    v_mfma_f32_16x16x32_bf16 v[44:47], a[0:3], a[140:143], v[44:47]
    v_mfma_f32_16x16x32_bf16 v[44:47], a[4:7], a[136:139], v[44:47]
    v_mfma_f32_16x16x32_bf16 v[44:47], a[8:11], a[132:135], v[44:47]
    v_mfma_f32_16x16x32_bf16 v[44:47], a[12:15], a[128:131], v[44:47]
    s_waitcnt lgkmcnt(4)
    v_mfma_f32_16x16x32_bf16 v[32:35], a[16:19], a[144:147], v[32:35]
    ds_read_b128 a[176:179], v26 offset:3776
    v_mfma_f32_16x16x32_bf16 v[36:39], a[16:19], a[148:151], v[36:39]
    ds_read_b128 a[180:183], v26 offset:3264
    v_mfma_f32_16x16x32_bf16 v[36:39], a[20:23], a[144:147], v[36:39]
    ds_read_b128 a[184:187], v26 offset:2752
    v_mfma_f32_16x16x32_bf16 v[40:43], a[16:19], a[152:155], v[40:43]
    ds_read_b128 a[188:191], v26 offset:2240
    v_mfma_f32_16x16x32_bf16 v[40:43], a[20:23], a[148:151], v[40:43]
iw_f1:
    s_cbranch_execz iw_f2
    v_mfma_f32_16x16x32_bf16 v[40:43], a[24:27], a[144:147], v[40:43]
    v_mfma_f32_16x16x32_bf16 v[44:47], a[16:19], a[156:159], v[44:47]
    v_mfma_f32_16x16x32_bf16 v[44:47], a[20:23], a[152:155], v[44:47]
    v_mfma_f32_16x16x32_bf16 v[44:47], a[24:27], a[148:151], v[44:47]
    v_mfma_f32_16x16x32_bf16 v[44:47], a[28:31], a[144:147], v[44:47]
    s_waitcnt lgkmcnt(4)
    s_waitcnt vmcnt(0)
    v_mfma_f32_16x16x32_bf16 v[32:35], a[32:35], a[160:163], v[32:35]
    ds_read_b128 a[192:195], v26 offset:3840
    buffer_load_dwordx4 v[232:235], v29, s[28:31], s56 offen offset:0 nt
    v_mfma_f32_16x16x32_bf16 v[36:39], a[32:35], a[164:167], v[36:39]
    ds_read_b128 a[196:199], v26 offset:3328
    v_mfma_f32_16x16x32_bf16 v[36:39], a[36:39], a[160:163], v[36:39]
    ds_read_b128 a[200:203], v26 offset:2816
    v_mfma_f32_16x16x32_bf16 v[40:43], a[32:35], a[168:171], v[40:43]
    ds_read_b128 a[204:207], v26 offset:2304
    v_mfma_f32_16x16x32_bf16 v[40:43], a[36:39], a[164:167], v[40:43]
    v_mfma_f32_16x16x32_bf16 v[40:43], a[40:43], a[160:163], v[40:43]
    v_mfma_f32_16x16x32_bf16 v[44:47], a[32:35], a[172:175], v[44:47]
    v_mfma_f32_16x16x32_bf16 v[44:47], a[36:39], a[168:171], v[44:47]
    v_mfma_f32_16x16x32_bf16 v[44:47], a[40:43], a[164:167], v[44:47]
    v_mfma_f32_16x16x32_bf16 v[44:47], a[44:47], a[160:163], v[44:47]
    s_waitcnt lgkmcnt(4)
    v_mfma_f32_16x16x32_bf16 v[32:35], a[48:51], a[176:179], v[32:35]
    ds_read_b128 a[208:211], v26 offset:3904
    v_mfma_f32_16x16x32_bf16 v[36:39], a[48:51], a[180:183], v[36:39]
    ds_read_b128 a[212:215], v26 offset:3392
    v_mfma_f32_16x16x32_bf16 v[36:39], a[52:55], a[176:179], v[36:39]
    ds_read_b128 a[216:219], v26 offset:2880
    v_mfma_f32_16x16x32_bf16 v[40:43], a[48:51], a[184:187], v[40:43]
    ds_read_b128 a[220:223], v26 offset:2368
    v_mfma_f32_16x16x32_bf16 v[40:43], a[52:55], a[180:183], v[40:43]
    v_mfma_f32_16x16x32_bf16 v[40:43], a[56:59], a[176:179], v[40:43]
    v_mfma_f32_16x16x32_bf16 v[44:47], a[48:51], a[188:191], v[44:47]
    v_mfma_f32_16x16x32_bf16 v[44:47], a[52:55], a[184:187], v[44:47]
    v_mfma_f32_16x16x32_bf16 v[44:47], a[56:59], a[180:183], v[44:47]
    v_mfma_f32_16x16x32_bf16 v[44:47], a[60:63], a[176:179], v[44:47]
    s_waitcnt lgkmcnt(4)
    v_mfma_f32_16x16x32_bf16 v[32:35], a[64:67], a[192:195], v[32:35]
    ds_read_b128 a[224:227], v26 offset:3968
    v_mfma_f32_16x16x32_bf16 v[36:39], a[64:67], a[196:199], v[36:39]
    ds_read_b128 a[228:231], v26 offset:3456
    v_mfma_f32_16x16x32_bf16 v[36:39], a[68:71], a[192:195], v[36:39]
    ds_read_b128 a[232:235], v26 offset:2944
    v_mfma_f32_16x16x32_bf16 v[40:43], a[64:67], a[200:203], v[40:43]
    ds_read_b128 a[236:239], v26 offset:2432
    v_mfma_f32_16x16x32_bf16 v[40:43], a[68:71], a[196:199], v[40:43]
    v_mfma_f32_16x16x32_bf16 v[40:43], a[72:75], a[192:195], v[40:43]
    v_mfma_f32_16x16x32_bf16 v[44:47], a[64:67], a[204:207], v[44:47]
    v_mfma_f32_16x16x32_bf16 v[44:47], a[68:71], a[200:203], v[44:47]
    v_mfma_f32_16x16x32_bf16 v[44:47], a[72:75], a[196:199], v[44:47]
    v_mfma_f32_16x16x32_bf16 v[44:47], a[76:79], a[192:195], v[44:47]
    s_waitcnt lgkmcnt(4)
    v_mfma_f32_16x16x32_bf16 v[32:35], a[80:83], a[208:211], v[32:35]
    ds_read_b128 a[240:243], v26 offset:4032
    v_mfma_f32_16x16x32_bf16 v[36:39], a[80:83], a[212:215], v[36:39]
    ds_read_b128 a[244:247], v26 offset:3520
    v_mfma_f32_16x16x32_bf16 v[36:39], a[84:87], a[208:211], v[36:39]
    ds_read_b128 a[248:251], v26 offset:3008
    v_mfma_f32_16x16x32_bf16 v[40:43], a[80:83], a[216:219], v[40:43]
    ds_read_b128 a[252:255], v26 offset:2496
    v_mfma_f32_16x16x32_bf16 v[40:43], a[84:87], a[212:215], v[40:43]
    v_mfma_f32_16x16x32_bf16 v[40:43], a[88:91], a[208:211], v[40:43]
    v_mfma_f32_16x16x32_bf16 v[44:47], a[80:83], a[220:223], v[44:47]
    v_mfma_f32_16x16x32_bf16 v[44:47], a[84:87], a[216:219], v[44:47]
    v_mfma_f32_16x16x32_bf16 v[44:47], a[88:91], a[212:215], v[44:47]
    v_mfma_f32_16x16x32_bf16 v[44:47], a[92:95], a[208:211], v[44:47]
    s_waitcnt lgkmcnt(4)
    v_mfma_f32_16x16x32_bf16 v[32:35], a[96:99], a[224:227], v[32:35]
    ds_read_b128 v[144:147], v26 offset:1536
    buffer_load_dwordx4 v[236:239], v29, s[28:31], s56 offen offset:128 nt
    v_mfma_f32_16x16x32_bf16 v[36:39], a[96:99], a[228:231], v[36:39]
    ds_read_b128 v[148:151], v26 offset:1024
    v_mfma_f32_16x16x32_bf16 v[36:39], a[100:103], a[224:227], v[36:39]
    ds_read_b128 v[152:155], v26 offset:512
    v_mfma_f32_16x16x32_bf16 v[40:43], a[96:99], a[232:235], v[40:43]
    ds_read_b128 v[156:159], v26 offset:0
    v_mfma_f32_16x16x32_bf16 v[40:43], a[100:103], a[228:231], v[40:43]
    ds_read2_b32 v[80:81], v227 offset0:0 offset1:1
    v_mfma_f32_16x16x32_bf16 v[40:43], a[104:107], a[224:227], v[40:43]
    ds_read2_b32 v[82:83], v227 offset0:2 offset1:3
    v_mfma_f32_16x16x32_bf16 v[44:47], a[96:99], a[236:239], v[44:47]
    v_mfma_f32_16x16x32_bf16 v[44:47], a[100:103], a[232:235], v[44:47]
    v_mfma_f32_16x16x32_bf16 v[44:47], a[104:107], a[228:231], v[44:47]
    v_mfma_f32_16x16x32_bf16 v[44:47], a[108:111], a[224:227], v[44:47]
    s_waitcnt lgkmcnt(6)
    v_mfma_f32_16x16x32_bf16 v[32:35], a[112:115], a[240:243], v[32:35]
    ds_read2_b32 v[84:85], v227 offset0:128 offset1:129
    v_mfma_f32_16x16x32_bf16 v[36:39], a[112:115], a[244:247], v[36:39]
    ds_read2_b32 v[86:87], v227 offset0:130 offset1:131
    v_mfma_f32_16x16x32_bf16 v[36:39], a[116:119], a[240:243], v[36:39]
    ds_read2_b32 v[88:89], v228 offset0:0 offset1:1
    v_mfma_f32_16x16x32_bf16 v[40:43], a[112:115], a[248:251], v[40:43]
    ds_read2_b32 v[90:91], v228 offset0:2 offset1:3
    v_mfma_f32_16x16x32_bf16 v[40:43], a[116:119], a[244:247], v[40:43]
    ds_read2_b32 v[92:93], v228 offset0:128 offset1:129
    v_mfma_f32_16x16x32_bf16 v[40:43], a[120:123], a[240:243], v[40:43]
    ds_read2_b32 v[94:95], v228 offset0:130 offset1:131
    v_mfma_f32_16x16x32_bf16 v[44:47], a[112:115], a[252:255], v[44:47]
    v_mfma_f32_16x16x32_bf16 v[44:47], a[116:119], a[248:251], v[44:47]
    v_mfma_f32_16x16x32_bf16 v[44:47], a[120:123], a[244:247], v[44:47]
    v_mfma_f32_16x16x32_bf16 v[44:47], a[124:127], a[240:243], v[44:47]
    s_waitcnt lgkmcnt(0)
    v_mfma_f32_16x16x32_bf16 v[48:51], v[252:255], v[144:147], 0
    v_mfma_f32_16x16x32_bf16 v[52:55], v[252:255], v[148:151], 0
    v_mfma_f32_16x16x32_bf16 v[56:59], v[252:255], v[152:155], 0
    v_mfma_f32_16x16x32_bf16 v[60:63], v[252:255], v[156:159], 0
    v_mfma_f32_16x16x32_bf16 v[48:51], a[0:3], v[144:147], v[48:51]
    ds_read_b128 v[176:179], v26 offset:1600
    v_cvt_pk_bf16_f32 v32, v32, v33
    v_mfma_f32_16x16x32_bf16 v[48:51], a[4:7], a[140:143], v[48:51]
    ds_read_b128 v[180:183], v26 offset:1088
    v_cvt_pk_bf16_f32 v33, v34, v35
    v_mfma_f32_16x16x32_bf16 v[48:51], a[8:11], a[136:139], v[48:51]
    ds_read_b128 v[184:187], v26 offset:576
    ds_write_b64 v212, v[32:33] offset:12992
    v_mfma_f32_16x16x32_bf16 v[48:51], a[12:15], a[132:135], v[48:51]
    ds_read_b128 v[188:191], v26 offset:64
    v_cvt_pk_bf16_f32 v36, v36, v37
    v_mfma_f32_16x16x32_bf16 v[48:51], v[80:83], a[128:131], v[48:51]
    ds_read2_b32 v[112:113], v227 offset0:16 offset1:17
    v_cvt_pk_bf16_f32 v37, v38, v39
    v_mfma_f32_16x16x32_bf16 v[52:55], a[0:3], v[148:151], v[52:55]
    ds_read2_b32 v[114:115], v227 offset0:18 offset1:19
    ds_write_b64 v212, v[36:37] offset:13632
    v_mfma_f32_16x16x32_bf16 v[52:55], a[4:7], v[144:147], v[52:55]
    ds_read2_b32 v[116:117], v227 offset0:144 offset1:145
    v_cvt_pk_bf16_f32 v40, v40, v41
    v_mfma_f32_16x16x32_bf16 v[52:55], a[8:11], a[140:143], v[52:55]
    ds_read2_b32 v[118:119], v227 offset0:146 offset1:147
    v_cvt_pk_bf16_f32 v41, v42, v43
    v_mfma_f32_16x16x32_bf16 v[52:55], a[12:15], a[136:139], v[52:55]
    ds_read2_b32 v[120:121], v228 offset0:16 offset1:17
    ds_write_b64 v212, v[40:41] offset:14272
    v_mfma_f32_16x16x32_bf16 v[52:55], v[80:83], a[132:135], v[52:55]
    ds_read2_b32 v[122:123], v228 offset0:18 offset1:19
    v_cvt_pk_bf16_f32 v44, v44, v45
    v_mfma_f32_16x16x32_bf16 v[52:55], v[84:87], a[128:131], v[52:55]
    ds_read2_b32 v[124:125], v228 offset0:144 offset1:145
    v_cvt_pk_bf16_f32 v45, v46, v47
    v_mfma_f32_16x16x32_bf16 v[56:59], a[0:3], v[152:155], v[56:59]
    ds_read2_b32 v[126:127], v228 offset0:146 offset1:147
    ds_write_b64 v212, v[44:45] offset:14912
    v_mfma_f32_16x16x32_bf16 v[56:59], a[4:7], v[148:151], v[56:59]
    v_mfma_f32_16x16x32_bf16 v[56:59], a[8:11], v[144:147], v[56:59]
    v_mfma_f32_16x16x32_bf16 v[56:59], a[12:15], a[140:143], v[56:59]
    v_mfma_f32_16x16x32_bf16 v[56:59], v[80:83], a[136:139], v[56:59]
    v_mfma_f32_16x16x32_bf16 v[56:59], v[84:87], a[132:135], v[56:59]
    v_mfma_f32_16x16x32_bf16 v[56:59], v[88:91], a[128:131], v[56:59]
    v_mfma_f32_16x16x32_bf16 v[60:63], a[0:3], v[156:159], v[60:63]
    v_mfma_f32_16x16x32_bf16 v[60:63], a[4:7], v[152:155], v[60:63]
    v_mfma_f32_16x16x32_bf16 v[60:63], a[8:11], v[148:151], v[60:63]
    buffer_load_dwordx4 v[240:243], v29, s[28:31], s56 offen offset:256 nt
    v_mfma_f32_16x16x32_bf16 v[60:63], a[12:15], v[144:147], v[60:63]
    v_mfma_f32_16x16x32_bf16 v[60:63], v[80:83], a[140:143], v[60:63]
    v_mfma_f32_16x16x32_bf16 v[60:63], v[84:87], a[136:139], v[60:63]
    v_mfma_f32_16x16x32_bf16 v[60:63], v[88:91], a[132:135], v[60:63]
    v_mfma_f32_16x16x32_bf16 v[60:63], v[92:95], a[128:131], v[60:63]
    s_waitcnt lgkmcnt(0)
    v_mfma_f32_16x16x32_bf16 v[48:51], a[16:19], v[176:179], v[48:51]
    s_barrier
    ds_read_b128 v[144:147], v26 offset:1664
    v_mfma_f32_16x16x32_bf16 v[48:51], a[20:23], a[156:159], v[48:51]
    ds_read_b128 v[148:151], v26 offset:1152
    v_mfma_f32_16x16x32_bf16 v[48:51], a[24:27], a[152:155], v[48:51]
    ds_read_b128 v[152:155], v26 offset:640
    v_mfma_f32_16x16x32_bf16 v[48:51], a[28:31], a[148:151], v[48:51]
    ds_read_b128 v[156:159], v26 offset:128
    v_mfma_f32_16x16x32_bf16 v[48:51], v[112:115], a[144:147], v[48:51]
    ds_read2_b32 v[80:81], v227 offset0:32 offset1:33
    v_mfma_f32_16x16x32_bf16 v[52:55], a[16:19], v[180:183], v[52:55]
    ds_read2_b32 v[82:83], v227 offset0:34 offset1:35
    v_mfma_f32_16x16x32_bf16 v[52:55], a[20:23], v[176:179], v[52:55]
    ds_read2_b32 v[84:85], v227 offset0:160 offset1:161
    v_mfma_f32_16x16x32_bf16 v[52:55], a[24:27], a[156:159], v[52:55]
    ds_read2_b32 v[86:87], v227 offset0:162 offset1:163
    v_mfma_f32_16x16x32_bf16 v[52:55], a[28:31], a[152:155], v[52:55]
    ds_read2_b32 v[88:89], v228 offset0:32 offset1:33
    v_mfma_f32_16x16x32_bf16 v[52:55], v[112:115], a[148:151], v[52:55]
    ds_read2_b32 v[90:91], v228 offset0:34 offset1:35
    v_mfma_f32_16x16x32_bf16 v[52:55], v[116:119], a[144:147], v[52:55]
    ds_read2_b32 v[92:93], v228 offset0:160 offset1:161
    v_mfma_f32_16x16x32_bf16 v[56:59], a[16:19], v[184:187], v[56:59]
    ds_read2_b32 v[94:95], v228 offset0:162 offset1:163
    v_mfma_f32_16x16x32_bf16 v[56:59], a[20:23], v[180:183], v[56:59]
    ds_read_b32 v64, v213 offset:12992
    v_mfma_f32_16x16x32_bf16 v[56:59], a[24:27], v[176:179], v[56:59]
    ds_read_b32 v65, v213 offset:46016
    v_mfma_f32_16x16x32_bf16 v[56:59], a[28:31], a[156:159], v[56:59]
    ds_read_b32 v66, v229 offset:12992
    v_mfma_f32_16x16x32_bf16 v[56:59], v[112:115], a[152:155], v[56:59]
    ds_read_b32 v67, v229 offset:46016
    v_mfma_f32_16x16x32_bf16 v[56:59], v[116:119], a[148:151], v[56:59]
    ds_read_b32 v68, v213 offset:13056
    v_mfma_f32_16x16x32_bf16 v[56:59], v[120:123], a[144:147], v[56:59]
    ds_read_b32 v69, v213 offset:46080
    v_mfma_f32_16x16x32_bf16 v[60:63], a[16:19], v[188:191], v[60:63]
    ds_read_b32 v70, v229 offset:13056
    v_mfma_f32_16x16x32_bf16 v[60:63], a[20:23], v[184:187], v[60:63]
    ds_read_b32 v71, v229 offset:46080
    v_mfma_f32_16x16x32_bf16 v[60:63], a[24:27], v[180:183], v[60:63]
    v_mfma_f32_16x16x32_bf16 v[60:63], a[28:31], v[176:179], v[60:63]
    v_mfma_f32_16x16x32_bf16 v[60:63], v[112:115], a[156:159], v[60:63]
    v_mfma_f32_16x16x32_bf16 v[60:63], v[116:119], a[152:155], v[60:63]
    v_mfma_f32_16x16x32_bf16 v[60:63], v[120:123], a[148:151], v[60:63]
    v_mfma_f32_16x16x32_bf16 v[60:63], v[124:127], a[144:147], v[60:63]
    s_waitcnt lgkmcnt(0)
    v_mfma_f32_16x16x32_bf16 v[48:51], a[32:35], v[144:147], v[48:51]
    ds_read_b128 v[176:179], v26 offset:1728
    v_mfma_f32_16x16x32_bf16 v[48:51], a[36:39], a[172:175], v[48:51]
    ds_read_b128 v[180:183], v26 offset:1216
    v_mfma_f32_16x16x32_bf16 v[48:51], a[40:43], a[168:171], v[48:51]
    ds_read_b128 v[184:187], v26 offset:704
    v_mfma_f32_16x16x32_bf16 v[48:51], a[44:47], a[164:167], v[48:51]
    ds_read_b128 v[188:191], v26 offset:192
    v_mfma_f32_16x16x32_bf16 v[48:51], v[80:83], a[160:163], v[48:51]
    ds_read2_b32 v[112:113], v227 offset0:48 offset1:49
    v_mfma_f32_16x16x32_bf16 v[52:55], a[32:35], v[148:151], v[52:55]
    ds_read2_b32 v[114:115], v227 offset0:50 offset1:51
    v_mfma_f32_16x16x32_bf16 v[52:55], a[36:39], v[144:147], v[52:55]
    ds_read2_b32 v[116:117], v227 offset0:176 offset1:177
    v_mfma_f32_16x16x32_bf16 v[52:55], a[40:43], a[172:175], v[52:55]
    ds_read2_b32 v[118:119], v227 offset0:178 offset1:179
    v_mfma_f32_16x16x32_bf16 v[52:55], a[44:47], a[168:171], v[52:55]
    ds_read2_b32 v[120:121], v228 offset0:48 offset1:49
    buffer_load_dwordx4 v[244:247], v29, s[28:31], s56 offen offset:384 nt
    v_mfma_f32_16x16x32_bf16 v[52:55], v[80:83], a[164:167], v[52:55]
    ds_read2_b32 v[122:123], v228 offset0:50 offset1:51
    v_mfma_f32_16x16x32_bf16 v[52:55], v[84:87], a[160:163], v[52:55]
    ds_read2_b32 v[124:125], v228 offset0:176 offset1:177
    v_mfma_f32_16x16x32_bf16 v[56:59], a[32:35], v[152:155], v[56:59]
    ds_read2_b32 v[126:127], v228 offset0:178 offset1:179
    v_mfma_f32_16x16x32_bf16 v[56:59], a[36:39], v[148:151], v[56:59]
    v_perm_b32 v128, v65, v64, s38
    v_mfma_f32_16x16x32_bf16 v[56:59], a[40:43], v[144:147], v[56:59]
    v_perm_b32 v129, v67, v66, s38
    v_mfma_f32_16x16x32_bf16 v[56:59], a[44:47], a[172:175], v[56:59]
    v_perm_b32 v130, v65, v64, s39
    v_mfma_f32_16x16x32_bf16 v[56:59], v[80:83], a[168:171], v[56:59]
    v_perm_b32 v131, v67, v66, s39
    v_mfma_f32_16x16x32_bf16 v[56:59], v[84:87], a[164:167], v[56:59]
    buffer_store_dwordx4 v[128:131], v214, s[12:15], s57 offen sc1
    v_mfma_f32_16x16x32_bf16 v[56:59], v[88:91], a[160:163], v[56:59]
    s_add_u32 s57, s57, 262144
    v_mfma_f32_16x16x32_bf16 v[60:63], a[32:35], v[156:159], v[60:63]
    v_perm_b32 v132, v69, v68, s38
    v_mfma_f32_16x16x32_bf16 v[60:63], a[36:39], v[152:155], v[60:63]
    v_perm_b32 v133, v71, v70, s38
    v_mfma_f32_16x16x32_bf16 v[60:63], a[40:43], v[148:151], v[60:63]
    v_perm_b32 v134, v69, v68, s39
    v_mfma_f32_16x16x32_bf16 v[60:63], a[44:47], v[144:147], v[60:63]
    v_perm_b32 v135, v71, v70, s39
    v_mfma_f32_16x16x32_bf16 v[60:63], v[80:83], a[172:175], v[60:63]
    buffer_store_dwordx4 v[132:135], v214, s[12:15], s57 offen sc1
    v_mfma_f32_16x16x32_bf16 v[60:63], v[84:87], a[168:171], v[60:63]
    s_add_u32 s57, s57, 1835008
    v_mfma_f32_16x16x32_bf16 v[60:63], v[88:91], a[164:167], v[60:63]
iw_f2:
    s_cbranch_execz iw_f3
    v_mfma_f32_16x16x32_bf16 v[60:63], v[92:95], a[160:163], v[60:63]
    s_waitcnt lgkmcnt(0)
    v_mfma_f32_16x16x32_bf16 v[48:51], a[48:51], v[176:179], v[48:51]
    ds_read_b128 v[144:147], v26 offset:1792
    v_mfma_f32_16x16x32_bf16 v[48:51], a[52:55], a[188:191], v[48:51]
    ds_read_b128 v[148:151], v26 offset:1280
    v_mfma_f32_16x16x32_bf16 v[48:51], a[56:59], a[184:187], v[48:51]
    ds_read_b128 v[152:155], v26 offset:768
    v_mfma_f32_16x16x32_bf16 v[48:51], a[60:63], a[180:183], v[48:51]
    ds_read_b128 v[156:159], v26 offset:256
    v_mfma_f32_16x16x32_bf16 v[48:51], v[112:115], a[176:179], v[48:51]
    ds_read2_b32 v[80:81], v227 offset0:64 offset1:65
    v_mfma_f32_16x16x32_bf16 v[52:55], a[48:51], v[180:183], v[52:55]
    ds_read2_b32 v[82:83], v227 offset0:66 offset1:67
    v_mfma_f32_16x16x32_bf16 v[52:55], a[52:55], v[176:179], v[52:55]
    ds_read2_b32 v[84:85], v227 offset0:192 offset1:193
    v_mfma_f32_16x16x32_bf16 v[52:55], a[56:59], a[188:191], v[52:55]
    ds_read2_b32 v[86:87], v227 offset0:194 offset1:195
    v_mfma_f32_16x16x32_bf16 v[52:55], a[60:63], a[184:187], v[52:55]
    ds_read2_b32 v[88:89], v228 offset0:64 offset1:65
    v_mfma_f32_16x16x32_bf16 v[52:55], v[112:115], a[180:183], v[52:55]
    ds_read2_b32 v[90:91], v228 offset0:66 offset1:67
    v_mfma_f32_16x16x32_bf16 v[52:55], v[116:119], a[176:179], v[52:55]
    ds_read2_b32 v[92:93], v228 offset0:192 offset1:193
    v_mfma_f32_16x16x32_bf16 v[56:59], a[48:51], v[184:187], v[56:59]
    ds_read2_b32 v[94:95], v228 offset0:194 offset1:195
    v_mfma_f32_16x16x32_bf16 v[56:59], a[52:55], v[180:183], v[56:59]
    buffer_load_dword v251, v224, s[8:11], s58 offen
    v_mfma_f32_16x16x32_bf16 v[56:59], a[56:59], v[176:179], v[56:59]
    s_add_u32 s58, s58, 458752
    v_mfma_f32_16x16x32_bf16 v[56:59], a[60:63], a[188:191], v[56:59]
    v_mfma_f32_16x16x32_bf16 v[56:59], v[112:115], a[184:187], v[56:59]
    v_mfma_f32_16x16x32_bf16 v[56:59], v[116:119], a[180:183], v[56:59]
    v_mfma_f32_16x16x32_bf16 v[56:59], v[120:123], a[176:179], v[56:59]
    v_mfma_f32_16x16x32_bf16 v[60:63], a[48:51], v[188:191], v[60:63]
    v_mfma_f32_16x16x32_bf16 v[60:63], a[52:55], v[184:187], v[60:63]
    v_mfma_f32_16x16x32_bf16 v[60:63], a[56:59], v[180:183], v[60:63]
    v_mfma_f32_16x16x32_bf16 v[60:63], a[60:63], v[176:179], v[60:63]
    v_mfma_f32_16x16x32_bf16 v[60:63], v[112:115], a[188:191], v[60:63]
    v_mfma_f32_16x16x32_bf16 v[60:63], v[116:119], a[184:187], v[60:63]
    v_mfma_f32_16x16x32_bf16 v[60:63], v[120:123], a[180:183], v[60:63]
    v_mfma_f32_16x16x32_bf16 v[60:63], v[124:127], a[176:179], v[60:63]
    s_waitcnt lgkmcnt(0)
    v_mfma_f32_16x16x32_bf16 v[48:51], a[64:67], v[144:147], v[48:51]
    ds_read_b128 v[176:179], v26 offset:1856
    v_mfma_f32_16x16x32_bf16 v[48:51], a[68:71], a[204:207], v[48:51]
    ds_read_b128 v[180:183], v26 offset:1344
    v_mfma_f32_16x16x32_bf16 v[48:51], a[72:75], a[200:203], v[48:51]
    ds_read_b128 v[184:187], v26 offset:832
    v_mfma_f32_16x16x32_bf16 v[48:51], a[76:79], a[196:199], v[48:51]
    ds_read_b128 v[188:191], v26 offset:320
    v_mfma_f32_16x16x32_bf16 v[48:51], v[80:83], a[192:195], v[48:51]
    ds_read2_b32 v[112:113], v227 offset0:80 offset1:81
    v_mfma_f32_16x16x32_bf16 v[52:55], a[64:67], v[148:151], v[52:55]
    ds_read2_b32 v[114:115], v227 offset0:82 offset1:83
    v_mfma_f32_16x16x32_bf16 v[52:55], a[68:71], v[144:147], v[52:55]
    ds_read2_b32 v[116:117], v227 offset0:208 offset1:209
    v_mfma_f32_16x16x32_bf16 v[52:55], a[72:75], a[204:207], v[52:55]
    ds_read2_b32 v[118:119], v227 offset0:210 offset1:211
    v_mfma_f32_16x16x32_bf16 v[52:55], a[76:79], a[200:203], v[52:55]
    ds_read2_b32 v[120:121], v228 offset0:80 offset1:81
    v_mfma_f32_16x16x32_bf16 v[52:55], v[80:83], a[196:199], v[52:55]
    ds_read2_b32 v[122:123], v228 offset0:82 offset1:83
    v_mfma_f32_16x16x32_bf16 v[52:55], v[84:87], a[192:195], v[52:55]
    ds_read2_b32 v[124:125], v228 offset0:208 offset1:209
    v_mfma_f32_16x16x32_bf16 v[56:59], a[64:67], v[152:155], v[56:59]
    ds_read2_b32 v[126:127], v228 offset0:210 offset1:211
    v_mfma_f32_16x16x32_bf16 v[56:59], a[68:71], v[148:151], v[56:59]
    v_mfma_f32_16x16x32_bf16 v[56:59], a[72:75], v[144:147], v[56:59]
    v_mfma_f32_16x16x32_bf16 v[56:59], a[76:79], a[204:207], v[56:59]
    v_mfma_f32_16x16x32_bf16 v[56:59], v[80:83], a[200:203], v[56:59]
    v_mfma_f32_16x16x32_bf16 v[56:59], v[84:87], a[196:199], v[56:59]
    v_mfma_f32_16x16x32_bf16 v[56:59], v[88:91], a[192:195], v[56:59]
    v_mfma_f32_16x16x32_bf16 v[60:63], a[64:67], v[156:159], v[60:63]
    v_mfma_f32_16x16x32_bf16 v[60:63], a[68:71], v[152:155], v[60:63]
    v_mfma_f32_16x16x32_bf16 v[60:63], a[72:75], v[148:151], v[60:63]
    v_mfma_f32_16x16x32_bf16 v[60:63], a[76:79], v[144:147], v[60:63]
    buffer_load_dword v251, v224, s[8:11], s58 offen
    v_mfma_f32_16x16x32_bf16 v[60:63], v[80:83], a[204:207], v[60:63]
    s_add_u32 s58, s58, 458752
    v_mfma_f32_16x16x32_bf16 v[60:63], v[84:87], a[200:203], v[60:63]
    v_mfma_f32_16x16x32_bf16 v[60:63], v[88:91], a[196:199], v[60:63]
    v_mfma_f32_16x16x32_bf16 v[60:63], v[92:95], a[192:195], v[60:63]
    s_waitcnt lgkmcnt(0)
    v_mfma_f32_16x16x32_bf16 v[48:51], a[80:83], v[176:179], v[48:51]
    ds_read_b128 v[144:147], v26 offset:1920
    v_mfma_f32_16x16x32_bf16 v[48:51], a[84:87], a[220:223], v[48:51]
    ds_read_b128 v[148:151], v26 offset:1408
    v_mfma_f32_16x16x32_bf16 v[48:51], a[88:91], a[216:219], v[48:51]
    ds_read_b128 v[152:155], v26 offset:896
    v_mfma_f32_16x16x32_bf16 v[48:51], a[92:95], a[212:215], v[48:51]
    ds_read_b128 v[156:159], v26 offset:384
    v_mfma_f32_16x16x32_bf16 v[48:51], v[112:115], a[208:211], v[48:51]
    ds_read2_b32 v[80:81], v227 offset0:96 offset1:97
    v_mfma_f32_16x16x32_bf16 v[52:55], a[80:83], v[180:183], v[52:55]
    ds_read2_b32 v[82:83], v227 offset0:98 offset1:99
    v_mfma_f32_16x16x32_bf16 v[52:55], a[84:87], v[176:179], v[52:55]
    ds_read2_b32 v[84:85], v227 offset0:224 offset1:225
    v_mfma_f32_16x16x32_bf16 v[52:55], a[88:91], a[220:223], v[52:55]
    ds_read2_b32 v[86:87], v227 offset0:226 offset1:227
    v_mfma_f32_16x16x32_bf16 v[52:55], a[92:95], a[216:219], v[52:55]
    ds_read2_b32 v[88:89], v228 offset0:96 offset1:97
    v_mfma_f32_16x16x32_bf16 v[52:55], v[112:115], a[212:215], v[52:55]
    ds_read2_b32 v[90:91], v228 offset0:98 offset1:99
    v_mfma_f32_16x16x32_bf16 v[52:55], v[116:119], a[208:211], v[52:55]
    ds_read2_b32 v[92:93], v228 offset0:224 offset1:225
    v_mfma_f32_16x16x32_bf16 v[56:59], a[80:83], v[184:187], v[56:59]
    ds_read2_b32 v[94:95], v228 offset0:226 offset1:227
    v_mfma_f32_16x16x32_bf16 v[56:59], a[84:87], v[180:183], v[56:59]
    v_mfma_f32_16x16x32_bf16 v[56:59], a[88:91], v[176:179], v[56:59]
    v_mfma_f32_16x16x32_bf16 v[56:59], a[92:95], a[220:223], v[56:59]
    v_mfma_f32_16x16x32_bf16 v[56:59], v[112:115], a[216:219], v[56:59]
    v_mfma_f32_16x16x32_bf16 v[56:59], v[116:119], a[212:215], v[56:59]
    v_mfma_f32_16x16x32_bf16 v[56:59], v[120:123], a[208:211], v[56:59]
    v_mfma_f32_16x16x32_bf16 v[60:63], a[80:83], v[188:191], v[60:63]
    v_mfma_f32_16x16x32_bf16 v[60:63], a[84:87], v[184:187], v[60:63]
    v_mfma_f32_16x16x32_bf16 v[60:63], a[88:91], v[180:183], v[60:63]
    v_mfma_f32_16x16x32_bf16 v[60:63], a[92:95], v[176:179], v[60:63]
    v_mfma_f32_16x16x32_bf16 v[60:63], v[112:115], a[220:223], v[60:63]
    v_mfma_f32_16x16x32_bf16 v[60:63], v[116:119], a[216:219], v[60:63]
    v_mfma_f32_16x16x32_bf16 v[60:63], v[120:123], a[212:215], v[60:63]
    v_mfma_f32_16x16x32_bf16 v[60:63], v[124:127], a[208:211], v[60:63]
    s_waitcnt lgkmcnt(0)
    v_mfma_f32_16x16x32_bf16 v[48:51], a[96:99], v[144:147], v[48:51]
    ds_read_b128 v[176:179], v26 offset:1984
    v_mfma_f32_16x16x32_bf16 v[48:51], a[100:103], a[236:239], v[48:51]
    ds_read_b128 v[180:183], v26 offset:1472
    v_mfma_f32_16x16x32_bf16 v[48:51], a[104:107], a[232:235], v[48:51]
    ds_read_b128 v[184:187], v26 offset:960
    v_mfma_f32_16x16x32_bf16 v[48:51], a[108:111], a[228:231], v[48:51]
    ds_read_b128 v[188:191], v26 offset:448
    v_mfma_f32_16x16x32_bf16 v[48:51], v[80:83], a[224:227], v[48:51]
    ds_read2_b32 v[112:113], v227 offset0:112 offset1:113
    buffer_load_dword v251, v224, s[8:11], s58 offen
    v_mfma_f32_16x16x32_bf16 v[52:55], a[96:99], v[148:151], v[52:55]
    ds_read2_b32 v[114:115], v227 offset0:114 offset1:115
    s_add_u32 s58, s58, 458752
    v_mfma_f32_16x16x32_bf16 v[52:55], a[100:103], v[144:147], v[52:55]
    ds_read2_b32 v[116:117], v227 offset0:240 offset1:241
    v_mfma_f32_16x16x32_bf16 v[52:55], a[104:107], a[236:239], v[52:55]
    ds_read2_b32 v[118:119], v227 offset0:242 offset1:243
    v_mfma_f32_16x16x32_bf16 v[52:55], a[108:111], a[232:235], v[52:55]
    ds_read2_b32 v[120:121], v228 offset0:112 offset1:113
    v_mfma_f32_16x16x32_bf16 v[52:55], v[80:83], a[228:231], v[52:55]
    ds_read2_b32 v[122:123], v228 offset0:114 offset1:115
    v_mfma_f32_16x16x32_bf16 v[52:55], v[84:87], a[224:227], v[52:55]
    ds_read2_b32 v[124:125], v228 offset0:240 offset1:241
    v_mfma_f32_16x16x32_bf16 v[56:59], a[96:99], v[152:155], v[56:59]
    ds_read2_b32 v[126:127], v228 offset0:242 offset1:243
    v_mfma_f32_16x16x32_bf16 v[56:59], a[100:103], v[148:151], v[56:59]
    v_mfma_f32_16x16x32_bf16 v[56:59], a[104:107], v[144:147], v[56:59]
    v_mfma_f32_16x16x32_bf16 v[56:59], a[108:111], a[236:239], v[56:59]
    v_mfma_f32_16x16x32_bf16 v[56:59], v[80:83], a[232:235], v[56:59]
    buffer_load_dword v248, v249, s[88:91], 0 offen sc1
    v_mfma_f32_16x16x32_bf16 v[56:59], v[84:87], a[228:231], v[56:59]
    v_mfma_f32_16x16x32_bf16 v[56:59], v[88:91], a[224:227], v[56:59]
    v_mfma_f32_16x16x32_bf16 v[60:63], a[96:99], v[156:159], v[60:63]
    v_mfma_f32_16x16x32_bf16 v[60:63], a[100:103], v[152:155], v[60:63]
    v_mfma_f32_16x16x32_bf16 v[60:63], a[104:107], v[148:151], v[60:63]
    v_mfma_f32_16x16x32_bf16 v[60:63], a[108:111], v[144:147], v[60:63]
    v_mfma_f32_16x16x32_bf16 v[60:63], v[80:83], a[236:239], v[60:63]
    v_mfma_f32_16x16x32_bf16 v[60:63], v[84:87], a[232:235], v[60:63]
    v_mfma_f32_16x16x32_bf16 v[60:63], v[88:91], a[228:231], v[60:63]
    v_mfma_f32_16x16x32_bf16 v[60:63], v[92:95], a[224:227], v[60:63]
    s_waitcnt vmcnt(4) lgkmcnt(0)
    v_mfma_f32_16x16x32_bf16 v[48:51], a[112:115], v[176:179], v[48:51]
    s_barrier
    v_mfma_f32_16x16x32_bf16 v[48:51], a[116:119], a[252:255], v[48:51]
    buffer_store_dword v231, v230, s[12:15], s85 offen sc1
    v_mfma_f32_16x16x32_bf16 v[48:51], a[120:123], a[248:251], v[48:51]
    v_mfma_f32_16x16x32_bf16 v[48:51], a[124:127], a[244:247], v[48:51]
    v_mfma_f32_16x16x32_bf16 v[48:51], v[112:115], a[240:243], v[48:51]
    s_nop 1
    v_mfma_f32_16x16x32_bf16 v[52:55], a[112:115], v[180:183], v[52:55]
    s_nop 1
    v_mfma_f32_16x16x32_bf16 v[52:55], a[116:119], v[176:179], v[52:55]
    s_nop 1
    v_mfma_f32_16x16x32_bf16 v[52:55], a[120:123], a[252:255], v[52:55]
    v_cvt_pk_bf16_f32 v48, v48, v49
    v_cvt_pk_bf16_f32 v49, v50, v51
    v_mfma_f32_16x16x32_bf16 v[52:55], a[124:127], a[248:251], v[52:55]
    ds_write_b64 v212, v[48:49] offset:0
    v_mfma_f32_16x16x32_bf16 v[52:55], v[112:115], a[244:247], v[52:55]
    v_mfma_f32_16x16x32_bf16 v[52:55], v[116:119], a[240:243], v[52:55]
    s_nop 1
    v_mfma_f32_16x16x32_bf16 v[56:59], a[112:115], v[184:187], v[56:59]
    s_nop 1
    v_mfma_f32_16x16x32_bf16 v[56:59], a[116:119], v[180:183], v[56:59]
    s_nop 1
    v_mfma_f32_16x16x32_bf16 v[56:59], a[120:123], v[176:179], v[56:59]
    v_cvt_pk_bf16_f32 v52, v52, v53
    v_cvt_pk_bf16_f32 v53, v54, v55
    v_mfma_f32_16x16x32_bf16 v[56:59], a[124:127], a[252:255], v[56:59]
    ds_write_b64 v212, v[52:53] offset:640
    v_mfma_f32_16x16x32_bf16 v[56:59], v[112:115], a[248:251], v[56:59]
    v_mfma_f32_16x16x32_bf16 v[56:59], v[116:119], a[244:247], v[56:59]
    v_mfma_f32_16x16x32_bf16 v[56:59], v[120:123], a[240:243], v[56:59]
    s_nop 1
    v_mfma_f32_16x16x32_bf16 v[60:63], a[112:115], v[188:191], v[60:63]
    s_nop 1
    v_mfma_f32_16x16x32_bf16 v[60:63], a[116:119], v[184:187], v[60:63]
    s_nop 1
    v_mfma_f32_16x16x32_bf16 v[60:63], a[120:123], v[180:183], v[60:63]
    v_cvt_pk_bf16_f32 v56, v56, v57
    v_cvt_pk_bf16_f32 v57, v58, v59
    v_mfma_f32_16x16x32_bf16 v[60:63], a[124:127], v[176:179], v[60:63]
    ds_write_b64 v212, v[56:57] offset:1280
    v_mfma_f32_16x16x32_bf16 v[60:63], v[112:115], a[252:255], v[60:63]
    v_mfma_f32_16x16x32_bf16 v[60:63], v[116:119], a[248:251], v[60:63]
    v_mfma_f32_16x16x32_bf16 v[60:63], v[120:123], a[244:247], v[60:63]
    v_mfma_f32_16x16x32_bf16 v[60:63], v[124:127], a[240:243], v[60:63]
    s_nop 1
    s_nop 5
    v_cvt_pk_bf16_f32 v60, v60, v61
    v_cvt_pk_bf16_f32 v61, v62, v63
    ds_write_b64 v212, v[60:61] offset:1920
    s_add_u32 s63, s63, 1
    s_waitcnt lgkmcnt(0)
    s_barrier
    ds_read_b32 v64, v213 offset:0
    ds_read_b32 v65, v213 offset:33024
    ds_read_b32 v66, v229 offset:0
    ds_read_b32 v67, v229 offset:33024
    ds_read_b32 v68, v213 offset:64
    ds_read_b32 v69, v213 offset:33088
    ds_read_b32 v70, v229 offset:64
    ds_read_b32 v71, v229 offset:33088
    s_waitcnt lgkmcnt(4)
    v_perm_b32 v128, v65, v64, s38
    v_perm_b32 v129, v67, v66, s38
    v_perm_b32 v130, v65, v64, s39
    v_perm_b32 v131, v67, v66, s39
    buffer_store_dwordx4 v[128:131], v214, s[12:15], s57 offen sc1
    s_add_u32 s57, s57, 262144
    s_waitcnt lgkmcnt(0)
    v_perm_b32 v132, v69, v68, s38
    v_perm_b32 v133, v71, v70, s38
    v_perm_b32 v134, v69, v68, s39
    v_perm_b32 v135, v71, v70, s39
    buffer_store_dwordx4 v[132:135], v214, s[12:15], s57 offen sc1
    s_add_u32 s57, s57, 1835008
interleave_layers__ssm_conv_h3__glu_gated_bilinear__prompt_kernel_layer:
    v_lshrrev_b32 v1, 4, v2
    s_lshl_b32 s42, s3, 12
    s_lshl_b32 s40, s4, 19
    s_add_u32 s40, s40, s42
    s_add_u32 s40, s40, s7
    s_lshl_b32 s33, s45, 13
    v_add_u32 v8, s33, v3
    v_add_u32 v9, 66048, v8
    v_bfe_u32 v4, v2, 2, 2
    v_and_b32 v5, 1, v1
    v_lshl_or_b32 v5, v5, 2, v4
    v_lshl_add_u32 v6, v1, 3, v4
    v_lshlrev_b32 v6, 8, v6
    v_add_u32 v6, 16384, v6
    v_and_b32 v7, 3, v2
    v_lshl_add_u32 v1, v7, 3, v6
    s_lshl_b32 s33, s44, 2
    s_add_u32 s33, s33, s46
    s_add_u32 s34, s33, 0
    v_xor_b32 v4, s34, v5
    v_lshl_add_u32 v10, v4, 5, v1
    s_add_u32 s34, s33, 1
    v_xor_b32 v4, s34, v5
    v_lshl_add_u32 v11, v4, 5, v1
    s_add_u32 s34, s33, 2
    v_xor_b32 v4, s34, v5
    v_lshl_add_u32 v12, v4, 5, v1
    s_add_u32 s34, s46, 3
    v_xor_b32 v4, s34, v5
    v_lshl_add_u32 v6, v4, 5, v6
    v_and_b32 v4, 1, v7
    v_lshl_add_u32 v6, v4, 3, v6
    v_lshrrev_b32 v4, 1, v7
    v_mul_u32_u24 v4, 8208, v4
iw_f3:
    s_cbranch_execz iw_fret
    s_lshl_b32 s34, s44, 4
    v_add3_u32 v13, v6, v4, s34
    v_add_u32 v14, 66048, v10
    v_add_u32 v15, 66048, v11
    v_add_u32 v16, 66048, v12
    v_add_u32 v17, 66048, v13
    s_sub_u32 s34, s6, 1
    s_add_u32 s35, s5, 1
    s_bfe_u32 s35, s35, 0x10001
    s_sub_u32 s35, s35, 1
    s_and_b32 s34, s34, s35
    s_bfe_u32 s36, s2, 0x20003
    s_bfe_u32 s35, s2, 0x20006
    s_lshl_b32 s35, s35, 2
    s_add_u32 s36, s36, s35
    s_lshl_b32 s33, s36, 1
    s_add_u32 s33, s33, s44
    s_lshl_b32 s33, s33, 1
    s_and_b32 s35, s2, 1
    s_add_u32 s33, s33, s35
    s_mul_i32 s33, s33, 14336
    s_lshr_b32 s35, s5, 3
    s_mul_i32 s35, s35, 1792
    s_add_u32 s33, s33, s35
    s_add_u32 s33, s33, 2293760
    v_lshlrev_b32 v4, 7, v2
    v_cmp_lt_u32 vcc, 13, v2
    v_add_u32 v5, s33, v4
    v_add_u32 v6, 5376, v5
    v_cndmask_b32 v5, v5, v6, vcc
    s_and_b32 s33, s34, 28
    v_cmp_gt_u32 vcc, s33, v2
    v_bfrev_b32 v6, 1
    s_nop 0
    v_cndmask_b32 v18, v6, v5, vcc
    v_and_b32 v4, 7, v2
    v_lshrrev_b32 v5, 3, v2
    v_lshlrev_b32 v6, 8, v5
    v_lshl_add_u32 v24, v4, 4, v6
    v_lshl_add_u32 v1, v4, 3, v6
    v_and_b32 v6, 0x3ff, v24
    v_lshrrev_b32 v7, 2, v5
    v_lshl_add_u32 v25, v7, 14, v6
    v_lshlrev_b32 v27, 4, v4
    v_add_u32 v27, 132096, v27
    s_lshl_b32 s33, s3, 2
    v_lshl_add_u32 v26, v7, 7, v27
    v_add_u32 v26, s33, v26
    s_lshr_b32 s33, s60, 1
    s_lshl_b32 s33, s33, 15
    s_lshl_b32 s34, s3, 13
    s_add_u32 s33, s33, s34
    s_and_b32 s34, s60, 1
    s_lshl_b32 s35, s34, 6
    s_add_u32 s33, s33, s35
    s_add_u32 s36, s33, s35
    s_add_u32 s33, s33, 4194304
    s_lshl_b32 s37, s4, 19
    s_lshl_b32 s35, s3, 17
    s_add_u32 s37, s37, s35
    s_bfe_u32 s35, s60, 0x40001
    s_lshl_b32 s35, s35, 10
    s_add_u32 s37, s37, s35
    s_lshl_b32 s35, s34, 7
    s_add_u32 s37, s37, s35
    s_add_u32 s37, s37, s7
    s_cmp_lg_u32 s6, 0
    s_cbranch_scc1 interl_ln111
    v_lshlrev_b32 v32, 16, v232
    v_and_b32 v33, s61, v232
    v_lshlrev_b32 v34, 16, v233
    v_and_b32 v35, s61, v233
    v_lshlrev_b32 v36, 16, v234
    v_and_b32 v37, s61, v234
    v_lshlrev_b32 v38, 16, v235
    v_and_b32 v39, s61, v235
    v_lshlrev_b32 v40, 16, v236
    v_and_b32 v41, s61, v236
    v_lshlrev_b32 v42, 16, v237
    v_and_b32 v43, s61, v237
    v_lshlrev_b32 v44, 16, v238
    v_and_b32 v45, s61, v238
    v_lshlrev_b32 v46, 16, v239
    v_and_b32 v47, s61, v239
    v_lshlrev_b32 v48, 16, v240
    v_and_b32 v49, s61, v240
    v_lshlrev_b32 v50, 16, v241
    v_and_b32 v51, s61, v241
    v_lshlrev_b32 v52, 16, v242
    v_and_b32 v53, s61, v242
    v_lshlrev_b32 v54, 16, v243
    v_and_b32 v55, s61, v243
    v_lshlrev_b32 v56, 16, v244
    v_and_b32 v57, s61, v244
    v_lshlrev_b32 v58, 16, v245
    v_and_b32 v59, s61, v245
    v_lshlrev_b32 v60, 16, v246
    v_and_b32 v61, s61, v246
    v_lshlrev_b32 v62, 16, v247
    v_and_b32 v63, s61, v247
    s_add_u32 s63, s63, 1
    v_mov_b32 v4, 0
    v_mov_b32 v5, s63
    s_cmp_lg_u32 s3, 0
    s_waitcnt vmcnt(0)
    s_barrier
    s_cbranch_scc1 interl_sig14
    s_mov_b64 exec, 1
    buffer_store_dword v5, v4, s[12:15], s94 offen sc1
    s_mov_b64 exec, -1
interl_sig14:
    s_add_u32 m0, s43, 0
    s_nop 0
    buffer_load_dwordx4 v19, s[8:11], s41 offen offset:0 lds
    buffer_load_dwordx4 v20, s[8:11], s41 offen offset:1024 lds
    buffer_load_dwordx4 v21, s[8:11], s41 offen offset:2048 lds
    buffer_load_dwordx4 v22, s[8:11], s41 offen offset:3072 lds
    s_add_u32 s41, s41, 229376
    v_pk_add_f32 v[28:29], v[32:33], v[34:35]
    v_pk_mul_f32 v[6:7], v[32:33], v[32:33]
    v_pk_fma_f32 v[6:7], v[34:35], v[34:35], v[6:7]
    v_pk_add_f32 v[28:29], v[28:29], v[36:37]
    v_pk_fma_f32 v[6:7], v[36:37], v[36:37], v[6:7]
    v_pk_add_f32 v[28:29], v[28:29], v[38:39]
    s_add_u32 m0, s43, 33024
    s_nop 0
    buffer_load_dwordx4 v19, s[8:11], s41 offen offset:0 lds
    v_pk_fma_f32 v[6:7], v[38:39], v[38:39], v[6:7]
    v_pk_add_f32 v[28:29], v[28:29], v[40:41]
    v_pk_fma_f32 v[6:7], v[40:41], v[40:41], v[6:7]
    v_pk_add_f32 v[28:29], v[28:29], v[42:43]
    v_pk_fma_f32 v[6:7], v[42:43], v[42:43], v[6:7]
    v_pk_add_f32 v[28:29], v[28:29], v[44:45]
    buffer_load_dwordx4 v20, s[8:11], s41 offen offset:1024 lds
    v_pk_fma_f32 v[6:7], v[44:45], v[44:45], v[6:7]
    v_pk_add_f32 v[28:29], v[28:29], v[46:47]
    v_pk_fma_f32 v[6:7], v[46:47], v[46:47], v[6:7]
    v_pk_add_f32 v[28:29], v[28:29], v[48:49]
    v_pk_fma_f32 v[6:7], v[48:49], v[48:49], v[6:7]
    v_pk_add_f32 v[28:29], v[28:29], v[50:51]
    buffer_load_dwordx4 v21, s[8:11], s41 offen offset:2048 lds
    v_pk_fma_f32 v[6:7], v[50:51], v[50:51], v[6:7]
    v_pk_add_f32 v[28:29], v[28:29], v[52:53]
    v_pk_fma_f32 v[6:7], v[52:53], v[52:53], v[6:7]
    v_pk_add_f32 v[28:29], v[28:29], v[54:55]
    v_pk_fma_f32 v[6:7], v[54:55], v[54:55], v[6:7]
    v_pk_add_f32 v[28:29], v[28:29], v[56:57]
    buffer_load_dwordx4 v22, s[8:11], s41 offen offset:3072 lds
    s_add_u32 s41, s41, 229376
    v_pk_fma_f32 v[6:7], v[56:57], v[56:57], v[6:7]
    v_pk_add_f32 v[28:29], v[28:29], v[58:59]
    v_pk_fma_f32 v[6:7], v[58:59], v[58:59], v[6:7]
    v_pk_add_f32 v[28:29], v[28:29], v[60:61]
    v_pk_fma_f32 v[6:7], v[60:61], v[60:61], v[6:7]
    v_pk_add_f32 v[28:29], v[28:29], v[62:63]
    s_add_u32 m0, s43, 66048
    s_nop 0
    buffer_load_dwordx4 v19, s[8:11], s41 offen offset:0 lds
    v_pk_fma_f32 v[6:7], v[62:63], v[62:63], v[6:7]
    v_add_f32 v28, v28, v29
    v_add_f32 v29, v6, v7
    s_nop 1
    v_permlane32_swap_b32 v28, v29
    v_add_f32 v28, v28, v29
    buffer_load_dwordx4 v20, s[8:11], s41 offen offset:1024 lds
    v_mov_b32 v29, v28
    s_nop 1
    v_permlane16_swap_b32 v28, v29
    v_add_f32 v28, v28, v29
    s_nop 1
    v_add_f32_dpp v28, v28, v28 row_ror:8 row_mask:0xf bank_mask:0xf
    buffer_load_dwordx4 v21, s[8:11], s41 offen offset:2048 lds
    ds_write_b32 v26, v28 offset:0
    s_waitcnt lgkmcnt(0)
    s_barrier
    ds_read_b128 v[4:7], v27 offset:0
    ds_read_b128 v[144:147], v27 offset:128
    s_waitcnt lgkmcnt(1)
    buffer_load_dwordx4 v22, s[8:11], s41 offen offset:3072 lds
    s_add_u32 s41, s41, 229376
    v_pk_add_f32 v[4:5], v[4:5], v[6:7]
    v_add_f32 v29, v4, v5
    v_mul_f32 v29, 0x3a800000, v29
    s_waitcnt lgkmcnt(0)
    v_pk_add_f32 v[6:7], v[144:145], v[146:147]
    v_add_f32 v28, v6, v7
    s_add_u32 m0, s43, 99072
    s_nop 0
    buffer_load_dwordx4 v19, s[8:11], s41 offen offset:0 lds
    v_mul_f32 v28, 0x3a800000, v28
    v_fma_f32 v28, -v29, v29, v28
    v_max_f32 v28, 0, v28
    v_add_f32 v28, 0x3727c5ac, v28
    v_rsq_f32 v28, v28
    s_nop 0
    buffer_load_dwordx4 v20, s[8:11], s41 offen offset:1024 lds
    v_mul_f32 v29, -v29, v28
    v_pk_fma_f32 v[160:161], v[32:33], v[28:29], v[28:29] op_sel:[0,0,1] op_sel_hi:[1,0,1]
    v_pk_fma_f32 v[162:163], v[34:35], v[28:29], v[28:29] op_sel:[0,0,1] op_sel_hi:[1,0,1]
    v_pk_fma_f32 v[164:165], v[36:37], v[28:29], v[28:29] op_sel:[0,0,1] op_sel_hi:[1,0,1]
    v_pk_fma_f32 v[166:167], v[38:39], v[28:29], v[28:29] op_sel:[0,0,1] op_sel_hi:[1,0,1]
    v_pk_fma_f32 v[168:169], v[40:41], v[28:29], v[28:29] op_sel:[0,0,1] op_sel_hi:[1,0,1]
    buffer_load_dwordx4 v21, s[8:11], s41 offen offset:2048 lds
    v_pk_fma_f32 v[170:171], v[42:43], v[28:29], v[28:29] op_sel:[0,0,1] op_sel_hi:[1,0,1]
    v_pk_fma_f32 v[172:173], v[44:45], v[28:29], v[28:29] op_sel:[0,0,1] op_sel_hi:[1,0,1]
    v_pk_fma_f32 v[174:175], v[46:47], v[28:29], v[28:29] op_sel:[0,0,1] op_sel_hi:[1,0,1]
    v_pk_fma_f32 v[176:177], v[48:49], v[28:29], v[28:29] op_sel:[0,0,1] op_sel_hi:[1,0,1]
    v_pk_fma_f32 v[178:179], v[50:51], v[28:29], v[28:29] op_sel:[0,0,1] op_sel_hi:[1,0,1]
    v_pk_fma_f32 v[180:181], v[52:53], v[28:29], v[28:29] op_sel:[0,0,1] op_sel_hi:[1,0,1]
    buffer_load_dwordx4 v22, s[8:11], s41 offen offset:3072 lds
    s_add_u32 s41, s41, 229376
    v_pk_fma_f32 v[182:183], v[54:55], v[28:29], v[28:29] op_sel:[0,0,1] op_sel_hi:[1,0,1]
    v_pk_fma_f32 v[184:185], v[56:57], v[28:29], v[28:29] op_sel:[0,0,1] op_sel_hi:[1,0,1]
    v_pk_fma_f32 v[186:187], v[58:59], v[28:29], v[28:29] op_sel:[0,0,1] op_sel_hi:[1,0,1]
    v_pk_fma_f32 v[188:189], v[60:61], v[28:29], v[28:29] op_sel:[0,0,1] op_sel_hi:[1,0,1]
    v_pk_fma_f32 v[190:191], v[62:63], v[28:29], v[28:29] op_sel:[0,0,1] op_sel_hi:[1,0,1]
    s_waitcnt lgkmcnt(0)
    s_branch interl_lns215
.p2align 12
iw_base:
interl_ln111:
iw_c0:
    s_cbranch_execz iw_c3
    v_accvgpr_read_b32 v128, a224
    v_accvgpr_read_b32 v129, a225
    v_accvgpr_read_b32 v130, a226
    v_accvgpr_read_b32 v131, a227
    v_accvgpr_read_b32 v132, a228
    v_accvgpr_read_b32 v133, a229
    v_accvgpr_read_b32 v134, a230
    v_accvgpr_read_b32 v135, a231
    v_accvgpr_read_b32 v136, a232
    v_accvgpr_read_b32 v137, a233
    v_accvgpr_read_b32 v138, a234
    v_accvgpr_read_b32 v139, a235
    v_accvgpr_read_b32 v140, a236
    v_accvgpr_read_b32 v141, a237
    v_accvgpr_read_b32 v142, a238
    v_accvgpr_read_b32 v143, a239
    v_lshlrev_b32 v32, 16, v128
    v_and_b32 v33, s61, v128
    v_lshlrev_b32 v34, 16, v129
    v_and_b32 v35, s61, v129
    v_lshlrev_b32 v36, 16, v130
    v_and_b32 v37, s61, v130
    v_lshlrev_b32 v38, 16, v131
    v_and_b32 v39, s61, v131
    v_lshlrev_b32 v40, 16, v132
    v_and_b32 v41, s61, v132
    v_lshlrev_b32 v42, 16, v133
    v_and_b32 v43, s61, v133
    v_lshlrev_b32 v44, 16, v134
    v_and_b32 v45, s61, v134
    v_lshlrev_b32 v46, 16, v135
    v_and_b32 v47, s61, v135
    v_lshlrev_b32 v48, 16, v136
    v_and_b32 v49, s61, v136
    v_lshlrev_b32 v50, 16, v137
    v_and_b32 v51, s61, v137
    v_lshlrev_b32 v52, 16, v138
    v_and_b32 v53, s61, v138
    v_lshlrev_b32 v54, 16, v139
    v_and_b32 v55, s61, v139
    v_lshlrev_b32 v56, 16, v140
    v_and_b32 v57, s61, v140
    v_lshlrev_b32 v58, 16, v141
    v_and_b32 v59, s61, v141
    v_lshlrev_b32 v60, 16, v142
    v_and_b32 v61, s61, v142
    v_lshlrev_b32 v62, 16, v143
    v_and_b32 v63, s61, v143
    s_bfe_u32 s39, s60, 0x10001
    s_xor_b32 s39, s39, 1
    s_lshl_b32 s38, s39, 22
    s_add_u32 s38, s38, s36
    s_xor_b32 s50, s38, 4194304
    s_add_u32 s38, s38, 23068672
    s_add_u32 s50, s50, 23068672
    s_lshl_b32 s39, s39, 4
    s_and_b32 s34, s5, 8
    s_add_u32 s39, s39, s34
    s_mov_b32 s51, s63
    s_mov_b32 s34, 0x3f80
    s_mov_b32 s35, 0x3f800000
    s_add_u32 s63, s63, 1
    v_mov_b32 v4, 0
    v_mov_b32 v5, s63
    s_cmp_lg_u32 s3, 0
    s_waitcnt vmcnt(0)
    s_barrier
    s_cbranch_scc1 interl_sig16
    s_mov_b64 exec, 1
    buffer_store_dword v5, v4, s[12:15], s94 offen sc1
    s_mov_b64 exec, -1
interl_sig16:
    s_mov_b32 s41, s92
    s_add_u32 m0, s43, 0
    s_nop 0
    buffer_load_dwordx4 v19, s[8:11], s41 offen offset:0 lds
    buffer_load_dwordx4 v20, s[8:11], s41 offen offset:1024 lds
    buffer_load_dwordx4 v21, s[8:11], s41 offen offset:2048 lds
    buffer_load_dwordx4 v22, s[8:11], s41 offen offset:3072 lds
    s_add_u32 s41, s41, 229376
    s_add_u32 m0, s43, 33024
    s_nop 0
    buffer_load_dwordx4 v19, s[8:11], s41 offen offset:0 lds
    buffer_load_dwordx4 v20, s[8:11], s41 offen offset:1024 lds
    buffer_load_dwordx4 v21, s[8:11], s41 offen offset:2048 lds
    buffer_load_dwordx4 v22, s[8:11], s41 offen offset:3072 lds
    s_add_u32 s41, s41, 229376
    s_add_u32 s41, s92, 917504
    v_accvgpr_read_b32 v128, a240
    v_accvgpr_read_b32 v129, a241
    v_accvgpr_read_b32 v130, a242
    v_accvgpr_read_b32 v131, a243
    v_accvgpr_read_b32 v132, a244
    v_accvgpr_read_b32 v133, a245
    v_accvgpr_read_b32 v134, a246
    v_accvgpr_read_b32 v135, a247
    v_accvgpr_read_b32 v136, a248
    v_accvgpr_read_b32 v137, a249
    v_accvgpr_read_b32 v138, a250
    v_accvgpr_read_b32 v139, a251
    v_accvgpr_read_b32 v140, a252
    v_accvgpr_read_b32 v141, a253
    v_accvgpr_read_b32 v142, a254
    v_accvgpr_read_b32 v143, a255
    v_lshlrev_b32 v64, 16, v128
    v_and_b32 v65, s61, v128
    v_lshlrev_b32 v66, 16, v129
    v_and_b32 v67, s61, v129
    v_lshlrev_b32 v68, 16, v130
    v_and_b32 v69, s61, v130
    v_lshlrev_b32 v70, 16, v131
    v_and_b32 v71, s61, v131
    v_lshlrev_b32 v72, 16, v132
    v_and_b32 v73, s61, v132
    v_lshlrev_b32 v74, 16, v133
    v_and_b32 v75, s61, v133
    v_lshlrev_b32 v76, 16, v134
    v_and_b32 v77, s61, v134
    v_lshlrev_b32 v78, 16, v135
    v_and_b32 v79, s61, v135
    v_lshlrev_b32 v80, 16, v136
    v_and_b32 v81, s61, v136
    v_lshlrev_b32 v82, 16, v137
    v_and_b32 v83, s61, v137
    v_lshlrev_b32 v84, 16, v138
    v_and_b32 v85, s61, v138
    v_lshlrev_b32 v86, 16, v139
    v_and_b32 v87, s61, v139
    v_lshlrev_b32 v88, 16, v140
    v_and_b32 v89, s61, v140
    v_lshlrev_b32 v90, 16, v141
    v_and_b32 v91, s61, v141
    v_lshlrev_b32 v92, 16, v142
    v_and_b32 v93, s61, v142
    v_lshlrev_b32 v94, 16, v143
    v_and_b32 v95, s61, v143
    s_cmp_lg_u32 s3, 0
    s_cbranch_scc1 interl_wt17
    s_and_b32 s62, s5, 8
    s_lshl_b32 exec_lo, 0x00ff00ff, s62
    s_mov_b32 exec_hi, 0
    s_mov_b32 s62, 4000000
interl_poll18:
    buffer_load_dword v7, v0, s[12:15], s95 offen sc1
    s_sub_u32 s62, s62, 1
    s_cbranch_scc1 interl_pd19
    s_waitcnt vmcnt(0)
    v_cmp_gt_u32 vcc, s63, v7
    s_cbranch_vccnz interl_poll18
interl_pd19:
    s_mov_b64 exec, -1
interl_wt17:
    s_barrier
    buffer_load_dwordx4 v[96:99], v24, s[12:15], s38 offen offset:0 sc1
    buffer_load_dwordx4 v[100:103], v24, s[12:15], s38 offen offset:2048 sc1
    s_add_u32 s38, s38, 4096
    buffer_load_dwordx4 v[104:107], v24, s[12:15], s38 offen offset:0 sc1
    buffer_load_dwordx4 v[108:111], v24, s[12:15], s38 offen offset:2048 sc1
    buffer_load_dwordx4 v[112:115], v24, s[12:15], s50 offen offset:0 sc1
    buffer_load_dwordx4 v[116:119], v24, s[12:15], s50 offen offset:2048 sc1
    s_add_u32 s50, s50, 4096
    buffer_load_dwordx4 v[120:123], v24, s[12:15], s50 offen offset:0 sc1
    buffer_load_dwordx4 v[124:127], v24, s[12:15], s50 offen offset:2048 sc1
    s_waitcnt vmcnt(7)
    v_dot2_f32_bf16 v32, v96, s34, v32
    v_dot2_f32_bf16 v33, v96, s35, v33
    v_dot2_f32_bf16 v34, v97, s34, v34
    v_dot2_f32_bf16 v35, v97, s35, v35
    v_dot2_f32_bf16 v36, v98, s34, v36
    v_dot2_f32_bf16 v37, v98, s35, v37
    v_dot2_f32_bf16 v38, v99, s34, v38
    v_dot2_f32_bf16 v39, v99, s35, v39
    s_waitcnt vmcnt(6)
    v_dot2_f32_bf16 v40, v100, s34, v40
    v_dot2_f32_bf16 v41, v100, s35, v41
    v_dot2_f32_bf16 v42, v101, s34, v42
    v_dot2_f32_bf16 v43, v101, s35, v43
    v_dot2_f32_bf16 v44, v102, s34, v44
    v_dot2_f32_bf16 v45, v102, s35, v45
    v_dot2_f32_bf16 v46, v103, s34, v46
    v_dot2_f32_bf16 v47, v103, s35, v47
iw_d0:
    s_cbranch_execz iw_d3
    s_waitcnt vmcnt(5)
    v_dot2_f32_bf16 v48, v104, s34, v48
    v_dot2_f32_bf16 v49, v104, s35, v49
    v_dot2_f32_bf16 v50, v105, s34, v50
    v_dot2_f32_bf16 v51, v105, s35, v51
    v_dot2_f32_bf16 v52, v106, s34, v52
    v_dot2_f32_bf16 v53, v106, s35, v53
    v_dot2_f32_bf16 v54, v107, s34, v54
    v_dot2_f32_bf16 v55, v107, s35, v55
    s_waitcnt vmcnt(4)
    v_dot2_f32_bf16 v56, v108, s34, v56
    v_dot2_f32_bf16 v57, v108, s35, v57
    v_dot2_f32_bf16 v58, v109, s34, v58
    v_dot2_f32_bf16 v59, v109, s35, v59
    v_dot2_f32_bf16 v60, v110, s34, v60
    v_dot2_f32_bf16 v61, v110, s35, v61
    v_dot2_f32_bf16 v62, v111, s34, v62
    v_dot2_f32_bf16 v63, v111, s35, v63
    s_waitcnt vmcnt(3)
    v_dot2_f32_bf16 v32, v112, s34, v32
    v_dot2_f32_bf16 v33, v112, s35, v33
    v_dot2_f32_bf16 v34, v113, s34, v34
    v_dot2_f32_bf16 v35, v113, s35, v35
    v_dot2_f32_bf16 v36, v114, s34, v36
    v_dot2_f32_bf16 v37, v114, s35, v37
    v_dot2_f32_bf16 v38, v115, s34, v38
    v_dot2_f32_bf16 v39, v115, s35, v39
    s_waitcnt vmcnt(2)
    v_dot2_f32_bf16 v40, v116, s34, v40
    v_dot2_f32_bf16 v41, v116, s35, v41
    v_dot2_f32_bf16 v42, v117, s34, v42
    v_dot2_f32_bf16 v43, v117, s35, v43
    v_dot2_f32_bf16 v44, v118, s34, v44
    v_dot2_f32_bf16 v45, v118, s35, v45
    v_dot2_f32_bf16 v46, v119, s34, v46
    v_dot2_f32_bf16 v47, v119, s35, v47
    s_waitcnt vmcnt(1)
    v_dot2_f32_bf16 v48, v120, s34, v48
    v_dot2_f32_bf16 v49, v120, s35, v49
    v_dot2_f32_bf16 v50, v121, s34, v50
    v_dot2_f32_bf16 v51, v121, s35, v51
    v_dot2_f32_bf16 v52, v122, s34, v52
    v_dot2_f32_bf16 v53, v122, s35, v53
    v_dot2_f32_bf16 v54, v123, s34, v54
    v_dot2_f32_bf16 v55, v123, s35, v55
    s_waitcnt vmcnt(0)
    v_dot2_f32_bf16 v56, v124, s34, v56
    v_dot2_f32_bf16 v57, v124, s35, v57
    v_dot2_f32_bf16 v58, v125, s34, v58
    v_dot2_f32_bf16 v59, v125, s35, v59
    v_dot2_f32_bf16 v60, v126, s34, v60
    v_dot2_f32_bf16 v61, v126, s35, v61
    v_dot2_f32_bf16 v62, v127, s34, v62
    v_dot2_f32_bf16 v63, v127, s35, v63
interl_lnst12:
    v_pk_add_f32 v[28:29], v[32:33], v[34:35]
    v_pk_mul_f32 v[6:7], v[32:33], v[32:33]
    v_pk_fma_f32 v[6:7], v[34:35], v[34:35], v[6:7]
    v_pk_add_f32 v[28:29], v[28:29], v[36:37]
    v_pk_fma_f32 v[6:7], v[36:37], v[36:37], v[6:7]
    v_pk_add_f32 v[28:29], v[28:29], v[38:39]
    v_pk_fma_f32 v[6:7], v[38:39], v[38:39], v[6:7]
    v_pk_add_f32 v[28:29], v[28:29], v[40:41]
    v_pk_fma_f32 v[6:7], v[40:41], v[40:41], v[6:7]
    v_pk_add_f32 v[28:29], v[28:29], v[42:43]
    v_pk_fma_f32 v[6:7], v[42:43], v[42:43], v[6:7]
    v_pk_add_f32 v[28:29], v[28:29], v[44:45]
    v_pk_fma_f32 v[6:7], v[44:45], v[44:45], v[6:7]
    v_pk_add_f32 v[28:29], v[28:29], v[46:47]
    v_pk_fma_f32 v[6:7], v[46:47], v[46:47], v[6:7]
    v_pk_add_f32 v[28:29], v[28:29], v[48:49]
    v_pk_fma_f32 v[6:7], v[48:49], v[48:49], v[6:7]
    v_pk_add_f32 v[28:29], v[28:29], v[50:51]
    v_pk_fma_f32 v[6:7], v[50:51], v[50:51], v[6:7]
    v_pk_add_f32 v[28:29], v[28:29], v[52:53]
    v_pk_fma_f32 v[6:7], v[52:53], v[52:53], v[6:7]
    v_pk_add_f32 v[28:29], v[28:29], v[54:55]
    v_pk_fma_f32 v[6:7], v[54:55], v[54:55], v[6:7]
    v_pk_add_f32 v[28:29], v[28:29], v[56:57]
    v_pk_fma_f32 v[6:7], v[56:57], v[56:57], v[6:7]
    v_pk_add_f32 v[28:29], v[28:29], v[58:59]
    v_pk_fma_f32 v[6:7], v[58:59], v[58:59], v[6:7]
    v_pk_add_f32 v[28:29], v[28:29], v[60:61]
    v_pk_fma_f32 v[6:7], v[60:61], v[60:61], v[6:7]
    v_pk_add_f32 v[28:29], v[28:29], v[62:63]
    v_pk_fma_f32 v[6:7], v[62:63], v[62:63], v[6:7]
    v_add_f32 v28, v28, v29
    v_add_f32 v29, v6, v7
    s_nop 1
    v_permlane32_swap_b32 v28, v29
    v_add_f32 v28, v28, v29
    v_mov_b32 v29, v28
    s_nop 1
    v_permlane16_swap_b32 v28, v29
    v_add_f32 v28, v28, v29
    s_nop 1
    v_add_f32_dpp v28, v28, v28 row_ror:8 row_mask:0xf bank_mask:0xf
    ds_write_b32 v26, v28 offset:0
    s_waitcnt lgkmcnt(0)
    s_barrier
    ds_read_b128 v[4:7], v27 offset:0
    ds_read_b128 v[144:147], v27 offset:128
    s_waitcnt lgkmcnt(1)
    v_pk_add_f32 v[4:5], v[4:5], v[6:7]
    v_add_f32 v29, v4, v5
    v_mul_f32 v29, 0x3a800000, v29
    s_waitcnt lgkmcnt(0)
    v_pk_add_f32 v[6:7], v[144:145], v[146:147]
    v_add_f32 v28, v6, v7
    v_mul_f32 v28, 0x3a800000, v28
    v_fma_f32 v28, -v29, v29, v28
    v_max_f32 v28, 0, v28
    v_add_f32 v28, 0x3727c5ac, v28
    v_rsq_f32 v28, v28
    s_nop 0
    v_mul_f32 v29, -v29, v28
    v_pk_fma_f32 v[160:161], v[32:33], v[28:29], v[28:29] op_sel:[0,0,1] op_sel_hi:[1,0,1]
    v_pk_fma_f32 v[162:163], v[34:35], v[28:29], v[28:29] op_sel:[0,0,1] op_sel_hi:[1,0,1]
    v_pk_fma_f32 v[164:165], v[36:37], v[28:29], v[28:29] op_sel:[0,0,1] op_sel_hi:[1,0,1]
    v_pk_fma_f32 v[166:167], v[38:39], v[28:29], v[28:29] op_sel:[0,0,1] op_sel_hi:[1,0,1]
    v_pk_fma_f32 v[168:169], v[40:41], v[28:29], v[28:29] op_sel:[0,0,1] op_sel_hi:[1,0,1]
    v_pk_fma_f32 v[170:171], v[42:43], v[28:29], v[28:29] op_sel:[0,0,1] op_sel_hi:[1,0,1]
    v_pk_fma_f32 v[172:173], v[44:45], v[28:29], v[28:29] op_sel:[0,0,1] op_sel_hi:[1,0,1]
    v_pk_fma_f32 v[174:175], v[46:47], v[28:29], v[28:29] op_sel:[0,0,1] op_sel_hi:[1,0,1]
    v_pk_fma_f32 v[176:177], v[48:49], v[28:29], v[28:29] op_sel:[0,0,1] op_sel_hi:[1,0,1]
    v_pk_fma_f32 v[178:179], v[50:51], v[28:29], v[28:29] op_sel:[0,0,1] op_sel_hi:[1,0,1]
    v_pk_fma_f32 v[180:181], v[52:53], v[28:29], v[28:29] op_sel:[0,0,1] op_sel_hi:[1,0,1]
    v_pk_fma_f32 v[182:183], v[54:55], v[28:29], v[28:29] op_sel:[0,0,1] op_sel_hi:[1,0,1]
    v_pk_fma_f32 v[184:185], v[56:57], v[28:29], v[28:29] op_sel:[0,0,1] op_sel_hi:[1,0,1]
    v_pk_fma_f32 v[186:187], v[58:59], v[28:29], v[28:29] op_sel:[0,0,1] op_sel_hi:[1,0,1]
    v_pk_fma_f32 v[188:189], v[60:61], v[28:29], v[28:29] op_sel:[0,0,1] op_sel_hi:[1,0,1]
    v_pk_fma_f32 v[190:191], v[62:63], v[28:29], v[28:29] op_sel:[0,0,1] op_sel_hi:[1,0,1]
    s_cmp_lg_u32 s6, 0
    s_cbranch_scc1 interl_lncm13
interl_lns215:
    s_cmp_lt_u32 s4, 4
    s_cbranch_scc1 interl_lny21
    s_lshl_b32 s51, s3, 13
    v_lshl_add_u32 v250, v2, 7, s51
    v_cmp_eq_u32 vcc, 0, v248
    s_cbranch_vccz interl_boot20
    s_mov_b32 s62, 4000000
interl_poll23:
    buffer_load_dword v7, v249, s[88:91], 0 offen sc1
    s_sub_u32 s62, s62, 1
    s_cbranch_scc1 interl_pd24
    s_waitcnt vmcnt(0)
    v_cmp_gt_u32 vcc, 1, v7
iw_c1:
    s_cbranch_execz iw_c4
    s_cbranch_vccnz interl_poll23
interl_pd24:
    s_mov_b64 exec, -1
interl_boot20:
    s_mov_b32 s62, 4000000
interl_poll25:
    buffer_load_dword v7, v250, s[12:15], s95 offen sc1
    s_sub_u32 s62, s62, 1
    s_cbranch_scc1 interl_pd26
    s_waitcnt vmcnt(0)
    v_cmp_gt_u32 vcc, 3, v7
    s_cbranch_vccnz interl_poll25
interl_pd26:
    s_mov_b64 exec, -1
    s_branch interl_lnz22
interl_lny21:
    s_cmp_lg_u32 s3, 0
    s_cbranch_scc1 interl_lnz22
    v_cmp_eq_u32 vcc, 0, v248
    s_cbranch_vccz interl_boot27
    s_mov_b32 s62, 4000000
interl_poll28:
    buffer_load_dword v7, v249, s[88:91], 0 offen sc1
    s_sub_u32 s62, s62, 1
    s_cbranch_scc1 interl_pd29
    s_waitcnt vmcnt(0)
    v_cmp_gt_u32 vcc, 1, v7
    s_cbranch_vccnz interl_poll28
interl_pd29:
    s_mov_b64 exec, -1
interl_boot27:
    s_mov_b32 s62, 4000000
interl_poll30:
    buffer_load_dwordx4 v[4:7], v250, s[12:15], s95 offen sc1
    s_sub_u32 s62, s62, 1
    s_cbranch_scc1 interl_pd31
    s_waitcnt vmcnt(0)
    v_min3_u32 v7, v5, v6, v7
    v_min_u32 v7, v4, v7
    v_cmp_gt_u32 vcc, 2, v7
    s_cbranch_vccnz interl_poll30
interl_pd31:
    s_mov_b64 exec, -1
interl_lnz22:
    s_barrier
    buffer_load_dwordx2 v[96:97], v1, s[12:15], s33 offen offset:0 sc1
    buffer_load_dwordx2 v[98:99], v1, s[12:15], s33 offen offset:128 sc1
    buffer_load_dwordx2 v[100:101], v1, s[12:15], s33 offen offset:2048 sc1
    buffer_load_dwordx2 v[102:103], v1, s[12:15], s33 offen offset:2176 sc1
    s_add_u32 s33, s33, 4096
    buffer_load_dwordx2 v[104:105], v1, s[12:15], s33 offen offset:0 sc1
    buffer_load_dwordx2 v[106:107], v1, s[12:15], s33 offen offset:128 sc1
    buffer_load_dwordx2 v[108:109], v1, s[12:15], s33 offen offset:2048 sc1
    buffer_load_dwordx2 v[110:111], v1, s[12:15], s33 offen offset:2176 sc1
    s_waitcnt vmcnt(6)
    v_lshlrev_b32 v64, 16, v96
    v_and_b32 v65, s61, v96
    v_lshlrev_b32 v66, 16, v97
    v_and_b32 v67, s61, v97
    v_lshlrev_b32 v68, 16, v98
    v_and_b32 v69, s61, v98
    v_lshlrev_b32 v70, 16, v99
    v_and_b32 v71, s61, v99
    s_waitcnt vmcnt(4)
    v_lshlrev_b32 v72, 16, v100
    v_and_b32 v73, s61, v100
    v_lshlrev_b32 v74, 16, v101
    v_and_b32 v75, s61, v101
    v_lshlrev_b32 v76, 16, v102
    v_and_b32 v77, s61, v102
    v_lshlrev_b32 v78, 16, v103
    v_and_b32 v79, s61, v103
    s_waitcnt vmcnt(2)
    v_lshlrev_b32 v80, 16, v104
    v_and_b32 v81, s61, v104
    v_lshlrev_b32 v82, 16, v105
    v_and_b32 v83, s61, v105
    v_lshlrev_b32 v84, 16, v106
    v_and_b32 v85, s61, v106
    v_lshlrev_b32 v86, 16, v107
    v_and_b32 v87, s61, v107
    s_waitcnt vmcnt(0)
    v_lshlrev_b32 v88, 16, v108
    v_and_b32 v89, s61, v108
    v_lshlrev_b32 v90, 16, v109
    v_and_b32 v91, s61, v109
    v_lshlrev_b32 v92, 16, v110
    v_and_b32 v93, s61, v110
    v_lshlrev_b32 v94, 16, v111
    v_and_b32 v95, s61, v111
interl_lncm13:
    v_pk_fma_f32 v[32:33], v[160:161], v[64:65], v[32:33]
    v_pk_fma_f32 v[34:35], v[162:163], v[66:67], v[34:35]
    v_pk_fma_f32 v[36:37], v[164:165], v[68:69], v[36:37]
    v_pk_fma_f32 v[38:39], v[166:167], v[70:71], v[38:39]
    v_pk_fma_f32 v[40:41], v[168:169], v[72:73], v[40:41]
    v_pk_fma_f32 v[42:43], v[170:171], v[74:75], v[42:43]
    v_pk_fma_f32 v[44:45], v[172:173], v[76:77], v[44:45]
    v_pk_fma_f32 v[46:47], v[174:175], v[78:79], v[46:47]
    v_pk_fma_f32 v[48:49], v[176:177], v[80:81], v[48:49]
    v_pk_fma_f32 v[50:51], v[178:179], v[82:83], v[50:51]
    v_pk_fma_f32 v[52:53], v[180:181], v[84:85], v[52:53]
    v_pk_fma_f32 v[54:55], v[182:183], v[86:87], v[54:55]
    v_pk_fma_f32 v[56:57], v[184:185], v[88:89], v[56:57]
    v_pk_fma_f32 v[58:59], v[186:187], v[90:91], v[58:59]
    v_pk_fma_f32 v[60:61], v[188:189], v[92:93], v[60:61]
    v_pk_fma_f32 v[62:63], v[190:191], v[94:95], v[62:63]
    v_pk_add_f32 v[28:29], v[32:33], v[34:35]
    v_pk_mul_f32 v[6:7], v[32:33], v[32:33]
    v_pk_fma_f32 v[6:7], v[34:35], v[34:35], v[6:7]
    v_pk_add_f32 v[28:29], v[28:29], v[36:37]
    v_pk_fma_f32 v[6:7], v[36:37], v[36:37], v[6:7]
    v_pk_add_f32 v[28:29], v[28:29], v[38:39]
    v_pk_fma_f32 v[6:7], v[38:39], v[38:39], v[6:7]
    v_pk_add_f32 v[28:29], v[28:29], v[40:41]
    v_pk_fma_f32 v[6:7], v[40:41], v[40:41], v[6:7]
    v_pk_add_f32 v[28:29], v[28:29], v[42:43]
    v_pk_fma_f32 v[6:7], v[42:43], v[42:43], v[6:7]
    v_pk_add_f32 v[28:29], v[28:29], v[44:45]
    v_pk_fma_f32 v[6:7], v[44:45], v[44:45], v[6:7]
    v_pk_add_f32 v[28:29], v[28:29], v[46:47]
    v_pk_fma_f32 v[6:7], v[46:47], v[46:47], v[6:7]
    v_pk_add_f32 v[28:29], v[28:29], v[48:49]
    v_pk_fma_f32 v[6:7], v[48:49], v[48:49], v[6:7]
    v_pk_add_f32 v[28:29], v[28:29], v[50:51]
    v_pk_fma_f32 v[6:7], v[50:51], v[50:51], v[6:7]
    v_pk_add_f32 v[28:29], v[28:29], v[52:53]
    v_pk_fma_f32 v[6:7], v[52:53], v[52:53], v[6:7]
    v_pk_add_f32 v[28:29], v[28:29], v[54:55]
    v_pk_fma_f32 v[6:7], v[54:55], v[54:55], v[6:7]
    v_pk_add_f32 v[28:29], v[28:29], v[56:57]
    v_pk_fma_f32 v[6:7], v[56:57], v[56:57], v[6:7]
    v_pk_add_f32 v[28:29], v[28:29], v[58:59]
    v_pk_fma_f32 v[6:7], v[58:59], v[58:59], v[6:7]
    v_pk_add_f32 v[28:29], v[28:29], v[60:61]
    v_pk_fma_f32 v[6:7], v[60:61], v[60:61], v[6:7]
    v_pk_add_f32 v[28:29], v[28:29], v[62:63]
    v_pk_fma_f32 v[6:7], v[62:63], v[62:63], v[6:7]
    v_add_f32 v28, v28, v29
    v_add_f32 v29, v6, v7
    s_nop 1
    v_permlane32_swap_b32 v28, v29
    v_add_f32 v28, v28, v29
    v_mov_b32 v29, v28
    s_nop 1
    v_permlane16_swap_b32 v28, v29
    v_add_f32 v28, v28, v29
    s_nop 1
    v_add_f32_dpp v28, v28, v28 row_ror:8 row_mask:0xf bank_mask:0xf
    ds_write_b32 v26, v28 offset:256
    s_waitcnt lgkmcnt(0)
    s_barrier
    ds_read_b128 v[4:7], v27 offset:256
    ds_read_b128 v[144:147], v27 offset:384
    s_waitcnt lgkmcnt(1)
    v_pk_add_f32 v[4:5], v[4:5], v[6:7]
    v_add_f32 v29, v4, v5
    v_mul_f32 v29, 0x3a800000, v29
    s_waitcnt lgkmcnt(0)
    v_pk_add_f32 v[6:7], v[144:145], v[146:147]
    v_add_f32 v28, v6, v7
    v_mul_f32 v28, 0x3a800000, v28
    v_fma_f32 v28, -v29, v29, v28
    v_max_f32 v28, 0, v28
    v_add_f32 v28, 0x3727c5ac, v28
    v_rsq_f32 v28, v28
    s_nop 0
    v_mul_f32 v29, -v29, v28
    v_pk_fma_f32 v[160:161], v[32:33], v[28:29], v[28:29] op_sel:[0,0,1] op_sel_hi:[1,0,1]
    v_cvt_pk_bf16_f32 v64, v160, v161
    v_pk_fma_f32 v[162:163], v[34:35], v[28:29], v[28:29] op_sel:[0,0,1] op_sel_hi:[1,0,1]
    v_cvt_pk_bf16_f32 v65, v162, v163
    v_pk_fma_f32 v[164:165], v[36:37], v[28:29], v[28:29] op_sel:[0,0,1] op_sel_hi:[1,0,1]
    v_cvt_pk_bf16_f32 v66, v164, v165
    v_pk_fma_f32 v[166:167], v[38:39], v[28:29], v[28:29] op_sel:[0,0,1] op_sel_hi:[1,0,1]
    v_cvt_pk_bf16_f32 v67, v166, v167
    buffer_store_dwordx4 v[64:67], v25, s[12:15], s37 offen sc1
    s_add_u32 s37, s37, 32768
    v_pk_fma_f32 v[168:169], v[40:41], v[28:29], v[28:29] op_sel:[0,0,1] op_sel_hi:[1,0,1]
    v_cvt_pk_bf16_f32 v68, v168, v169
    v_pk_fma_f32 v[170:171], v[42:43], v[28:29], v[28:29] op_sel:[0,0,1] op_sel_hi:[1,0,1]
iw_d1:
    s_cbranch_execz iw_d4
    v_cvt_pk_bf16_f32 v69, v170, v171
    v_pk_fma_f32 v[172:173], v[44:45], v[28:29], v[28:29] op_sel:[0,0,1] op_sel_hi:[1,0,1]
    v_cvt_pk_bf16_f32 v70, v172, v173
    v_pk_fma_f32 v[174:175], v[46:47], v[28:29], v[28:29] op_sel:[0,0,1] op_sel_hi:[1,0,1]
    v_cvt_pk_bf16_f32 v71, v174, v175
    buffer_store_dwordx4 v[68:71], v25, s[12:15], s37 offen sc1
    s_add_u32 s37, s37, 32768
    v_pk_fma_f32 v[176:177], v[48:49], v[28:29], v[28:29] op_sel:[0,0,1] op_sel_hi:[1,0,1]
    v_cvt_pk_bf16_f32 v72, v176, v177
    v_pk_fma_f32 v[178:179], v[50:51], v[28:29], v[28:29] op_sel:[0,0,1] op_sel_hi:[1,0,1]
    v_cvt_pk_bf16_f32 v73, v178, v179
    v_pk_fma_f32 v[180:181], v[52:53], v[28:29], v[28:29] op_sel:[0,0,1] op_sel_hi:[1,0,1]
    v_cvt_pk_bf16_f32 v74, v180, v181
    v_pk_fma_f32 v[182:183], v[54:55], v[28:29], v[28:29] op_sel:[0,0,1] op_sel_hi:[1,0,1]
    v_cvt_pk_bf16_f32 v75, v182, v183
    buffer_store_dwordx4 v[72:75], v25, s[12:15], s37 offen sc1
    s_add_u32 s37, s37, 32768
    v_pk_fma_f32 v[184:185], v[56:57], v[28:29], v[28:29] op_sel:[0,0,1] op_sel_hi:[1,0,1]
    v_cvt_pk_bf16_f32 v76, v184, v185
    v_pk_fma_f32 v[186:187], v[58:59], v[28:29], v[28:29] op_sel:[0,0,1] op_sel_hi:[1,0,1]
    v_cvt_pk_bf16_f32 v77, v186, v187
    v_pk_fma_f32 v[188:189], v[60:61], v[28:29], v[28:29] op_sel:[0,0,1] op_sel_hi:[1,0,1]
    v_cvt_pk_bf16_f32 v78, v188, v189
    v_pk_fma_f32 v[190:191], v[62:63], v[28:29], v[28:29] op_sel:[0,0,1] op_sel_hi:[1,0,1]
    v_cvt_pk_bf16_f32 v79, v190, v191
    buffer_store_dwordx4 v[76:79], v25, s[12:15], s37 offen sc1
    s_add_u32 s37, s37, 32768
    s_cmp_lg_u32 s3, 3
    s_cbranch_scc1 interl_lnq32
    s_lshl_b32 s35, s60, 7
    s_add_u32 s35, s35, 8388608
    v_lshlrev_b32 v4, 3, v2
    s_mov_b64 exec, 0xffff
    buffer_store_dwordx2 v[28:29], v4, s[12:15], s35 offen sc1
    s_mov_b64 exec, -1
interl_lnq32:
    ds_read_b64_tr_b16 a[0:1], v10 offset:0
    ds_read_b64_tr_b16 a[2:3], v10 offset:1024
    ds_read_b64_tr_b16 a[4:5], v11 offset:0
    ds_read_b64_tr_b16 a[6:7], v11 offset:1024
    ds_read_b64_tr_b16 a[8:9], v12 offset:0
    ds_read_b64_tr_b16 a[10:11], v12 offset:1024
    ds_read_b64_tr_b16 a[12:13], v10 offset:8208
    ds_read_b64_tr_b16 a[14:15], v10 offset:9232
    ds_read_b64_tr_b16 a[16:17], v11 offset:8208
    ds_read_b64_tr_b16 a[18:19], v11 offset:9232
    ds_read_b64_tr_b16 a[20:21], v12 offset:8208
    ds_read_b64_tr_b16 a[22:23], v12 offset:9232
    ds_read_b64_tr_b16 a[24:25], v13 offset:0
    ds_read_b64_tr_b16 a[26:27], v13 offset:1024
    ds_read_b64_tr_b16 a[28:29], v10 offset:33024
    ds_read_b64_tr_b16 a[30:31], v10 offset:34048
    ds_read_b64_tr_b16 a[32:33], v11 offset:33024
    ds_read_b64_tr_b16 a[34:35], v11 offset:34048
    ds_read_b64_tr_b16 a[36:37], v12 offset:33024
    ds_read_b64_tr_b16 a[38:39], v12 offset:34048
    ds_read_b64_tr_b16 a[40:41], v10 offset:41232
    ds_read_b64_tr_b16 a[42:43], v10 offset:42256
    ds_read_b64_tr_b16 a[44:45], v11 offset:41232
    ds_read_b64_tr_b16 a[46:47], v11 offset:42256
    ds_read_b64_tr_b16 a[48:49], v12 offset:41232
    ds_read_b64_tr_b16 a[50:51], v12 offset:42256
    ds_read_b64_tr_b16 a[52:53], v13 offset:33024
    ds_read_b64_tr_b16 a[54:55], v13 offset:34048
    s_waitcnt lgkmcnt(0)
    s_add_u32 s63, s63, 1
    v_mov_b32 v4, 0
    v_mov_b32 v5, s63
    s_cmp_lg_u32 s3, 0
    s_waitcnt vmcnt(0)
    s_barrier
    s_cbranch_scc1 interl_sig33
    s_mov_b64 exec, 1
    buffer_store_dword v5, v4, s[12:15], s94 offen sc1
    s_mov_b64 exec, -1
interl_sig33:
    s_cmp_lg_u32 s6, 0
    s_cbranch_scc1 interl_lnd34
    v_cvt_pk_bf16_f32 v128, v32, v33
    v_cvt_pk_bf16_f32 v129, v34, v35
    v_cvt_pk_bf16_f32 v130, v36, v37
    v_cvt_pk_bf16_f32 v131, v38, v39
    v_cvt_pk_bf16_f32 v132, v40, v41
    v_cvt_pk_bf16_f32 v133, v42, v43
    v_cvt_pk_bf16_f32 v134, v44, v45
    v_cvt_pk_bf16_f32 v135, v46, v47
    v_cvt_pk_bf16_f32 v136, v48, v49
    v_cvt_pk_bf16_f32 v137, v50, v51
    v_cvt_pk_bf16_f32 v138, v52, v53
    v_cvt_pk_bf16_f32 v139, v54, v55
    v_cvt_pk_bf16_f32 v140, v56, v57
    v_cvt_pk_bf16_f32 v141, v58, v59
    v_cvt_pk_bf16_f32 v142, v60, v61
    v_cvt_pk_bf16_f32 v143, v62, v63
    v_accvgpr_write_b32 a224, v128
    v_accvgpr_write_b32 a240, v96
    v_accvgpr_write_b32 a225, v129
    v_accvgpr_write_b32 a241, v97
    v_accvgpr_write_b32 a226, v130
    v_accvgpr_write_b32 a242, v98
    v_accvgpr_write_b32 a227, v131
    v_accvgpr_write_b32 a243, v99
    v_accvgpr_write_b32 a228, v132
    v_accvgpr_write_b32 a244, v100
    v_accvgpr_write_b32 a229, v133
    v_accvgpr_write_b32 a245, v101
    v_accvgpr_write_b32 a230, v134
    v_accvgpr_write_b32 a246, v102
    v_accvgpr_write_b32 a231, v135
    v_accvgpr_write_b32 a247, v103
    v_accvgpr_write_b32 a232, v136
    v_accvgpr_write_b32 a248, v104
    v_accvgpr_write_b32 a233, v137
    v_accvgpr_write_b32 a249, v105
    v_accvgpr_write_b32 a234, v138
    v_accvgpr_write_b32 a250, v106
    v_accvgpr_write_b32 a235, v139
    v_accvgpr_write_b32 a251, v107
    v_accvgpr_write_b32 a236, v140
    v_accvgpr_write_b32 a252, v108
    v_accvgpr_write_b32 a237, v141
    v_accvgpr_write_b32 a253, v109
    v_accvgpr_write_b32 a238, v142
    v_accvgpr_write_b32 a254, v110
    v_accvgpr_write_b32 a239, v143
    v_accvgpr_write_b32 a255, v111
interl_lnd34:
    s_add_u32 m0, s43, 0
    s_nop 0
    buffer_load_dwordx4 v19, s[8:11], s41 offen offset:0 lds
    buffer_load_dwordx4 v20, s[8:11], s41 offen offset:1024 lds
    buffer_load_dwordx4 v21, s[8:11], s41 offen offset:2048 lds
    buffer_load_dwordx4 v22, s[8:11], s41 offen offset:3072 lds
    s_add_u32 s41, s41, 229376
    s_add_u32 m0, s43, 33024
    s_nop 0
    buffer_load_dwordx4 v19, s[8:11], s41 offen offset:0 lds
    buffer_load_dwordx4 v20, s[8:11], s41 offen offset:1024 lds
    buffer_load_dwordx4 v21, s[8:11], s41 offen offset:2048 lds
    buffer_load_dwordx4 v22, s[8:11], s41 offen offset:3072 lds
iw_c2:
    s_cbranch_execz iw_c5
    s_add_u32 s41, s41, 229376
    s_lshl_b32 s59, s4, 3
    s_lshl_b32 s33, s45, 2
    s_add_u32 s59, s59, s33
    s_mul_i32 s59, s59, 229376
    s_lshr_b32 s33, s5, 4
    s_mul_i32 s33, s33, 114688
    s_add_u32 s59, s59, s33
    s_add_u32 s59, s59, s7
    s_add_u32 s59, s59, 12582912
    s_lshl_b32 s34, s46, 1
    s_add_u32 s34, s34, s44
    s_mov_b32 s53, s59
    s_mov_b32 s52, s59
    s_and_b32 s36, s5, 15
    s_lshl_b32 s33, s36, 1
    s_add_u32 s33, s33, s44
    s_lshl_b32 s33, s33, 11
    v_add_u32 v24, s33, v3
    v_and_b32 v4, 15, v2
    v_lshlrev_b32 v4, 4, v4
    v_lshrrev_b32 v5, 5, v2
    v_lshl_add_u32 v4, v5, 10, v4
    v_bfe_u32 v5, v2, 4, 1
    s_add_u32 s33, s36, 32
    s_lshl_b32 s33, s33, 11
    s_lshl_b32 s35, s44, 9
    s_add_u32 s33, s33, s35
    v_lshl_add_u32 v25, v5, 8, v4
    v_add_u32 v25, s33, v25
    s_lshl_b32 s33, s34, 8
    s_lshr_b32 s36, s36, 1
    s_lshl_b32 s36, s36, 11
    s_add_u32 s33, s33, s36
    s_add_u32 s33, s33, 98304
    v_mul_u32_u24 v5, 229376, v5
    v_add3_u32 v26, v4, v5, s33
    s_lshr_b32 s33, s5, 4
    s_lshl_b32 s33, s33, 2
    s_add_u32 s33, s33, s3
    s_lshl_b32 s34, s5, 1
    s_add_u32 s34, s34, 10
    v_and_b32 v5, 7, v2
    v_add_u32 v5, s34, v5
    v_and_b32 v5, 15, v5
    v_bfe_u32 v7, v2, 3, 1
    v_lshl_add_u32 v5, v7, 4, v5
    v_mov_b32 v7, s33
    v_cmp_gt_u32 vcc, 16, v2
    v_lshlrev_b32 v5, 3, v5
    s_nop 0
    v_cndmask_b32 v7, 4, v7, vcc
    v_add_lshl_u32 v23, v5, v7, 7
    s_mov_b32 s47, 6
    s_lshl_b32 s33, s45, 13
    s_mul_i32 s34, s44, 33024
    s_add_u32 s34, s34, s33
    s_lshl_b32 s35, s44, 14
    s_add_u32 s33, s33, s35
    s_sub_u32 s35, s40, s42
    s_add_u32 s33, s33, s35
    s_add_u32 s35, s33, 4096
    s_add_u32 s40, s40, 32768
    v_lshrrev_b32 v1, 5, v2
    v_bfe_u32 v4, v2, 3, 2
    v_and_b32 v5, 0x70, v3
    v_lshl_add_u32 v5, v4, 11, v5
    v_mov_b32 v6, v219
    s_lshl_b32 s49, s6, 4
    s_add_u32 s49, s49, 1
    s_lshl_b32 s62, s6, 2
    s_add_u32 s62, s62, s3
    s_mov_b64 exec, 0
    s_cmp_eq_u32 s62, 1
    s_cbranch_scc1 iw_d0
    s_cmp_eq_u32 s62, 2
    s_cbranch_scc1 iw_d1
    s_cmp_eq_u32 s62, 3
    s_cbranch_scc1 iw_d2
iw_ret2:
    s_mov_b64 exec, -1
    s_cmp_lg_u32 s3, 0
    s_cbranch_scc1 interl_wt35
    s_mov_b32 exec_hi, 0
    s_mov_b32 s62, 4000000
interl_poll36:
    buffer_load_dword v7, v0, s[12:15], s95 offen sc1
    s_sub_u32 s62, s62, 1
    s_cbranch_scc1 interl_pd37
    s_waitcnt vmcnt(0)
    v_cmp_gt_u32 vcc, s63, v7
    s_cbranch_vccnz interl_poll36
interl_pd37:
    s_mov_b64 exec, -1
interl_wt35:
    s_barrier
    s_add_u32 m0, s34, 0
    s_nop 0
    buffer_load_dwordx4 v3, s[12:15], s33 offen offset:0 sc1 lds
    buffer_load_dwordx4 v3, s[12:15], s33 offen offset:1024 sc1 lds
    buffer_load_dwordx4 v3, s[12:15], s33 offen offset:2048 sc1 lds
    buffer_load_dwordx4 v3, s[12:15], s33 offen offset:3072 sc1 lds
    s_add_u32 m0, s34, 4096
    s_nop 0
    buffer_load_dwordx4 v3, s[12:15], s35 offen offset:0 sc1 lds
    buffer_load_dwordx4 v3, s[12:15], s35 offen offset:1024 sc1 lds
    buffer_load_dwordx4 v3, s[12:15], s35 offen offset:2048 sc1 lds
    buffer_load_dwordx4 v3, s[12:15], s35 offen offset:3072 sc1 lds
    s_add_u32 m0, s42, 66048
    s_waitcnt vmcnt(6)
    s_barrier
    ds_read_b128 a[112:115], v8 offset:0
    ds_read_b128 a[116:119], v8 offset:33024
    ds_read_b128 a[120:123], v8 offset:1024
    ds_read_b128 a[124:127], v8 offset:34048
    s_waitcnt lgkmcnt(2)
    v_mfma_f32_16x16x32_bf16 v[32:35], a[0:3], a[112:115], 0
    v_mfma_f32_16x16x32_bf16 v[32:35], a[28:31], a[116:119], v[32:35]
    buffer_load_dwordx4 v3, s[12:15], s40 offen offset:0 sc1 lds
    v_mfma_f32_16x16x32_bf16 v[36:39], a[32:35], a[116:119], 0
    ds_read_b64_tr_b16 a[56:57], v14 offset:0
    v_mfma_f32_16x16x32_bf16 v[36:39], a[4:7], a[112:115], v[36:39]
    ds_read_b64_tr_b16 a[58:59], v14 offset:1024
    v_mfma_f32_16x16x32_bf16 v[40:43], a[8:11], a[112:115], 0
    ds_read_b64_tr_b16 a[60:61], v15 offset:0
    v_mfma_f32_16x16x32_bf16 v[40:43], a[36:39], a[116:119], v[40:43]
    buffer_load_dwordx4 v3, s[12:15], s40 offen offset:1024 sc1 lds
    v_mfma_f32_16x16x32_bf16 v[44:47], a[40:43], a[116:119], 0
    ds_read_b64_tr_b16 a[62:63], v15 offset:1024
    v_mfma_f32_16x16x32_bf16 v[44:47], a[12:15], a[112:115], v[44:47]
    ds_read_b64_tr_b16 a[64:65], v16 offset:0
    v_mfma_f32_16x16x32_bf16 v[48:51], a[16:19], a[112:115], 0
    ds_read_b64_tr_b16 a[66:67], v16 offset:1024
    v_mfma_f32_16x16x32_bf16 v[48:51], a[44:47], a[116:119], v[48:51]
    buffer_load_dwordx4 v3, s[12:15], s40 offen offset:2048 sc1 lds
    v_mfma_f32_16x16x32_bf16 v[52:55], a[48:51], a[116:119], 0
    v_mfma_f32_16x16x32_bf16 v[52:55], a[20:23], a[112:115], v[52:55]
    v_mfma_f32_16x16x32_bf16 v[56:59], a[24:27], a[112:115], 0
    s_waitcnt vmcnt(3) lgkmcnt(0)
    s_barrier
    v_mfma_f32_16x16x32_bf16 v[56:59], a[52:55], a[116:119], v[56:59]
    buffer_load_dwordx4 v3, s[12:15], s40 offen offset:3072 sc1 lds
    ds_read_b128 a[128:131], v8 offset:2048
    v_mfma_f32_16x16x32_bf16 v[84:87], a[24:27], a[120:123], 0
    s_add_u32 s40, s40, 16384
    ds_read_b128 a[132:135], v8 offset:35072
    v_mfma_f32_16x16x32_bf16 v[84:87], a[52:55], a[124:127], v[84:87]
    s_add_u32 m0, s42, 99072
    ds_read_b128 a[136:139], v8 offset:3072
    v_mfma_f32_16x16x32_bf16 v[80:83], a[48:51], a[124:127], 0
    ds_read_b128 a[140:143], v8 offset:36096
    v_mfma_f32_16x16x32_bf16 v[80:83], a[20:23], a[120:123], v[80:83]
    buffer_load_dwordx4 v3, s[12:15], s40 offen offset:0 sc1 lds
    ds_read_b128 a[144:147], v8 offset:4096
    v_mfma_f32_16x16x32_bf16 v[76:79], a[16:19], a[120:123], 0
    ds_read_b128 a[148:151], v8 offset:37120
    v_mfma_f32_16x16x32_bf16 v[76:79], a[44:47], a[124:127], v[76:79]
    ds_read_b128 a[152:155], v8 offset:5120
    v_mfma_f32_16x16x32_bf16 v[72:75], a[40:43], a[124:127], 0
    ds_read_b128 a[156:159], v8 offset:38144
    v_mfma_f32_16x16x32_bf16 v[72:75], a[12:15], a[120:123], v[72:75]
    buffer_load_dwordx4 v3, s[12:15], s40 offen offset:1024 sc1 lds
    ds_read_b128 a[160:163], v8 offset:6144
    v_mfma_f32_16x16x32_bf16 v[68:71], a[8:11], a[120:123], 0
    ds_read_b128 a[164:167], v8 offset:39168
    v_mfma_f32_16x16x32_bf16 v[68:71], a[36:39], a[124:127], v[68:71]
    ds_read_b128 a[168:171], v8 offset:7168
    v_mfma_f32_16x16x32_bf16 v[64:67], a[32:35], a[124:127], 0
    ds_read_b128 a[172:175], v8 offset:40192
    v_mfma_f32_16x16x32_bf16 v[64:67], a[4:7], a[120:123], v[64:67]
    buffer_load_dwordx4 v3, s[12:15], s40 offen offset:2048 sc1 lds
    v_mfma_f32_16x16x32_bf16 v[60:63], a[0:3], a[120:123], 0
iw_d2:
    s_cbranch_execz iw_d5
    v_mfma_f32_16x16x32_bf16 v[60:63], a[28:31], a[124:127], v[60:63]
    s_waitcnt lgkmcnt(10)
    v_mfma_f32_16x16x32_bf16 v[88:91], a[0:3], a[128:131], 0
    v_mfma_f32_16x16x32_bf16 v[88:91], a[28:31], a[132:135], v[88:91]
    buffer_load_dwordx4 v3, s[12:15], s40 offen offset:3072 sc1 lds
    v_mfma_f32_16x16x32_bf16 v[92:95], a[32:35], a[132:135], 0
    s_add_u32 s40, s40, 16384
    v_mfma_f32_16x16x32_bf16 v[92:95], a[4:7], a[128:131], v[92:95]
    v_mfma_f32_16x16x32_bf16 v[96:99], a[8:11], a[128:131], 0
    v_mfma_f32_16x16x32_bf16 v[96:99], a[36:39], a[132:135], v[96:99]
    s_waitcnt lgkmcnt(0)
    s_barrier
    v_mfma_f32_16x16x32_bf16 v[100:103], a[40:43], a[132:135], 0
    ds_read_b64_tr_b16 a[68:69], v14 offset:8208
    s_add_u32 m0, s42, 0
    v_mfma_f32_16x16x32_bf16 v[100:103], a[12:15], a[128:131], v[100:103]
    ds_read_b64_tr_b16 a[70:71], v14 offset:9232
    buffer_load_dwordx4 v3, s[12:15], s40 offen offset:0 sc1 lds
    v_mfma_f32_16x16x32_bf16 v[104:107], a[16:19], a[128:131], 0
    ds_read_b64_tr_b16 a[72:73], v15 offset:8208
    v_mfma_f32_16x16x32_bf16 v[104:107], a[44:47], a[132:135], v[104:107]
    ds_read_b64_tr_b16 a[74:75], v15 offset:9232
    v_mfma_f32_16x16x32_bf16 v[108:111], a[48:51], a[132:135], 0
    ds_read_b64_tr_b16 a[76:77], v16 offset:8208
    v_mfma_f32_16x16x32_bf16 v[108:111], a[20:23], a[128:131], v[108:111]
    ds_read_b64_tr_b16 a[78:79], v16 offset:9232
    buffer_load_dwordx4 v3, s[12:15], s40 offen offset:1024 sc1 lds
    v_mfma_f32_16x16x32_bf16 v[112:115], a[24:27], a[128:131], 0
    ds_read_b64_tr_b16 a[80:81], v17 offset:0
    v_mfma_f32_16x16x32_bf16 v[112:115], a[52:55], a[132:135], v[112:115]
    ds_read_b64_tr_b16 a[82:83], v17 offset:1024
    v_mfma_f32_16x16x32_bf16 v[140:143], a[24:27], a[136:139], 0
    ds_read_b64_tr_b16 a[84:85], v14 offset:33024
    v_mfma_f32_16x16x32_bf16 v[140:143], a[52:55], a[140:143], v[140:143]
    ds_read_b64_tr_b16 a[86:87], v14 offset:34048
    buffer_load_dwordx4 v3, s[12:15], s40 offen offset:2048 sc1 lds
    v_mfma_f32_16x16x32_bf16 v[136:139], a[48:51], a[140:143], 0
    ds_read_b64_tr_b16 a[88:89], v15 offset:33024
    v_mfma_f32_16x16x32_bf16 v[136:139], a[20:23], a[136:139], v[136:139]
    ds_read_b64_tr_b16 a[90:91], v15 offset:34048
    v_mfma_f32_16x16x32_bf16 v[132:135], a[16:19], a[136:139], 0
    ds_read_b64_tr_b16 a[92:93], v16 offset:33024
    v_mfma_f32_16x16x32_bf16 v[132:135], a[44:47], a[140:143], v[132:135]
    ds_read_b64_tr_b16 a[94:95], v16 offset:34048
    buffer_load_dwordx4 v3, s[12:15], s40 offen offset:3072 sc1 lds
    v_mfma_f32_16x16x32_bf16 v[128:131], a[40:43], a[140:143], 0
    ds_read_b64_tr_b16 a[96:97], v14 offset:41232
    s_add_u32 s40, s40, 16384
    v_mfma_f32_16x16x32_bf16 v[128:131], a[12:15], a[136:139], v[128:131]
    ds_read_b64_tr_b16 a[98:99], v14 offset:42256
    v_mfma_f32_16x16x32_bf16 v[124:127], a[8:11], a[136:139], 0
    ds_read_b64_tr_b16 a[100:101], v15 offset:41232
    s_add_u32 m0, s42, 33024
    v_mfma_f32_16x16x32_bf16 v[124:127], a[36:39], a[140:143], v[124:127]
    ds_read_b64_tr_b16 a[102:103], v15 offset:42256
    buffer_load_dwordx4 v3, s[12:15], s40 offen offset:0 sc1 lds
    v_mfma_f32_16x16x32_bf16 v[120:123], a[32:35], a[140:143], 0
    ds_read_b64_tr_b16 a[104:105], v16 offset:41232
    v_mfma_f32_16x16x32_bf16 v[120:123], a[4:7], a[136:139], v[120:123]
    ds_read_b64_tr_b16 a[106:107], v16 offset:42256
    v_mfma_f32_16x16x32_bf16 v[116:119], a[0:3], a[136:139], 0
    ds_read_b64_tr_b16 a[108:109], v17 offset:33024
    v_mfma_f32_16x16x32_bf16 v[116:119], a[28:31], a[140:143], v[116:119]
    ds_read_b64_tr_b16 a[110:111], v17 offset:34048
    buffer_load_dwordx4 v3, s[12:15], s40 offen offset:1024 sc1 lds
    v_mfma_f32_16x16x32_bf16 v[144:147], a[0:3], a[144:147], 0
    v_mfma_f32_16x16x32_bf16 v[144:147], a[28:31], a[148:151], v[144:147]
    v_mfma_f32_16x16x32_bf16 v[148:151], a[32:35], a[148:151], 0
    v_mfma_f32_16x16x32_bf16 v[148:151], a[4:7], a[144:147], v[148:151]
    buffer_load_dwordx4 v3, s[12:15], s40 offen offset:2048 sc1 lds
    v_mfma_f32_16x16x32_bf16 v[152:155], a[8:11], a[144:147], 0
    v_mfma_f32_16x16x32_bf16 v[152:155], a[36:39], a[148:151], v[152:155]
    v_mfma_f32_16x16x32_bf16 v[156:159], a[40:43], a[148:151], 0
    s_waitcnt vmcnt(7) lgkmcnt(0)
    v_mfma_f32_16x16x32_bf16 v[156:159], a[12:15], a[144:147], v[156:159]
    s_barrier
    v_mfma_f32_16x16x32_bf16 v[160:163], a[16:19], a[144:147], 0
    buffer_load_dwordx4 v3, s[12:15], s40 offen offset:3072 sc1 lds
    v_mfma_f32_16x16x32_bf16 v[160:163], a[44:47], a[148:151], v[160:163]
    ds_read_b128 a[112:115], v9 offset:0
    s_add_u32 s40, s40, 16384
    v_mfma_f32_16x16x32_bf16 v[164:167], a[48:51], a[148:151], 0
    ds_read_b128 a[116:119], v9 offset:33024
    v_mfma_f32_16x16x32_bf16 v[164:167], a[20:23], a[144:147], v[164:167]
    v_mfma_f32_16x16x32_bf16 v[168:171], a[24:27], a[144:147], 0
    ds_read_b128 a[120:123], v9 offset:1024
    s_add_u32 m0, s43, 66048
    v_mfma_f32_16x16x32_bf16 v[168:171], a[52:55], a[148:151], v[168:171]
    ds_read_b128 a[124:127], v9 offset:34048
    buffer_load_dwordx4 v19, s[8:11], s41 offen offset:0 lds
    v_mfma_f32_16x16x32_bf16 v[196:199], a[24:27], a[152:155], 0
    v_mfma_f32_16x16x32_bf16 v[196:199], a[52:55], a[156:159], v[196:199]
    ds_read_b128 a[128:131], v9 offset:2048
    v_mfma_f32_16x16x32_bf16 v[192:195], a[48:51], a[156:159], 0
    ds_read_b128 a[132:135], v9 offset:35072
    v_mfma_f32_16x16x32_bf16 v[192:195], a[20:23], a[152:155], v[192:195]
    v_mfma_f32_16x16x32_bf16 v[188:191], a[16:19], a[152:155], 0
    ds_read_b128 a[136:139], v9 offset:3072
    buffer_load_dwordx4 v20, s[8:11], s41 offen offset:1024 lds
    v_mfma_f32_16x16x32_bf16 v[188:191], a[44:47], a[156:159], v[188:191]
    ds_read_b128 a[140:143], v9 offset:36096
    v_mfma_f32_16x16x32_bf16 v[184:187], a[40:43], a[156:159], 0
    v_mfma_f32_16x16x32_bf16 v[184:187], a[12:15], a[152:155], v[184:187]
    ds_read_b128 a[144:147], v9 offset:4096
    v_mfma_f32_16x16x32_bf16 v[180:183], a[8:11], a[152:155], 0
    ds_read_b128 a[148:151], v9 offset:37120
    v_mfma_f32_16x16x32_bf16 v[180:183], a[36:39], a[156:159], v[180:183]
    buffer_load_dwordx4 v21, s[8:11], s41 offen offset:2048 lds
    v_mfma_f32_16x16x32_bf16 v[176:179], a[32:35], a[156:159], 0
    v_mfma_f32_16x16x32_bf16 v[176:179], a[4:7], a[152:155], v[176:179]
    v_mfma_f32_16x16x32_bf16 v[172:175], a[0:3], a[152:155], 0
    v_mfma_f32_16x16x32_bf16 v[172:175], a[28:31], a[156:159], v[172:175]
    ds_read_b128 a[152:155], v9 offset:5120
    v_mfma_f32_16x16x32_bf16 v[200:203], a[0:3], a[160:163], 0
    ds_read_b128 a[156:159], v9 offset:38144
    v_mfma_f32_16x16x32_bf16 v[200:203], a[28:31], a[164:167], v[200:203]
    buffer_load_dwordx4 v22, s[8:11], s41 offen offset:3072 lds
    v_mfma_f32_16x16x32_bf16 v[204:207], a[32:35], a[164:167], 0
    s_add_u32 s41, s41, 229376
    v_mfma_f32_16x16x32_bf16 v[204:207], a[4:7], a[160:163], v[204:207]
    v_mfma_f32_16x16x32_bf16 v[208:211], a[8:11], a[160:163], 0
    v_mfma_f32_16x16x32_bf16 v[208:211], a[36:39], a[164:167], v[208:211]
    s_add_u32 m0, s43, 99072
    v_mfma_f32_16x16x32_bf16 v[212:215], a[40:43], a[164:167], 0
    buffer_load_dwordx4 v19, s[8:11], s41 offen offset:0 lds
    v_mfma_f32_16x16x32_bf16 v[212:215], a[12:15], a[160:163], v[212:215]
    v_mfma_f32_16x16x32_bf16 v[216:219], a[16:19], a[160:163], 0
    v_mfma_f32_16x16x32_bf16 v[216:219], a[44:47], a[164:167], v[216:219]
    v_mfma_f32_16x16x32_bf16 v[220:223], a[48:51], a[164:167], 0
    v_mfma_f32_16x16x32_bf16 v[220:223], a[20:23], a[160:163], v[220:223]
    buffer_load_dwordx4 v20, s[8:11], s41 offen offset:1024 lds
    v_mfma_f32_16x16x32_bf16 v[224:227], a[24:27], a[160:163], 0
iw_c3:
    s_cbranch_execz iw_c6
    v_mfma_f32_16x16x32_bf16 v[224:227], a[52:55], a[164:167], v[224:227]
    ds_read_b128 a[160:163], v9 offset:6144
    v_mfma_f32_16x16x32_bf16 v[252:255], a[24:27], a[168:171], 0
    ds_read_b128 a[164:167], v9 offset:39168
    v_mfma_f32_16x16x32_bf16 v[252:255], a[52:55], a[172:175], v[252:255]
    v_mfma_f32_16x16x32_bf16 v[248:251], a[48:51], a[172:175], 0
    buffer_load_dwordx4 v21, s[8:11], s41 offen offset:2048 lds
    v_mfma_f32_16x16x32_bf16 v[248:251], a[20:23], a[168:171], v[248:251]
    s_mov_b64 s[24:25], s[12:13]
    v_mfma_f32_16x16x32_bf16 v[244:247], a[16:19], a[168:171], 0
    v_mfma_f32_16x16x32_bf16 v[244:247], a[44:47], a[172:175], v[244:247]
    v_mfma_f32_16x16x32_bf16 v[240:243], a[40:43], a[172:175], 0
    v_mfma_f32_16x16x32_bf16 v[240:243], a[12:15], a[168:171], v[240:243]
    buffer_load_dwordx4 v22, s[8:11], s41 offen offset:3072 lds
    v_mfma_f32_16x16x32_bf16 v[236:239], a[8:11], a[168:171], 0
    s_add_u32 s41, s41, 229376
    v_mfma_f32_16x16x32_bf16 v[236:239], a[36:39], a[172:175], v[236:239]
    v_mfma_f32_16x16x32_bf16 v[232:235], a[32:35], a[172:175], 0
    v_mfma_f32_16x16x32_bf16 v[232:235], a[4:7], a[168:171], v[232:235]
    v_mfma_f32_16x16x32_bf16 v[228:231], a[0:3], a[168:171], 0
    ds_read_b128 a[168:171], v9 offset:7168
    s_cmp_eq_u32 s6, 0
    v_mfma_f32_16x16x32_bf16 v[228:231], a[28:31], a[172:175], v[228:231]
    ds_read_b128 a[172:175], v9 offset:40192
    s_cbranch_scc1 interl_g1k47
    s_cmp_eq_u32 s3, 0
    s_cbranch_scc1 interl_g1m42
    s_cmp_eq_u32 s3, 2
    s_cbranch_scc1 interl_g1m42
    s_branch interl_g1m43
interl_g1m42:
    s_waitcnt lgkmcnt(2)
    v_mfma_f32_16x16x32_bf16 v[32:35], a[56:59], a[112:115], v[32:35]
    v_mfma_f32_16x16x32_bf16 v[32:35], a[84:87], a[116:119], v[32:35]
    v_mfma_f32_16x16x32_bf16 v[36:39], a[88:91], a[116:119], v[36:39]
    v_mfma_f32_16x16x32_bf16 v[36:39], a[60:63], a[112:115], v[36:39]
    v_mfma_f32_16x16x32_bf16 v[40:43], a[64:67], a[112:115], v[40:43]
    v_mfma_f32_16x16x32_bf16 v[40:43], a[92:95], a[116:119], v[40:43]
    v_mfma_f32_16x16x32_bf16 v[44:47], a[96:99], a[116:119], v[44:47]
    s_waitcnt vmcnt(17) lgkmcnt(0)
    v_mfma_f32_16x16x32_bf16 v[44:47], a[68:71], a[112:115], v[44:47]
    s_barrier
    v_mfma_f32_16x16x32_bf16 v[48:51], a[72:75], a[112:115], v[48:51]
    ds_read_b64_tr_b16 a[0:1], v10 offset:0
    v_mfma_f32_16x16x32_bf16 v[48:51], a[100:103], a[116:119], v[48:51]
    ds_read_b64_tr_b16 a[2:3], v10 offset:1024
    v_mfma_f32_16x16x32_bf16 v[52:55], a[104:107], a[116:119], v[52:55]
    v_mfma_f32_16x16x32_bf16 v[52:55], a[76:79], a[112:115], v[52:55]
    ds_read_b64_tr_b16 a[4:5], v11 offset:0
    v_mfma_f32_16x16x32_bf16 v[56:59], a[80:83], a[112:115], v[56:59]
    ds_read_b64_tr_b16 a[6:7], v11 offset:1024
    v_mfma_f32_16x16x32_bf16 v[56:59], a[108:111], a[116:119], v[56:59]
    v_mfma_f32_16x16x32_bf16 v[84:87], a[80:83], a[120:123], v[84:87]
    ds_read_b64_tr_b16 a[8:9], v12 offset:0
    v_mfma_f32_16x16x32_bf16 v[84:87], a[108:111], a[124:127], v[84:87]
    ds_read_b64_tr_b16 a[10:11], v12 offset:1024
    s_add_u32 m0, s42, 66048
    v_mfma_f32_16x16x32_bf16 v[80:83], a[104:107], a[124:127], v[80:83]
    buffer_load_dwordx4 v3, s[12:15], s40 offen offset:0 sc1 lds
    v_mfma_f32_16x16x32_bf16 v[80:83], a[76:79], a[120:123], v[80:83]
    ds_read_b64_tr_b16 a[12:13], v10 offset:8208
    v_mfma_f32_16x16x32_bf16 v[76:79], a[72:75], a[120:123], v[76:79]
    ds_read_b64_tr_b16 a[14:15], v10 offset:9232
    v_mfma_f32_16x16x32_bf16 v[76:79], a[100:103], a[124:127], v[76:79]
    v_mfma_f32_16x16x32_bf16 v[72:75], a[96:99], a[124:127], v[72:75]
    ds_read_b64_tr_b16 a[16:17], v11 offset:8208
    v_mfma_f32_16x16x32_bf16 v[72:75], a[68:71], a[120:123], v[72:75]
    ds_read_b64_tr_b16 a[18:19], v11 offset:9232
    v_mfma_f32_16x16x32_bf16 v[68:71], a[64:67], a[120:123], v[68:71]
    buffer_load_dwordx4 v3, s[12:15], s40 offen offset:1024 sc1 lds
    v_mfma_f32_16x16x32_bf16 v[68:71], a[92:95], a[124:127], v[68:71]
    ds_read_b64_tr_b16 a[20:21], v12 offset:8208
    v_mfma_f32_16x16x32_bf16 v[64:67], a[88:91], a[124:127], v[64:67]
    ds_read_b64_tr_b16 a[22:23], v12 offset:9232
    v_mfma_f32_16x16x32_bf16 v[64:67], a[60:63], a[120:123], v[64:67]
    v_mfma_f32_16x16x32_bf16 v[60:63], a[56:59], a[120:123], v[60:63]
    ds_read_b64_tr_b16 a[24:25], v13 offset:0
    v_mfma_f32_16x16x32_bf16 v[60:63], a[84:87], a[124:127], v[60:63]
    ds_read_b64_tr_b16 a[26:27], v13 offset:1024
    v_mfma_f32_16x16x32_bf16 v[88:91], a[56:59], a[128:131], v[88:91]
    buffer_load_dwordx4 v3, s[12:15], s40 offen offset:2048 sc1 lds
    v_mfma_f32_16x16x32_bf16 v[88:91], a[84:87], a[132:135], v[88:91]
    ds_read_b64_tr_b16 a[28:29], v10 offset:33024
    v_mfma_f32_16x16x32_bf16 v[92:95], a[88:91], a[132:135], v[92:95]
    ds_read_b64_tr_b16 a[30:31], v10 offset:34048
    v_mfma_f32_16x16x32_bf16 v[92:95], a[60:63], a[128:131], v[92:95]
    v_mfma_f32_16x16x32_bf16 v[96:99], a[64:67], a[128:131], v[96:99]
    ds_read_b64_tr_b16 a[32:33], v11 offset:33024
    v_mfma_f32_16x16x32_bf16 v[96:99], a[92:95], a[132:135], v[96:99]
    ds_read_b64_tr_b16 a[34:35], v11 offset:34048
    v_mfma_f32_16x16x32_bf16 v[100:103], a[96:99], a[132:135], v[100:103]
    buffer_load_dwordx4 v3, s[12:15], s40 offen offset:3072 sc1 lds
    v_mfma_f32_16x16x32_bf16 v[100:103], a[68:71], a[128:131], v[100:103]
    ds_read_b64_tr_b16 a[36:37], v12 offset:33024
    s_add_u32 s40, s40, 16384
    v_mfma_f32_16x16x32_bf16 v[104:107], a[72:75], a[128:131], v[104:107]
    ds_read_b64_tr_b16 a[38:39], v12 offset:34048
    v_mfma_f32_16x16x32_bf16 v[104:107], a[100:103], a[132:135], v[104:107]
    v_mfma_f32_16x16x32_bf16 v[108:111], a[104:107], a[132:135], v[108:111]
    ds_read_b64_tr_b16 a[40:41], v10 offset:41232
    v_mfma_f32_16x16x32_bf16 v[108:111], a[76:79], a[128:131], v[108:111]
    ds_read_b64_tr_b16 a[42:43], v10 offset:42256
    s_add_u32 m0, s42, 99072
    v_mfma_f32_16x16x32_bf16 v[112:115], a[80:83], a[128:131], v[112:115]
    buffer_load_dwordx4 v3, s[12:15], s40 offen offset:0 sc1 lds
    v_mfma_f32_16x16x32_bf16 v[112:115], a[108:111], a[132:135], v[112:115]
    ds_read_b64_tr_b16 a[44:45], v11 offset:41232
    v_mfma_f32_16x16x32_bf16 v[140:143], a[80:83], a[136:139], v[140:143]
    ds_read_b64_tr_b16 a[46:47], v11 offset:42256
    v_mfma_f32_16x16x32_bf16 v[140:143], a[108:111], a[140:143], v[140:143]
    v_mfma_f32_16x16x32_bf16 v[136:139], a[104:107], a[140:143], v[136:139]
    ds_read_b64_tr_b16 a[48:49], v12 offset:41232
    v_mfma_f32_16x16x32_bf16 v[136:139], a[76:79], a[136:139], v[136:139]
    ds_read_b64_tr_b16 a[50:51], v12 offset:42256
    v_mfma_f32_16x16x32_bf16 v[132:135], a[72:75], a[136:139], v[132:135]
    buffer_load_dwordx4 v3, s[12:15], s40 offen offset:1024 sc1 lds
    v_mfma_f32_16x16x32_bf16 v[132:135], a[100:103], a[140:143], v[132:135]
    ds_read_b64_tr_b16 a[52:53], v13 offset:33024
    v_mfma_f32_16x16x32_bf16 v[128:131], a[96:99], a[140:143], v[128:131]
    ds_read_b64_tr_b16 a[54:55], v13 offset:34048
    v_mfma_f32_16x16x32_bf16 v[128:131], a[68:71], a[136:139], v[128:131]
    v_mfma_f32_16x16x32_bf16 v[124:127], a[64:67], a[136:139], v[124:127]
    v_mfma_f32_16x16x32_bf16 v[124:127], a[92:95], a[140:143], v[124:127]
    v_mfma_f32_16x16x32_bf16 v[120:123], a[88:91], a[140:143], v[120:123]
    buffer_load_dwordx4 v3, s[12:15], s40 offen offset:2048 sc1 lds
    v_mfma_f32_16x16x32_bf16 v[120:123], a[60:63], a[136:139], v[120:123]
    v_mfma_f32_16x16x32_bf16 v[116:119], a[56:59], a[136:139], v[116:119]
    v_mfma_f32_16x16x32_bf16 v[116:119], a[84:87], a[140:143], v[116:119]
    v_mfma_f32_16x16x32_bf16 v[144:147], a[56:59], a[144:147], v[144:147]
    v_mfma_f32_16x16x32_bf16 v[144:147], a[84:87], a[148:151], v[144:147]
    v_mfma_f32_16x16x32_bf16 v[148:151], a[88:91], a[148:151], v[148:151]
    buffer_load_dwordx4 v3, s[12:15], s40 offen offset:3072 sc1 lds
    v_mfma_f32_16x16x32_bf16 v[148:151], a[60:63], a[144:147], v[148:151]
    s_add_u32 s40, s40, 16384
    v_mfma_f32_16x16x32_bf16 v[152:155], a[64:67], a[144:147], v[152:155]
iw_d3:
    s_cbranch_execz iw_d6
    v_mfma_f32_16x16x32_bf16 v[152:155], a[92:95], a[148:151], v[152:155]
    v_mfma_f32_16x16x32_bf16 v[156:159], a[96:99], a[148:151], v[156:159]
    s_waitcnt vmcnt(16) lgkmcnt(0)
    v_mfma_f32_16x16x32_bf16 v[156:159], a[68:71], a[144:147], v[156:159]
    s_barrier
    v_mfma_f32_16x16x32_bf16 v[160:163], a[72:75], a[144:147], v[160:163]
    v_mfma_f32_16x16x32_bf16 v[160:163], a[100:103], a[148:151], v[160:163]
    ds_read_b128 a[112:115], v8 offset:0
    v_mfma_f32_16x16x32_bf16 v[164:167], a[104:107], a[148:151], v[164:167]
    ds_read_b128 a[116:119], v8 offset:33024
    s_add_u32 m0, s43, 0
    v_mfma_f32_16x16x32_bf16 v[164:167], a[76:79], a[144:147], v[164:167]
    buffer_load_dwordx4 v19, s[8:11], s41 offen offset:0 lds
    v_mfma_f32_16x16x32_bf16 v[168:171], a[80:83], a[144:147], v[168:171]
    ds_read_b128 a[120:123], v8 offset:1024
    v_mfma_f32_16x16x32_bf16 v[168:171], a[108:111], a[148:151], v[168:171]
    ds_read_b128 a[124:127], v8 offset:34048
    v_mfma_f32_16x16x32_bf16 v[196:199], a[80:83], a[152:155], v[196:199]
    v_mfma_f32_16x16x32_bf16 v[196:199], a[108:111], a[156:159], v[196:199]
    ds_read_b128 a[128:131], v8 offset:2048
    v_mfma_f32_16x16x32_bf16 v[192:195], a[104:107], a[156:159], v[192:195]
    ds_read_b128 a[132:135], v8 offset:35072
    buffer_load_dwordx4 v20, s[8:11], s41 offen offset:1024 lds
    v_mfma_f32_16x16x32_bf16 v[192:195], a[76:79], a[152:155], v[192:195]
    v_mfma_f32_16x16x32_bf16 v[188:191], a[72:75], a[152:155], v[188:191]
    ds_read_b128 a[136:139], v8 offset:3072
    v_mfma_f32_16x16x32_bf16 v[188:191], a[100:103], a[156:159], v[188:191]
    ds_read_b128 a[140:143], v8 offset:36096
    v_mfma_f32_16x16x32_bf16 v[184:187], a[96:99], a[156:159], v[184:187]
    v_mfma_f32_16x16x32_bf16 v[184:187], a[68:71], a[152:155], v[184:187]
    ds_read_b128 a[144:147], v8 offset:4096
    buffer_load_dwordx4 v21, s[8:11], s41 offen offset:2048 lds
    v_mfma_f32_16x16x32_bf16 v[180:183], a[64:67], a[152:155], v[180:183]
    ds_read_b128 a[148:151], v8 offset:37120
    v_mfma_f32_16x16x32_bf16 v[180:183], a[92:95], a[156:159], v[180:183]
    v_mfma_f32_16x16x32_bf16 v[176:179], a[88:91], a[156:159], v[176:179]
    v_mfma_f32_16x16x32_bf16 v[176:179], a[60:63], a[152:155], v[176:179]
    v_mfma_f32_16x16x32_bf16 v[172:175], a[56:59], a[152:155], v[172:175]
    buffer_load_dwordx4 v22, s[8:11], s41 offen offset:3072 lds
    v_mfma_f32_16x16x32_bf16 v[172:175], a[84:87], a[156:159], v[172:175]
    ds_read_b128 a[152:155], v8 offset:5120
    s_add_u32 s41, s41, 229376
    v_mfma_f32_16x16x32_bf16 v[200:203], a[56:59], a[160:163], v[200:203]
    ds_read_b128 a[156:159], v8 offset:38144
    v_mfma_f32_16x16x32_bf16 v[200:203], a[84:87], a[164:167], v[200:203]
    v_mfma_f32_16x16x32_bf16 v[204:207], a[88:91], a[164:167], v[204:207]
    s_add_u32 m0, s43, 33024
    v_mfma_f32_16x16x32_bf16 v[204:207], a[60:63], a[160:163], v[204:207]
    buffer_load_dwordx4 v19, s[8:11], s41 offen offset:0 lds
    v_mfma_f32_16x16x32_bf16 v[208:211], a[64:67], a[160:163], v[208:211]
    v_mfma_f32_16x16x32_bf16 v[208:211], a[92:95], a[164:167], v[208:211]
    v_mfma_f32_16x16x32_bf16 v[212:215], a[96:99], a[164:167], v[212:215]
    v_mfma_f32_16x16x32_bf16 v[212:215], a[68:71], a[160:163], v[212:215]
    v_mfma_f32_16x16x32_bf16 v[216:219], a[72:75], a[160:163], v[216:219]
    buffer_load_dwordx4 v20, s[8:11], s41 offen offset:1024 lds
    v_mfma_f32_16x16x32_bf16 v[216:219], a[100:103], a[164:167], v[216:219]
    v_mfma_f32_16x16x32_bf16 v[220:223], a[104:107], a[164:167], v[220:223]
    v_mfma_f32_16x16x32_bf16 v[220:223], a[76:79], a[160:163], v[220:223]
    v_mfma_f32_16x16x32_bf16 v[224:227], a[80:83], a[160:163], v[224:227]
    v_mfma_f32_16x16x32_bf16 v[224:227], a[108:111], a[164:167], v[224:227]
    ds_read_b128 a[160:163], v8 offset:6144
    buffer_load_dwordx4 v21, s[8:11], s41 offen offset:2048 lds
    v_mfma_f32_16x16x32_bf16 v[252:255], a[80:83], a[168:171], v[252:255]
    ds_read_b128 a[164:167], v8 offset:39168
    v_mfma_f32_16x16x32_bf16 v[252:255], a[108:111], a[172:175], v[252:255]
    v_mfma_f32_16x16x32_bf16 v[248:251], a[104:107], a[172:175], v[248:251]
    v_mfma_f32_16x16x32_bf16 v[248:251], a[76:79], a[168:171], v[248:251]
    v_mfma_f32_16x16x32_bf16 v[244:247], a[72:75], a[168:171], v[244:247]
    buffer_load_dwordx4 v22, s[8:11], s41 offen offset:3072 lds
    v_mfma_f32_16x16x32_bf16 v[244:247], a[100:103], a[172:175], v[244:247]
    s_add_u32 s41, s41, 229376
    v_mfma_f32_16x16x32_bf16 v[240:243], a[96:99], a[172:175], v[240:243]
    v_mfma_f32_16x16x32_bf16 v[240:243], a[68:71], a[168:171], v[240:243]
    buffer_load_dword v27, v18, s[8:11], 0 offen
    v_mfma_f32_16x16x32_bf16 v[236:239], a[64:67], a[168:171], v[236:239]
    v_add_u32 v18, 917504, v18
    v_mfma_f32_16x16x32_bf16 v[236:239], a[92:95], a[172:175], v[236:239]
    v_mfma_f32_16x16x32_bf16 v[232:235], a[88:91], a[172:175], v[232:235]
    v_mfma_f32_16x16x32_bf16 v[232:235], a[60:63], a[168:171], v[232:235]
    v_mfma_f32_16x16x32_bf16 v[228:231], a[56:59], a[168:171], v[228:231]
    ds_read_b128 a[168:171], v8 offset:7168
    v_mfma_f32_16x16x32_bf16 v[228:231], a[84:87], a[172:175], v[228:231]
    ds_read_b128 a[172:175], v8 offset:40192
interl_g1l45:
    s_waitcnt lgkmcnt(2)
    v_mfma_f32_16x16x32_bf16 v[32:35], a[0:3], a[112:115], v[32:35]
    v_mfma_f32_16x16x32_bf16 v[32:35], a[28:31], a[116:119], v[32:35]
    v_mfma_f32_16x16x32_bf16 v[36:39], a[32:35], a[116:119], v[36:39]
    s_sub_u32 s47, s47, 1
    v_mfma_f32_16x16x32_bf16 v[36:39], a[4:7], a[112:115], v[36:39]
    v_mfma_f32_16x16x32_bf16 v[40:43], a[8:11], a[112:115], v[40:43]
    v_mfma_f32_16x16x32_bf16 v[40:43], a[36:39], a[116:119], v[40:43]
    v_mfma_f32_16x16x32_bf16 v[44:47], a[40:43], a[116:119], v[44:47]
    s_waitcnt vmcnt(17) lgkmcnt(0)
    v_mfma_f32_16x16x32_bf16 v[44:47], a[12:15], a[112:115], v[44:47]
    s_barrier
    v_mfma_f32_16x16x32_bf16 v[48:51], a[16:19], a[112:115], v[48:51]
    ds_read_b64_tr_b16 a[56:57], v14 offset:0
    v_mfma_f32_16x16x32_bf16 v[48:51], a[44:47], a[116:119], v[48:51]
    ds_read_b64_tr_b16 a[58:59], v14 offset:1024
    v_mfma_f32_16x16x32_bf16 v[52:55], a[48:51], a[116:119], v[52:55]
    v_mfma_f32_16x16x32_bf16 v[52:55], a[20:23], a[112:115], v[52:55]
    ds_read_b64_tr_b16 a[60:61], v15 offset:0
    v_mfma_f32_16x16x32_bf16 v[56:59], a[24:27], a[112:115], v[56:59]
    ds_read_b64_tr_b16 a[62:63], v15 offset:1024
    v_mfma_f32_16x16x32_bf16 v[56:59], a[52:55], a[116:119], v[56:59]
    v_mfma_f32_16x16x32_bf16 v[84:87], a[24:27], a[120:123], v[84:87]
    ds_read_b64_tr_b16 a[64:65], v16 offset:0
    v_mfma_f32_16x16x32_bf16 v[84:87], a[52:55], a[124:127], v[84:87]
    ds_read_b64_tr_b16 a[66:67], v16 offset:1024
    s_add_u32 m0, s42, 0
    v_mfma_f32_16x16x32_bf16 v[80:83], a[48:51], a[124:127], v[80:83]
    buffer_load_dwordx4 v3, s[12:15], s40 offen offset:0 sc1 lds
    v_mfma_f32_16x16x32_bf16 v[80:83], a[20:23], a[120:123], v[80:83]
    ds_read_b64_tr_b16 a[68:69], v14 offset:8208
    v_mfma_f32_16x16x32_bf16 v[76:79], a[16:19], a[120:123], v[76:79]
    ds_read_b64_tr_b16 a[70:71], v14 offset:9232
    v_mfma_f32_16x16x32_bf16 v[76:79], a[44:47], a[124:127], v[76:79]
    v_mfma_f32_16x16x32_bf16 v[72:75], a[40:43], a[124:127], v[72:75]
    ds_read_b64_tr_b16 a[72:73], v15 offset:8208
    v_mfma_f32_16x16x32_bf16 v[72:75], a[12:15], a[120:123], v[72:75]
    ds_read_b64_tr_b16 a[74:75], v15 offset:9232
    v_mfma_f32_16x16x32_bf16 v[68:71], a[8:11], a[120:123], v[68:71]
    buffer_load_dwordx4 v3, s[12:15], s40 offen offset:1024 sc1 lds
    v_mfma_f32_16x16x32_bf16 v[68:71], a[36:39], a[124:127], v[68:71]
    ds_read_b64_tr_b16 a[76:77], v16 offset:8208
    v_mfma_f32_16x16x32_bf16 v[64:67], a[32:35], a[124:127], v[64:67]
    ds_read_b64_tr_b16 a[78:79], v16 offset:9232
    v_mfma_f32_16x16x32_bf16 v[64:67], a[4:7], a[120:123], v[64:67]
iw_c4:
    s_cbranch_execz iw_c7
    v_mfma_f32_16x16x32_bf16 v[60:63], a[0:3], a[120:123], v[60:63]
    ds_read_b64_tr_b16 a[80:81], v17 offset:0
    v_mfma_f32_16x16x32_bf16 v[60:63], a[28:31], a[124:127], v[60:63]
    ds_read_b64_tr_b16 a[82:83], v17 offset:1024
    v_mfma_f32_16x16x32_bf16 v[88:91], a[0:3], a[128:131], v[88:91]
    buffer_load_dwordx4 v3, s[12:15], s40 offen offset:2048 sc1 lds
    v_mfma_f32_16x16x32_bf16 v[88:91], a[28:31], a[132:135], v[88:91]
    ds_read_b64_tr_b16 a[84:85], v14 offset:33024
    v_mfma_f32_16x16x32_bf16 v[92:95], a[32:35], a[132:135], v[92:95]
    ds_read_b64_tr_b16 a[86:87], v14 offset:34048
    v_mfma_f32_16x16x32_bf16 v[92:95], a[4:7], a[128:131], v[92:95]
    v_mfma_f32_16x16x32_bf16 v[96:99], a[8:11], a[128:131], v[96:99]
    ds_read_b64_tr_b16 a[88:89], v15 offset:33024
    v_mfma_f32_16x16x32_bf16 v[96:99], a[36:39], a[132:135], v[96:99]
    ds_read_b64_tr_b16 a[90:91], v15 offset:34048
    v_mfma_f32_16x16x32_bf16 v[100:103], a[40:43], a[132:135], v[100:103]
    buffer_load_dwordx4 v3, s[12:15], s40 offen offset:3072 sc1 lds
    v_mfma_f32_16x16x32_bf16 v[100:103], a[12:15], a[128:131], v[100:103]
    ds_read_b64_tr_b16 a[92:93], v16 offset:33024
    s_add_u32 s40, s40, 16384
    v_mfma_f32_16x16x32_bf16 v[104:107], a[16:19], a[128:131], v[104:107]
    ds_read_b64_tr_b16 a[94:95], v16 offset:34048
    v_mfma_f32_16x16x32_bf16 v[104:107], a[44:47], a[132:135], v[104:107]
    v_mfma_f32_16x16x32_bf16 v[108:111], a[48:51], a[132:135], v[108:111]
    ds_read_b64_tr_b16 a[96:97], v14 offset:41232
    v_mfma_f32_16x16x32_bf16 v[108:111], a[20:23], a[128:131], v[108:111]
    ds_read_b64_tr_b16 a[98:99], v14 offset:42256
    s_add_u32 m0, s42, 33024
    v_mfma_f32_16x16x32_bf16 v[112:115], a[24:27], a[128:131], v[112:115]
    buffer_load_dwordx4 v3, s[12:15], s40 offen offset:0 sc1 lds
    v_mfma_f32_16x16x32_bf16 v[112:115], a[52:55], a[132:135], v[112:115]
    ds_read_b64_tr_b16 a[100:101], v15 offset:41232
    v_mfma_f32_16x16x32_bf16 v[140:143], a[24:27], a[136:139], v[140:143]
    ds_read_b64_tr_b16 a[102:103], v15 offset:42256
    v_mfma_f32_16x16x32_bf16 v[140:143], a[52:55], a[140:143], v[140:143]
    v_mfma_f32_16x16x32_bf16 v[136:139], a[48:51], a[140:143], v[136:139]
    ds_read_b64_tr_b16 a[104:105], v16 offset:41232
    v_mfma_f32_16x16x32_bf16 v[136:139], a[20:23], a[136:139], v[136:139]
    ds_read_b64_tr_b16 a[106:107], v16 offset:42256
    v_mfma_f32_16x16x32_bf16 v[132:135], a[16:19], a[136:139], v[132:135]
    buffer_load_dwordx4 v3, s[12:15], s40 offen offset:1024 sc1 lds
    v_mfma_f32_16x16x32_bf16 v[132:135], a[44:47], a[140:143], v[132:135]
    ds_read_b64_tr_b16 a[108:109], v17 offset:33024
    v_mfma_f32_16x16x32_bf16 v[128:131], a[40:43], a[140:143], v[128:131]
    ds_read_b64_tr_b16 a[110:111], v17 offset:34048
    v_mfma_f32_16x16x32_bf16 v[128:131], a[12:15], a[136:139], v[128:131]
    v_mfma_f32_16x16x32_bf16 v[124:127], a[8:11], a[136:139], v[124:127]
    v_mfma_f32_16x16x32_bf16 v[124:127], a[36:39], a[140:143], v[124:127]
    v_mfma_f32_16x16x32_bf16 v[120:123], a[32:35], a[140:143], v[120:123]
    buffer_load_dwordx4 v3, s[12:15], s40 offen offset:2048 sc1 lds
    v_mfma_f32_16x16x32_bf16 v[120:123], a[4:7], a[136:139], v[120:123]
    v_mfma_f32_16x16x32_bf16 v[116:119], a[0:3], a[136:139], v[116:119]
    v_mfma_f32_16x16x32_bf16 v[116:119], a[28:31], a[140:143], v[116:119]
    v_mfma_f32_16x16x32_bf16 v[144:147], a[0:3], a[144:147], v[144:147]
    v_mfma_f32_16x16x32_bf16 v[144:147], a[28:31], a[148:151], v[144:147]
    v_mfma_f32_16x16x32_bf16 v[148:151], a[32:35], a[148:151], v[148:151]
    buffer_load_dwordx4 v3, s[12:15], s40 offen offset:3072 sc1 lds
    v_mfma_f32_16x16x32_bf16 v[148:151], a[4:7], a[144:147], v[148:151]
    s_add_u32 s40, s40, 16384
    v_mfma_f32_16x16x32_bf16 v[152:155], a[8:11], a[144:147], v[152:155]
    v_mfma_f32_16x16x32_bf16 v[152:155], a[36:39], a[148:151], v[152:155]
    s_cmp_eq_u32 s47, s49
    v_mfma_f32_16x16x32_bf16 v[156:159], a[40:43], a[148:151], v[156:159]
    s_waitcnt vmcnt(17) lgkmcnt(0)
    v_mfma_f32_16x16x32_bf16 v[156:159], a[12:15], a[144:147], v[156:159]
    s_barrier
    v_mfma_f32_16x16x32_bf16 v[160:163], a[16:19], a[144:147], v[160:163]
    s_cbranch_scc1 interl_g1s52
interl_g1t53:
    v_mfma_f32_16x16x32_bf16 v[160:163], a[44:47], a[148:151], v[160:163]
    ds_read_b128 a[112:115], v9 offset:0
    v_mfma_f32_16x16x32_bf16 v[164:167], a[48:51], a[148:151], v[164:167]
    ds_read_b128 a[116:119], v9 offset:33024
    s_add_u32 m0, s43, 66048
    v_mfma_f32_16x16x32_bf16 v[164:167], a[20:23], a[144:147], v[164:167]
    buffer_load_dwordx4 v19, s[8:11], s41 offen offset:0 lds
    v_mfma_f32_16x16x32_bf16 v[168:171], a[24:27], a[144:147], v[168:171]
    ds_read_b128 a[120:123], v9 offset:1024
    v_mfma_f32_16x16x32_bf16 v[168:171], a[52:55], a[148:151], v[168:171]
    ds_read_b128 a[124:127], v9 offset:34048
    v_mfma_f32_16x16x32_bf16 v[196:199], a[24:27], a[152:155], v[196:199]
    v_mfma_f32_16x16x32_bf16 v[196:199], a[52:55], a[156:159], v[196:199]
    ds_read_b128 a[128:131], v9 offset:2048
    v_mfma_f32_16x16x32_bf16 v[192:195], a[48:51], a[156:159], v[192:195]
    ds_read_b128 a[132:135], v9 offset:35072
    buffer_load_dwordx4 v20, s[8:11], s41 offen offset:1024 lds
    v_mfma_f32_16x16x32_bf16 v[192:195], a[20:23], a[152:155], v[192:195]
    v_mfma_f32_16x16x32_bf16 v[188:191], a[16:19], a[152:155], v[188:191]
    ds_read_b128 a[136:139], v9 offset:3072
    v_mfma_f32_16x16x32_bf16 v[188:191], a[44:47], a[156:159], v[188:191]
    ds_read_b128 a[140:143], v9 offset:36096
    v_mfma_f32_16x16x32_bf16 v[184:187], a[40:43], a[156:159], v[184:187]
    v_mfma_f32_16x16x32_bf16 v[184:187], a[12:15], a[152:155], v[184:187]
    ds_read_b128 a[144:147], v9 offset:4096
    buffer_load_dwordx4 v21, s[8:11], s41 offen offset:2048 lds
    v_mfma_f32_16x16x32_bf16 v[180:183], a[8:11], a[152:155], v[180:183]
    ds_read_b128 a[148:151], v9 offset:37120
    v_mfma_f32_16x16x32_bf16 v[180:183], a[36:39], a[156:159], v[180:183]
    v_mfma_f32_16x16x32_bf16 v[176:179], a[32:35], a[156:159], v[176:179]
    v_mfma_f32_16x16x32_bf16 v[176:179], a[4:7], a[152:155], v[176:179]
    v_mfma_f32_16x16x32_bf16 v[172:175], a[0:3], a[152:155], v[172:175]
    buffer_load_dwordx4 v22, s[8:11], s41 offen offset:3072 lds
    v_mfma_f32_16x16x32_bf16 v[172:175], a[28:31], a[156:159], v[172:175]
    ds_read_b128 a[152:155], v9 offset:5120
    s_add_u32 s41, s41, 229376
    v_mfma_f32_16x16x32_bf16 v[200:203], a[0:3], a[160:163], v[200:203]
    ds_read_b128 a[156:159], v9 offset:38144
    v_mfma_f32_16x16x32_bf16 v[200:203], a[28:31], a[164:167], v[200:203]
    v_mfma_f32_16x16x32_bf16 v[204:207], a[32:35], a[164:167], v[204:207]
    s_add_u32 m0, s43, 99072
    v_mfma_f32_16x16x32_bf16 v[204:207], a[4:7], a[160:163], v[204:207]
    buffer_load_dwordx4 v19, s[8:11], s41 offen offset:0 lds
    v_mfma_f32_16x16x32_bf16 v[208:211], a[8:11], a[160:163], v[208:211]
    v_mfma_f32_16x16x32_bf16 v[208:211], a[36:39], a[164:167], v[208:211]
    v_mfma_f32_16x16x32_bf16 v[212:215], a[40:43], a[164:167], v[212:215]
    v_mfma_f32_16x16x32_bf16 v[212:215], a[12:15], a[160:163], v[212:215]
    v_mfma_f32_16x16x32_bf16 v[216:219], a[16:19], a[160:163], v[216:219]
    buffer_load_dwordx4 v20, s[8:11], s41 offen offset:1024 lds
    v_mfma_f32_16x16x32_bf16 v[216:219], a[44:47], a[164:167], v[216:219]
    v_mfma_f32_16x16x32_bf16 v[220:223], a[48:51], a[164:167], v[220:223]
    v_mfma_f32_16x16x32_bf16 v[220:223], a[20:23], a[160:163], v[220:223]
    v_mfma_f32_16x16x32_bf16 v[224:227], a[24:27], a[160:163], v[224:227]
    v_mfma_f32_16x16x32_bf16 v[224:227], a[52:55], a[164:167], v[224:227]
    ds_read_b128 a[160:163], v9 offset:6144
    buffer_load_dwordx4 v21, s[8:11], s41 offen offset:2048 lds
    v_mfma_f32_16x16x32_bf16 v[252:255], a[24:27], a[168:171], v[252:255]
    ds_read_b128 a[164:167], v9 offset:39168
    v_mfma_f32_16x16x32_bf16 v[252:255], a[52:55], a[172:175], v[252:255]
    v_mfma_f32_16x16x32_bf16 v[248:251], a[48:51], a[172:175], v[248:251]
    v_mfma_f32_16x16x32_bf16 v[248:251], a[20:23], a[168:171], v[248:251]
    v_mfma_f32_16x16x32_bf16 v[244:247], a[16:19], a[168:171], v[244:247]
    buffer_load_dwordx4 v22, s[8:11], s41 offen offset:3072 lds
    v_mfma_f32_16x16x32_bf16 v[244:247], a[44:47], a[172:175], v[244:247]
    s_add_u32 s41, s41, 229376
    v_mfma_f32_16x16x32_bf16 v[240:243], a[40:43], a[172:175], v[240:243]
iw_d4:
    s_cbranch_execz iw_d7
    v_mfma_f32_16x16x32_bf16 v[240:243], a[12:15], a[168:171], v[240:243]
    v_mfma_f32_16x16x32_bf16 v[236:239], a[8:11], a[168:171], v[236:239]
    v_mfma_f32_16x16x32_bf16 v[236:239], a[36:39], a[172:175], v[236:239]
    v_mfma_f32_16x16x32_bf16 v[232:235], a[32:35], a[172:175], v[232:235]
    v_mfma_f32_16x16x32_bf16 v[232:235], a[4:7], a[168:171], v[232:235]
    v_mfma_f32_16x16x32_bf16 v[228:231], a[0:3], a[168:171], v[228:231]
    ds_read_b128 a[168:171], v9 offset:7168
    s_cmp_lg_u32 s47, 0
    v_mfma_f32_16x16x32_bf16 v[228:231], a[28:31], a[172:175], v[228:231]
    ds_read_b128 a[172:175], v9 offset:40192
    s_cbranch_scc1 interl_g1m42
    s_branch interl_g1z44
interl_g1m43:
    s_waitcnt lgkmcnt(2)
    v_mfma_f32_16x16x32_bf16 v[32:35], a[56:59], a[112:115], v[32:35]
    v_mfma_f32_16x16x32_bf16 v[32:35], a[84:87], a[116:119], v[32:35]
    v_mfma_f32_16x16x32_bf16 v[36:39], a[88:91], a[116:119], v[36:39]
    v_mfma_f32_16x16x32_bf16 v[36:39], a[60:63], a[112:115], v[36:39]
    v_mfma_f32_16x16x32_bf16 v[40:43], a[64:67], a[112:115], v[40:43]
    v_mfma_f32_16x16x32_bf16 v[40:43], a[92:95], a[116:119], v[40:43]
    v_mfma_f32_16x16x32_bf16 v[44:47], a[96:99], a[116:119], v[44:47]
    s_waitcnt vmcnt(17) lgkmcnt(0)
    v_mfma_f32_16x16x32_bf16 v[44:47], a[68:71], a[112:115], v[44:47]
    s_barrier
    v_mfma_f32_16x16x32_bf16 v[48:51], a[72:75], a[112:115], v[48:51]
    ds_read_b64_tr_b16 a[0:1], v10 offset:0
    v_mfma_f32_16x16x32_bf16 v[48:51], a[100:103], a[116:119], v[48:51]
    ds_read_b64_tr_b16 a[2:3], v10 offset:1024
    v_mfma_f32_16x16x32_bf16 v[52:55], a[104:107], a[116:119], v[52:55]
    v_mfma_f32_16x16x32_bf16 v[52:55], a[76:79], a[112:115], v[52:55]
    ds_read_b64_tr_b16 a[4:5], v11 offset:0
    v_mfma_f32_16x16x32_bf16 v[56:59], a[80:83], a[112:115], v[56:59]
    ds_read_b64_tr_b16 a[6:7], v11 offset:1024
    s_add_u32 m0, s42, 66048
    v_mfma_f32_16x16x32_bf16 v[56:59], a[108:111], a[116:119], v[56:59]
    buffer_load_dwordx4 v3, s[12:15], s40 offen offset:0 sc1 lds
    v_mfma_f32_16x16x32_bf16 v[84:87], a[80:83], a[120:123], v[84:87]
    ds_read_b64_tr_b16 a[8:9], v12 offset:0
    v_mfma_f32_16x16x32_bf16 v[84:87], a[108:111], a[124:127], v[84:87]
    ds_read_b64_tr_b16 a[10:11], v12 offset:1024
    v_mfma_f32_16x16x32_bf16 v[80:83], a[104:107], a[124:127], v[80:83]
    v_mfma_f32_16x16x32_bf16 v[80:83], a[76:79], a[120:123], v[80:83]
    ds_read_b64_tr_b16 a[12:13], v10 offset:8208
    v_mfma_f32_16x16x32_bf16 v[76:79], a[72:75], a[120:123], v[76:79]
    ds_read_b64_tr_b16 a[14:15], v10 offset:9232
    v_mfma_f32_16x16x32_bf16 v[76:79], a[100:103], a[124:127], v[76:79]
    buffer_load_dwordx4 v3, s[12:15], s40 offen offset:1024 sc1 lds
    v_mfma_f32_16x16x32_bf16 v[72:75], a[96:99], a[124:127], v[72:75]
    ds_read_b64_tr_b16 a[16:17], v11 offset:8208
    v_mfma_f32_16x16x32_bf16 v[72:75], a[68:71], a[120:123], v[72:75]
    ds_read_b64_tr_b16 a[18:19], v11 offset:9232
    v_mfma_f32_16x16x32_bf16 v[68:71], a[64:67], a[120:123], v[68:71]
    v_mfma_f32_16x16x32_bf16 v[68:71], a[92:95], a[124:127], v[68:71]
    ds_read_b64_tr_b16 a[20:21], v12 offset:8208
    v_mfma_f32_16x16x32_bf16 v[64:67], a[88:91], a[124:127], v[64:67]
    ds_read_b64_tr_b16 a[22:23], v12 offset:9232
    v_mfma_f32_16x16x32_bf16 v[64:67], a[60:63], a[120:123], v[64:67]
    buffer_load_dwordx4 v3, s[12:15], s40 offen offset:2048 sc1 lds
    v_mfma_f32_16x16x32_bf16 v[60:63], a[56:59], a[120:123], v[60:63]
    ds_read_b64_tr_b16 a[24:25], v13 offset:0
    v_mfma_f32_16x16x32_bf16 v[60:63], a[84:87], a[124:127], v[60:63]
    ds_read_b64_tr_b16 a[26:27], v13 offset:1024
    v_mfma_f32_16x16x32_bf16 v[88:91], a[56:59], a[128:131], v[88:91]
    v_mfma_f32_16x16x32_bf16 v[88:91], a[84:87], a[132:135], v[88:91]
    ds_read_b64_tr_b16 a[28:29], v10 offset:33024
    v_mfma_f32_16x16x32_bf16 v[92:95], a[88:91], a[132:135], v[92:95]
    ds_read_b64_tr_b16 a[30:31], v10 offset:34048
    v_mfma_f32_16x16x32_bf16 v[92:95], a[60:63], a[128:131], v[92:95]
    buffer_load_dwordx4 v3, s[12:15], s40 offen offset:3072 sc1 lds
    v_mfma_f32_16x16x32_bf16 v[96:99], a[64:67], a[128:131], v[96:99]
    ds_read_b64_tr_b16 a[32:33], v11 offset:33024
    s_add_u32 s40, s40, 16384
    v_mfma_f32_16x16x32_bf16 v[96:99], a[92:95], a[132:135], v[96:99]
    ds_read_b64_tr_b16 a[34:35], v11 offset:34048
    v_mfma_f32_16x16x32_bf16 v[100:103], a[96:99], a[132:135], v[100:103]
    v_mfma_f32_16x16x32_bf16 v[100:103], a[68:71], a[128:131], v[100:103]
    ds_read_b64_tr_b16 a[36:37], v12 offset:33024
    v_mfma_f32_16x16x32_bf16 v[104:107], a[72:75], a[128:131], v[104:107]
    ds_read_b64_tr_b16 a[38:39], v12 offset:34048
    s_add_u32 m0, s42, 99072
    v_mfma_f32_16x16x32_bf16 v[104:107], a[100:103], a[132:135], v[104:107]
    buffer_load_dwordx4 v3, s[12:15], s40 offen offset:0 sc1 lds
    v_mfma_f32_16x16x32_bf16 v[108:111], a[104:107], a[132:135], v[108:111]
    ds_read_b64_tr_b16 a[40:41], v10 offset:41232
    v_mfma_f32_16x16x32_bf16 v[108:111], a[76:79], a[128:131], v[108:111]
    ds_read_b64_tr_b16 a[42:43], v10 offset:42256
    v_mfma_f32_16x16x32_bf16 v[112:115], a[80:83], a[128:131], v[112:115]
    v_mfma_f32_16x16x32_bf16 v[112:115], a[108:111], a[132:135], v[112:115]
    ds_read_b64_tr_b16 a[44:45], v11 offset:41232
    v_mfma_f32_16x16x32_bf16 v[140:143], a[80:83], a[136:139], v[140:143]
    ds_read_b64_tr_b16 a[46:47], v11 offset:42256
    v_mfma_f32_16x16x32_bf16 v[140:143], a[108:111], a[140:143], v[140:143]
    buffer_load_dwordx4 v3, s[12:15], s40 offen offset:1024 sc1 lds
    v_mfma_f32_16x16x32_bf16 v[136:139], a[104:107], a[140:143], v[136:139]
    ds_read_b64_tr_b16 a[48:49], v12 offset:41232
    v_mfma_f32_16x16x32_bf16 v[136:139], a[76:79], a[136:139], v[136:139]
    ds_read_b64_tr_b16 a[50:51], v12 offset:42256
    v_mfma_f32_16x16x32_bf16 v[132:135], a[72:75], a[136:139], v[132:135]
    v_mfma_f32_16x16x32_bf16 v[132:135], a[100:103], a[140:143], v[132:135]
    ds_read_b64_tr_b16 a[52:53], v13 offset:33024
    v_mfma_f32_16x16x32_bf16 v[128:131], a[96:99], a[140:143], v[128:131]
    ds_read_b64_tr_b16 a[54:55], v13 offset:34048
    v_mfma_f32_16x16x32_bf16 v[128:131], a[68:71], a[136:139], v[128:131]
    buffer_load_dwordx4 v3, s[12:15], s40 offen offset:2048 sc1 lds
    v_mfma_f32_16x16x32_bf16 v[124:127], a[64:67], a[136:139], v[124:127]
    v_mfma_f32_16x16x32_bf16 v[124:127], a[92:95], a[140:143], v[124:127]
    v_mfma_f32_16x16x32_bf16 v[120:123], a[88:91], a[140:143], v[120:123]
    v_mfma_f32_16x16x32_bf16 v[120:123], a[60:63], a[136:139], v[120:123]
    v_mfma_f32_16x16x32_bf16 v[116:119], a[56:59], a[136:139], v[116:119]
    v_mfma_f32_16x16x32_bf16 v[116:119], a[84:87], a[140:143], v[116:119]
    buffer_load_dwordx4 v3, s[12:15], s40 offen offset:3072 sc1 lds
    v_mfma_f32_16x16x32_bf16 v[144:147], a[56:59], a[144:147], v[144:147]
    s_add_u32 s40, s40, 16384
    v_mfma_f32_16x16x32_bf16 v[144:147], a[84:87], a[148:151], v[144:147]
    v_mfma_f32_16x16x32_bf16 v[148:151], a[88:91], a[148:151], v[148:151]
    v_mfma_f32_16x16x32_bf16 v[148:151], a[60:63], a[144:147], v[148:151]
    v_mfma_f32_16x16x32_bf16 v[152:155], a[64:67], a[144:147], v[152:155]
    v_mfma_f32_16x16x32_bf16 v[152:155], a[92:95], a[148:151], v[152:155]
    v_mfma_f32_16x16x32_bf16 v[156:159], a[96:99], a[148:151], v[156:159]
    s_waitcnt vmcnt(16) lgkmcnt(0)
    v_mfma_f32_16x16x32_bf16 v[156:159], a[68:71], a[144:147], v[156:159]
    s_barrier
    v_mfma_f32_16x16x32_bf16 v[160:163], a[72:75], a[144:147], v[160:163]
    v_mfma_f32_16x16x32_bf16 v[160:163], a[100:103], a[148:151], v[160:163]
    ds_read_b128 a[112:115], v8 offset:0
    v_mfma_f32_16x16x32_bf16 v[164:167], a[104:107], a[148:151], v[164:167]
    ds_read_b128 a[116:119], v8 offset:33024
    v_mfma_f32_16x16x32_bf16 v[164:167], a[76:79], a[144:147], v[164:167]
iw_c5:
    s_cbranch_execz iw_c8
    v_mfma_f32_16x16x32_bf16 v[168:171], a[80:83], a[144:147], v[168:171]
    ds_read_b128 a[120:123], v8 offset:1024
    v_mfma_f32_16x16x32_bf16 v[168:171], a[108:111], a[148:151], v[168:171]
    ds_read_b128 a[124:127], v8 offset:34048
    s_add_u32 m0, s43, 0
    v_mfma_f32_16x16x32_bf16 v[196:199], a[80:83], a[152:155], v[196:199]
    buffer_load_dwordx4 v19, s[8:11], s41 offen offset:0 lds
    v_mfma_f32_16x16x32_bf16 v[196:199], a[108:111], a[156:159], v[196:199]
    ds_read_b128 a[128:131], v8 offset:2048
    v_mfma_f32_16x16x32_bf16 v[192:195], a[104:107], a[156:159], v[192:195]
    ds_read_b128 a[132:135], v8 offset:35072
    v_mfma_f32_16x16x32_bf16 v[192:195], a[76:79], a[152:155], v[192:195]
    v_mfma_f32_16x16x32_bf16 v[188:191], a[72:75], a[152:155], v[188:191]
    ds_read_b128 a[136:139], v8 offset:3072
    v_mfma_f32_16x16x32_bf16 v[188:191], a[100:103], a[156:159], v[188:191]
    ds_read_b128 a[140:143], v8 offset:36096
    buffer_load_dwordx4 v20, s[8:11], s41 offen offset:1024 lds
    v_mfma_f32_16x16x32_bf16 v[184:187], a[96:99], a[156:159], v[184:187]
    v_mfma_f32_16x16x32_bf16 v[184:187], a[68:71], a[152:155], v[184:187]
    ds_read_b128 a[144:147], v8 offset:4096
    v_mfma_f32_16x16x32_bf16 v[180:183], a[64:67], a[152:155], v[180:183]
    ds_read_b128 a[148:151], v8 offset:37120
    v_mfma_f32_16x16x32_bf16 v[180:183], a[92:95], a[156:159], v[180:183]
    v_mfma_f32_16x16x32_bf16 v[176:179], a[88:91], a[156:159], v[176:179]
    buffer_load_dwordx4 v21, s[8:11], s41 offen offset:2048 lds
    v_mfma_f32_16x16x32_bf16 v[176:179], a[60:63], a[152:155], v[176:179]
    v_mfma_f32_16x16x32_bf16 v[172:175], a[56:59], a[152:155], v[172:175]
    v_mfma_f32_16x16x32_bf16 v[172:175], a[84:87], a[156:159], v[172:175]
    ds_read_b128 a[152:155], v8 offset:5120
    v_mfma_f32_16x16x32_bf16 v[200:203], a[56:59], a[160:163], v[200:203]
    ds_read_b128 a[156:159], v8 offset:38144
    v_mfma_f32_16x16x32_bf16 v[200:203], a[84:87], a[164:167], v[200:203]
    buffer_load_dwordx4 v22, s[8:11], s41 offen offset:3072 lds
    v_mfma_f32_16x16x32_bf16 v[204:207], a[88:91], a[164:167], v[204:207]
    s_add_u32 s41, s41, 229376
    v_mfma_f32_16x16x32_bf16 v[204:207], a[60:63], a[160:163], v[204:207]
    v_mfma_f32_16x16x32_bf16 v[208:211], a[64:67], a[160:163], v[208:211]
    v_mfma_f32_16x16x32_bf16 v[208:211], a[92:95], a[164:167], v[208:211]
    s_add_u32 m0, s43, 33024
    v_mfma_f32_16x16x32_bf16 v[212:215], a[96:99], a[164:167], v[212:215]
    buffer_load_dwordx4 v19, s[8:11], s41 offen offset:0 lds
    v_mfma_f32_16x16x32_bf16 v[212:215], a[68:71], a[160:163], v[212:215]
    v_mfma_f32_16x16x32_bf16 v[216:219], a[72:75], a[160:163], v[216:219]
    v_mfma_f32_16x16x32_bf16 v[216:219], a[100:103], a[164:167], v[216:219]
    v_mfma_f32_16x16x32_bf16 v[220:223], a[104:107], a[164:167], v[220:223]
    v_mfma_f32_16x16x32_bf16 v[220:223], a[76:79], a[160:163], v[220:223]
    buffer_load_dwordx4 v20, s[8:11], s41 offen offset:1024 lds
    v_mfma_f32_16x16x32_bf16 v[224:227], a[80:83], a[160:163], v[224:227]
    v_mfma_f32_16x16x32_bf16 v[224:227], a[108:111], a[164:167], v[224:227]
    ds_read_b128 a[160:163], v8 offset:6144
    v_mfma_f32_16x16x32_bf16 v[252:255], a[80:83], a[168:171], v[252:255]
    ds_read_b128 a[164:167], v8 offset:39168
    v_mfma_f32_16x16x32_bf16 v[252:255], a[108:111], a[172:175], v[252:255]
    v_mfma_f32_16x16x32_bf16 v[248:251], a[104:107], a[172:175], v[248:251]
    buffer_load_dwordx4 v21, s[8:11], s41 offen offset:2048 lds
    v_mfma_f32_16x16x32_bf16 v[248:251], a[76:79], a[168:171], v[248:251]
    v_mfma_f32_16x16x32_bf16 v[244:247], a[72:75], a[168:171], v[244:247]
    v_mfma_f32_16x16x32_bf16 v[244:247], a[100:103], a[172:175], v[244:247]
    v_mfma_f32_16x16x32_bf16 v[240:243], a[96:99], a[172:175], v[240:243]
    v_mfma_f32_16x16x32_bf16 v[240:243], a[68:71], a[168:171], v[240:243]
    buffer_load_dwordx4 v22, s[8:11], s41 offen offset:3072 lds
    v_mfma_f32_16x16x32_bf16 v[236:239], a[64:67], a[168:171], v[236:239]
    s_add_u32 s41, s41, 229376
    v_mfma_f32_16x16x32_bf16 v[236:239], a[92:95], a[172:175], v[236:239]
    v_mfma_f32_16x16x32_bf16 v[232:235], a[88:91], a[172:175], v[232:235]
    buffer_load_dword v27, v18, s[8:11], 0 offen
    v_mfma_f32_16x16x32_bf16 v[232:235], a[60:63], a[168:171], v[232:235]
    v_add_u32 v18, 917504, v18
    v_mfma_f32_16x16x32_bf16 v[228:231], a[56:59], a[168:171], v[228:231]
    ds_read_b128 a[168:171], v8 offset:7168
    v_mfma_f32_16x16x32_bf16 v[228:231], a[84:87], a[172:175], v[228:231]
    ds_read_b128 a[172:175], v8 offset:40192
interl_g1l46:
    s_waitcnt lgkmcnt(2)
    v_mfma_f32_16x16x32_bf16 v[32:35], a[0:3], a[112:115], v[32:35]
    v_mfma_f32_16x16x32_bf16 v[32:35], a[28:31], a[116:119], v[32:35]
    v_mfma_f32_16x16x32_bf16 v[36:39], a[32:35], a[116:119], v[36:39]
    s_sub_u32 s47, s47, 1
    v_mfma_f32_16x16x32_bf16 v[36:39], a[4:7], a[112:115], v[36:39]
    v_mfma_f32_16x16x32_bf16 v[40:43], a[8:11], a[112:115], v[40:43]
    v_mfma_f32_16x16x32_bf16 v[40:43], a[36:39], a[116:119], v[40:43]
    v_mfma_f32_16x16x32_bf16 v[44:47], a[40:43], a[116:119], v[44:47]
    s_waitcnt vmcnt(17) lgkmcnt(0)
    v_mfma_f32_16x16x32_bf16 v[44:47], a[12:15], a[112:115], v[44:47]
    s_barrier
    v_mfma_f32_16x16x32_bf16 v[48:51], a[16:19], a[112:115], v[48:51]
    ds_read_b64_tr_b16 a[56:57], v14 offset:0
    v_mfma_f32_16x16x32_bf16 v[48:51], a[44:47], a[116:119], v[48:51]
    ds_read_b64_tr_b16 a[58:59], v14 offset:1024
    v_mfma_f32_16x16x32_bf16 v[52:55], a[48:51], a[116:119], v[52:55]
    v_mfma_f32_16x16x32_bf16 v[52:55], a[20:23], a[112:115], v[52:55]
    ds_read_b64_tr_b16 a[60:61], v15 offset:0
    v_mfma_f32_16x16x32_bf16 v[56:59], a[24:27], a[112:115], v[56:59]
    ds_read_b64_tr_b16 a[62:63], v15 offset:1024
    s_add_u32 m0, s42, 0
    v_mfma_f32_16x16x32_bf16 v[56:59], a[52:55], a[116:119], v[56:59]
    buffer_load_dwordx4 v3, s[12:15], s40 offen offset:0 sc1 lds
    v_mfma_f32_16x16x32_bf16 v[84:87], a[24:27], a[120:123], v[84:87]
    ds_read_b64_tr_b16 a[64:65], v16 offset:0
    v_mfma_f32_16x16x32_bf16 v[84:87], a[52:55], a[124:127], v[84:87]
    ds_read_b64_tr_b16 a[66:67], v16 offset:1024
    v_mfma_f32_16x16x32_bf16 v[80:83], a[48:51], a[124:127], v[80:83]
    v_mfma_f32_16x16x32_bf16 v[80:83], a[20:23], a[120:123], v[80:83]
    ds_read_b64_tr_b16 a[68:69], v14 offset:8208
    v_mfma_f32_16x16x32_bf16 v[76:79], a[16:19], a[120:123], v[76:79]
    ds_read_b64_tr_b16 a[70:71], v14 offset:9232
    v_mfma_f32_16x16x32_bf16 v[76:79], a[44:47], a[124:127], v[76:79]
    buffer_load_dwordx4 v3, s[12:15], s40 offen offset:1024 sc1 lds
    v_mfma_f32_16x16x32_bf16 v[72:75], a[40:43], a[124:127], v[72:75]
    ds_read_b64_tr_b16 a[72:73], v15 offset:8208
    v_mfma_f32_16x16x32_bf16 v[72:75], a[12:15], a[120:123], v[72:75]
    ds_read_b64_tr_b16 a[74:75], v15 offset:9232
    v_mfma_f32_16x16x32_bf16 v[68:71], a[8:11], a[120:123], v[68:71]
    v_mfma_f32_16x16x32_bf16 v[68:71], a[36:39], a[124:127], v[68:71]
    ds_read_b64_tr_b16 a[76:77], v16 offset:8208
    v_mfma_f32_16x16x32_bf16 v[64:67], a[32:35], a[124:127], v[64:67]
    ds_read_b64_tr_b16 a[78:79], v16 offset:9232
    v_mfma_f32_16x16x32_bf16 v[64:67], a[4:7], a[120:123], v[64:67]
    buffer_load_dwordx4 v3, s[12:15], s40 offen offset:2048 sc1 lds
    v_mfma_f32_16x16x32_bf16 v[60:63], a[0:3], a[120:123], v[60:63]
    ds_read_b64_tr_b16 a[80:81], v17 offset:0
    v_mfma_f32_16x16x32_bf16 v[60:63], a[28:31], a[124:127], v[60:63]
    ds_read_b64_tr_b16 a[82:83], v17 offset:1024
    v_mfma_f32_16x16x32_bf16 v[88:91], a[0:3], a[128:131], v[88:91]
    v_mfma_f32_16x16x32_bf16 v[88:91], a[28:31], a[132:135], v[88:91]
    ds_read_b64_tr_b16 a[84:85], v14 offset:33024
    v_mfma_f32_16x16x32_bf16 v[92:95], a[32:35], a[132:135], v[92:95]
    ds_read_b64_tr_b16 a[86:87], v14 offset:34048
    v_mfma_f32_16x16x32_bf16 v[92:95], a[4:7], a[128:131], v[92:95]
    buffer_load_dwordx4 v3, s[12:15], s40 offen offset:3072 sc1 lds
    v_mfma_f32_16x16x32_bf16 v[96:99], a[8:11], a[128:131], v[96:99]
    ds_read_b64_tr_b16 a[88:89], v15 offset:33024
    s_add_u32 s40, s40, 16384
    v_mfma_f32_16x16x32_bf16 v[96:99], a[36:39], a[132:135], v[96:99]
    ds_read_b64_tr_b16 a[90:91], v15 offset:34048
    v_mfma_f32_16x16x32_bf16 v[100:103], a[40:43], a[132:135], v[100:103]
iw_d5:
    s_cbranch_execz iw_d8
    v_mfma_f32_16x16x32_bf16 v[100:103], a[12:15], a[128:131], v[100:103]
    ds_read_b64_tr_b16 a[92:93], v16 offset:33024
    v_mfma_f32_16x16x32_bf16 v[104:107], a[16:19], a[128:131], v[104:107]
    ds_read_b64_tr_b16 a[94:95], v16 offset:34048
    s_add_u32 m0, s42, 33024
    v_mfma_f32_16x16x32_bf16 v[104:107], a[44:47], a[132:135], v[104:107]
    buffer_load_dwordx4 v3, s[12:15], s40 offen offset:0 sc1 lds
    v_mfma_f32_16x16x32_bf16 v[108:111], a[48:51], a[132:135], v[108:111]
    ds_read_b64_tr_b16 a[96:97], v14 offset:41232
    v_mfma_f32_16x16x32_bf16 v[108:111], a[20:23], a[128:131], v[108:111]
    ds_read_b64_tr_b16 a[98:99], v14 offset:42256
    v_mfma_f32_16x16x32_bf16 v[112:115], a[24:27], a[128:131], v[112:115]
    v_mfma_f32_16x16x32_bf16 v[112:115], a[52:55], a[132:135], v[112:115]
    ds_read_b64_tr_b16 a[100:101], v15 offset:41232
    v_mfma_f32_16x16x32_bf16 v[140:143], a[24:27], a[136:139], v[140:143]
    ds_read_b64_tr_b16 a[102:103], v15 offset:42256
    v_mfma_f32_16x16x32_bf16 v[140:143], a[52:55], a[140:143], v[140:143]
    buffer_load_dwordx4 v3, s[12:15], s40 offen offset:1024 sc1 lds
    v_mfma_f32_16x16x32_bf16 v[136:139], a[48:51], a[140:143], v[136:139]
    ds_read_b64_tr_b16 a[104:105], v16 offset:41232
    v_mfma_f32_16x16x32_bf16 v[136:139], a[20:23], a[136:139], v[136:139]
    ds_read_b64_tr_b16 a[106:107], v16 offset:42256
    v_mfma_f32_16x16x32_bf16 v[132:135], a[16:19], a[136:139], v[132:135]
    v_mfma_f32_16x16x32_bf16 v[132:135], a[44:47], a[140:143], v[132:135]
    ds_read_b64_tr_b16 a[108:109], v17 offset:33024
    v_mfma_f32_16x16x32_bf16 v[128:131], a[40:43], a[140:143], v[128:131]
    ds_read_b64_tr_b16 a[110:111], v17 offset:34048
    v_mfma_f32_16x16x32_bf16 v[128:131], a[12:15], a[136:139], v[128:131]
    buffer_load_dwordx4 v3, s[12:15], s40 offen offset:2048 sc1 lds
    v_mfma_f32_16x16x32_bf16 v[124:127], a[8:11], a[136:139], v[124:127]
    v_mfma_f32_16x16x32_bf16 v[124:127], a[36:39], a[140:143], v[124:127]
    v_mfma_f32_16x16x32_bf16 v[120:123], a[32:35], a[140:143], v[120:123]
    v_mfma_f32_16x16x32_bf16 v[120:123], a[4:7], a[136:139], v[120:123]
    v_mfma_f32_16x16x32_bf16 v[116:119], a[0:3], a[136:139], v[116:119]
    v_mfma_f32_16x16x32_bf16 v[116:119], a[28:31], a[140:143], v[116:119]
    buffer_load_dwordx4 v3, s[12:15], s40 offen offset:3072 sc1 lds
    v_mfma_f32_16x16x32_bf16 v[144:147], a[0:3], a[144:147], v[144:147]
    s_add_u32 s40, s40, 16384
    v_mfma_f32_16x16x32_bf16 v[144:147], a[28:31], a[148:151], v[144:147]
    v_mfma_f32_16x16x32_bf16 v[148:151], a[32:35], a[148:151], v[148:151]
    v_mfma_f32_16x16x32_bf16 v[148:151], a[4:7], a[144:147], v[148:151]
    v_mfma_f32_16x16x32_bf16 v[152:155], a[8:11], a[144:147], v[152:155]
    v_mfma_f32_16x16x32_bf16 v[152:155], a[36:39], a[148:151], v[152:155]
    s_cmp_eq_u32 s47, s49
    v_mfma_f32_16x16x32_bf16 v[156:159], a[40:43], a[148:151], v[156:159]
    s_waitcnt vmcnt(17) lgkmcnt(0)
    v_mfma_f32_16x16x32_bf16 v[156:159], a[12:15], a[144:147], v[156:159]
    s_barrier
    v_mfma_f32_16x16x32_bf16 v[160:163], a[16:19], a[144:147], v[160:163]
    s_cbranch_scc1 interl_g1s54
interl_g1t55:
    v_mfma_f32_16x16x32_bf16 v[160:163], a[44:47], a[148:151], v[160:163]
    ds_read_b128 a[112:115], v9 offset:0
    v_mfma_f32_16x16x32_bf16 v[164:167], a[48:51], a[148:151], v[164:167]
    ds_read_b128 a[116:119], v9 offset:33024
    v_mfma_f32_16x16x32_bf16 v[164:167], a[20:23], a[144:147], v[164:167]
    v_mfma_f32_16x16x32_bf16 v[168:171], a[24:27], a[144:147], v[168:171]
    ds_read_b128 a[120:123], v9 offset:1024
    v_mfma_f32_16x16x32_bf16 v[168:171], a[52:55], a[148:151], v[168:171]
    ds_read_b128 a[124:127], v9 offset:34048
    s_add_u32 m0, s43, 66048
    v_mfma_f32_16x16x32_bf16 v[196:199], a[24:27], a[152:155], v[196:199]
    buffer_load_dwordx4 v19, s[8:11], s41 offen offset:0 lds
    v_mfma_f32_16x16x32_bf16 v[196:199], a[52:55], a[156:159], v[196:199]
    ds_read_b128 a[128:131], v9 offset:2048
    v_mfma_f32_16x16x32_bf16 v[192:195], a[48:51], a[156:159], v[192:195]
    ds_read_b128 a[132:135], v9 offset:35072
    v_mfma_f32_16x16x32_bf16 v[192:195], a[20:23], a[152:155], v[192:195]
    v_mfma_f32_16x16x32_bf16 v[188:191], a[16:19], a[152:155], v[188:191]
    ds_read_b128 a[136:139], v9 offset:3072
    v_mfma_f32_16x16x32_bf16 v[188:191], a[44:47], a[156:159], v[188:191]
    ds_read_b128 a[140:143], v9 offset:36096
    buffer_load_dwordx4 v20, s[8:11], s41 offen offset:1024 lds
    v_mfma_f32_16x16x32_bf16 v[184:187], a[40:43], a[156:159], v[184:187]
    v_mfma_f32_16x16x32_bf16 v[184:187], a[12:15], a[152:155], v[184:187]
    ds_read_b128 a[144:147], v9 offset:4096
    v_mfma_f32_16x16x32_bf16 v[180:183], a[8:11], a[152:155], v[180:183]
    ds_read_b128 a[148:151], v9 offset:37120
    v_mfma_f32_16x16x32_bf16 v[180:183], a[36:39], a[156:159], v[180:183]
    v_mfma_f32_16x16x32_bf16 v[176:179], a[32:35], a[156:159], v[176:179]
    buffer_load_dwordx4 v21, s[8:11], s41 offen offset:2048 lds
    v_mfma_f32_16x16x32_bf16 v[176:179], a[4:7], a[152:155], v[176:179]
    v_mfma_f32_16x16x32_bf16 v[172:175], a[0:3], a[152:155], v[172:175]
    v_mfma_f32_16x16x32_bf16 v[172:175], a[28:31], a[156:159], v[172:175]
    ds_read_b128 a[152:155], v9 offset:5120
    v_mfma_f32_16x16x32_bf16 v[200:203], a[0:3], a[160:163], v[200:203]
    ds_read_b128 a[156:159], v9 offset:38144
    v_mfma_f32_16x16x32_bf16 v[200:203], a[28:31], a[164:167], v[200:203]
    buffer_load_dwordx4 v22, s[8:11], s41 offen offset:3072 lds
    v_mfma_f32_16x16x32_bf16 v[204:207], a[32:35], a[164:167], v[204:207]
    s_add_u32 s41, s41, 229376
    v_mfma_f32_16x16x32_bf16 v[204:207], a[4:7], a[160:163], v[204:207]
    v_mfma_f32_16x16x32_bf16 v[208:211], a[8:11], a[160:163], v[208:211]
    v_mfma_f32_16x16x32_bf16 v[208:211], a[36:39], a[164:167], v[208:211]
    s_add_u32 m0, s43, 99072
    v_mfma_f32_16x16x32_bf16 v[212:215], a[40:43], a[164:167], v[212:215]
    buffer_load_dwordx4 v19, s[8:11], s41 offen offset:0 lds
    v_mfma_f32_16x16x32_bf16 v[212:215], a[12:15], a[160:163], v[212:215]
    v_mfma_f32_16x16x32_bf16 v[216:219], a[16:19], a[160:163], v[216:219]
    v_mfma_f32_16x16x32_bf16 v[216:219], a[44:47], a[164:167], v[216:219]
    v_mfma_f32_16x16x32_bf16 v[220:223], a[48:51], a[164:167], v[220:223]
    v_mfma_f32_16x16x32_bf16 v[220:223], a[20:23], a[160:163], v[220:223]
    buffer_load_dwordx4 v20, s[8:11], s41 offen offset:1024 lds
    v_mfma_f32_16x16x32_bf16 v[224:227], a[24:27], a[160:163], v[224:227]
    v_mfma_f32_16x16x32_bf16 v[224:227], a[52:55], a[164:167], v[224:227]
    ds_read_b128 a[160:163], v9 offset:6144
    v_mfma_f32_16x16x32_bf16 v[252:255], a[24:27], a[168:171], v[252:255]
    ds_read_b128 a[164:167], v9 offset:39168
    v_mfma_f32_16x16x32_bf16 v[252:255], a[52:55], a[172:175], v[252:255]
    v_mfma_f32_16x16x32_bf16 v[248:251], a[48:51], a[172:175], v[248:251]
    buffer_load_dwordx4 v21, s[8:11], s41 offen offset:2048 lds
    v_mfma_f32_16x16x32_bf16 v[248:251], a[20:23], a[168:171], v[248:251]
    v_mfma_f32_16x16x32_bf16 v[244:247], a[16:19], a[168:171], v[244:247]
    v_mfma_f32_16x16x32_bf16 v[244:247], a[44:47], a[172:175], v[244:247]
    v_mfma_f32_16x16x32_bf16 v[240:243], a[40:43], a[172:175], v[240:243]
    v_mfma_f32_16x16x32_bf16 v[240:243], a[12:15], a[168:171], v[240:243]
    buffer_load_dwordx4 v22, s[8:11], s41 offen offset:3072 lds
    v_mfma_f32_16x16x32_bf16 v[236:239], a[8:11], a[168:171], v[236:239]
    s_add_u32 s41, s41, 229376
    v_mfma_f32_16x16x32_bf16 v[236:239], a[36:39], a[172:175], v[236:239]
    v_mfma_f32_16x16x32_bf16 v[232:235], a[32:35], a[172:175], v[232:235]
    v_mfma_f32_16x16x32_bf16 v[232:235], a[4:7], a[168:171], v[232:235]
    v_mfma_f32_16x16x32_bf16 v[228:231], a[0:3], a[168:171], v[228:231]
    ds_read_b128 a[168:171], v9 offset:7168
    s_cmp_lg_u32 s47, 0
    v_mfma_f32_16x16x32_bf16 v[228:231], a[28:31], a[172:175], v[228:231]
    ds_read_b128 a[172:175], v9 offset:40192
    s_cbranch_scc1 interl_g1m43
interl_g1z44:
    s_waitcnt lgkmcnt(2)
    v_mfma_f32_16x16x32_bf16 v[32:35], a[56:59], a[112:115], v[32:35]
iw_c6:
    s_cbranch_execz iw_c9
    s_lshr_b32 s57, s5, 4
    v_mfma_f32_16x16x32_bf16 v[32:35], a[84:87], a[116:119], v[32:35]
    s_lshl_b32 s54, s3, 12
    v_mfma_f32_16x16x32_bf16 v[36:39], a[88:91], a[116:119], v[36:39]
    s_and_b32 s35, s5, 7
    v_mfma_f32_16x16x32_bf16 v[36:39], a[60:63], a[112:115], v[36:39]
    s_lshl_b32 s35, s35, 1
    v_mfma_f32_16x16x32_bf16 v[40:43], a[64:67], a[112:115], v[40:43]
    s_add_u32 s35, s35, s57
    v_mfma_f32_16x16x32_bf16 v[40:43], a[92:95], a[116:119], v[40:43]
    s_mul_i32 s51, s35, 458752
    v_mfma_f32_16x16x32_bf16 v[44:47], a[96:99], a[116:119], v[44:47]
    s_waitcnt vmcnt(17) lgkmcnt(0)
    v_mfma_f32_16x16x32_bf16 v[44:47], a[68:71], a[112:115], v[44:47]
    s_barrier
    v_mfma_f32_16x16x32_bf16 v[48:51], a[72:75], a[112:115], v[48:51]
    ds_read_b64_tr_b16 a[0:1], v10 offset:0
    v_mfma_f32_16x16x32_bf16 v[48:51], a[100:103], a[116:119], v[48:51]
    ds_read_b64_tr_b16 a[2:3], v10 offset:1024
    v_mfma_f32_16x16x32_bf16 v[52:55], a[104:107], a[116:119], v[52:55]
    buffer_load_dword v7, v23, s[12:15], s95 offen sc1
    v_mfma_f32_16x16x32_bf16 v[52:55], a[76:79], a[112:115], v[52:55]
    ds_read_b64_tr_b16 a[4:5], v11 offset:0
    v_mfma_f32_16x16x32_bf16 v[56:59], a[80:83], a[112:115], v[56:59]
    ds_read_b64_tr_b16 a[6:7], v11 offset:1024
    v_mfma_f32_16x16x32_bf16 v[56:59], a[108:111], a[116:119], v[56:59]
    v_mfma_f32_16x16x32_bf16 v[84:87], a[80:83], a[120:123], v[84:87]
    ds_read_b64_tr_b16 a[8:9], v12 offset:0
    v_mfma_f32_16x16x32_bf16 v[84:87], a[108:111], a[124:127], v[84:87]
    ds_read_b64_tr_b16 a[10:11], v12 offset:1024
    s_add_u32 m0, s42, 66048
    v_mfma_f32_16x16x32_bf16 v[80:83], a[104:107], a[124:127], v[80:83]
    buffer_load_dwordx4 v3, s[12:15], s40 offen offset:0 sc1 lds
    v_mfma_f32_16x16x32_bf16 v[80:83], a[76:79], a[120:123], v[80:83]
    ds_read_b64_tr_b16 a[12:13], v10 offset:8208
    v_mfma_f32_16x16x32_bf16 v[76:79], a[72:75], a[120:123], v[76:79]
    ds_read_b64_tr_b16 a[14:15], v10 offset:9232
    v_mfma_f32_16x16x32_bf16 v[76:79], a[100:103], a[124:127], v[76:79]
    v_mfma_f32_16x16x32_bf16 v[72:75], a[96:99], a[124:127], v[72:75]
    ds_read_b64_tr_b16 a[16:17], v11 offset:8208
    v_mfma_f32_16x16x32_bf16 v[72:75], a[68:71], a[120:123], v[72:75]
    ds_read_b64_tr_b16 a[18:19], v11 offset:9232
    v_mfma_f32_16x16x32_bf16 v[68:71], a[64:67], a[120:123], v[68:71]
    buffer_load_dwordx4 v3, s[12:15], s40 offen offset:1024 sc1 lds
    v_mfma_f32_16x16x32_bf16 v[68:71], a[92:95], a[124:127], v[68:71]
    ds_read_b64_tr_b16 a[20:21], v12 offset:8208
    v_mfma_f32_16x16x32_bf16 v[64:67], a[88:91], a[124:127], v[64:67]
    ds_read_b64_tr_b16 a[22:23], v12 offset:9232
    v_mfma_f32_16x16x32_bf16 v[64:67], a[60:63], a[120:123], v[64:67]
    v_mfma_f32_16x16x32_bf16 v[60:63], a[56:59], a[120:123], v[60:63]
    ds_read_b64_tr_b16 a[24:25], v13 offset:0
    v_mfma_f32_16x16x32_bf16 v[60:63], a[84:87], a[124:127], v[60:63]
    ds_read_b64_tr_b16 a[26:27], v13 offset:1024
    v_mfma_f32_16x16x32_bf16 v[88:91], a[56:59], a[128:131], v[88:91]
    buffer_load_dwordx4 v3, s[12:15], s40 offen offset:2048 sc1 lds
    v_mfma_f32_16x16x32_bf16 v[88:91], a[84:87], a[132:135], v[88:91]
    ds_read_b64_tr_b16 a[28:29], v10 offset:33024
    v_mfma_f32_16x16x32_bf16 v[92:95], a[88:91], a[132:135], v[92:95]
    ds_read_b64_tr_b16 a[30:31], v10 offset:34048
    v_mfma_f32_16x16x32_bf16 v[92:95], a[60:63], a[128:131], v[92:95]
    v_mfma_f32_16x16x32_bf16 v[96:99], a[64:67], a[128:131], v[96:99]
    ds_read_b64_tr_b16 a[32:33], v11 offset:33024
    v_mfma_f32_16x16x32_bf16 v[96:99], a[92:95], a[132:135], v[96:99]
    ds_read_b64_tr_b16 a[34:35], v11 offset:34048
    v_mfma_f32_16x16x32_bf16 v[100:103], a[96:99], a[132:135], v[100:103]
    buffer_load_dwordx4 v3, s[12:15], s40 offen offset:3072 sc1 lds
    v_mfma_f32_16x16x32_bf16 v[100:103], a[68:71], a[128:131], v[100:103]
    ds_read_b64_tr_b16 a[36:37], v12 offset:33024
    s_add_u32 s40, s40, 16384
    v_mfma_f32_16x16x32_bf16 v[104:107], a[72:75], a[128:131], v[104:107]
    ds_read_b64_tr_b16 a[38:39], v12 offset:34048
    v_mfma_f32_16x16x32_bf16 v[104:107], a[100:103], a[132:135], v[104:107]
    v_mfma_f32_16x16x32_bf16 v[108:111], a[104:107], a[132:135], v[108:111]
    ds_read_b64_tr_b16 a[40:41], v10 offset:41232
    v_mfma_f32_16x16x32_bf16 v[108:111], a[76:79], a[128:131], v[108:111]
    ds_read_b64_tr_b16 a[42:43], v10 offset:42256
    s_add_u32 m0, s42, 99072
    v_mfma_f32_16x16x32_bf16 v[112:115], a[80:83], a[128:131], v[112:115]
    buffer_load_dwordx4 v3, s[12:15], s40 offen offset:0 sc1 lds
    v_mfma_f32_16x16x32_bf16 v[112:115], a[108:111], a[132:135], v[112:115]
    ds_read_b64_tr_b16 a[44:45], v11 offset:41232
    v_mfma_f32_16x16x32_bf16 v[140:143], a[80:83], a[136:139], v[140:143]
    ds_read_b64_tr_b16 a[46:47], v11 offset:42256
    v_mfma_f32_16x16x32_bf16 v[140:143], a[108:111], a[140:143], v[140:143]
    v_mfma_f32_16x16x32_bf16 v[136:139], a[104:107], a[140:143], v[136:139]
    ds_read_b64_tr_b16 a[48:49], v12 offset:41232
    v_mfma_f32_16x16x32_bf16 v[136:139], a[76:79], a[136:139], v[136:139]
    ds_read_b64_tr_b16 a[50:51], v12 offset:42256
    v_mfma_f32_16x16x32_bf16 v[132:135], a[72:75], a[136:139], v[132:135]
    buffer_load_dwordx4 v3, s[12:15], s40 offen offset:1024 sc1 lds
    v_mfma_f32_16x16x32_bf16 v[132:135], a[100:103], a[140:143], v[132:135]
    ds_read_b64_tr_b16 a[52:53], v13 offset:33024
    v_mfma_f32_16x16x32_bf16 v[128:131], a[96:99], a[140:143], v[128:131]
    ds_read_b64_tr_b16 a[54:55], v13 offset:34048
    v_mfma_f32_16x16x32_bf16 v[128:131], a[68:71], a[136:139], v[128:131]
    v_mfma_f32_16x16x32_bf16 v[124:127], a[64:67], a[136:139], v[124:127]
    s_mul_i32 s35, s57, 0
    v_mfma_f32_16x16x32_bf16 v[124:127], a[92:95], a[140:143], v[124:127]
    s_add_u32 s51, s51, s35
    v_mfma_f32_16x16x32_bf16 v[120:123], a[88:91], a[140:143], v[120:123]
    buffer_load_dwordx4 v3, s[12:15], s40 offen offset:2048 sc1 lds
    v_mfma_f32_16x16x32_bf16 v[120:123], a[60:63], a[136:139], v[120:123]
    s_add_u32 s51, s51, s54
    v_mfma_f32_16x16x32_bf16 v[116:119], a[56:59], a[136:139], v[116:119]
    s_add_u32 s51, s51, 77594624
    v_mfma_f32_16x16x32_bf16 v[116:119], a[84:87], a[140:143], v[116:119]
    s_add_u32 s54, s54, 256
    v_mfma_f32_16x16x32_bf16 v[144:147], a[56:59], a[144:147], v[144:147]
    s_mov_b64 s[28:29], s[12:13]
    v_mfma_f32_16x16x32_bf16 v[144:147], a[84:87], a[148:151], v[144:147]
    s_mov_b32 s30, s14
    v_mfma_f32_16x16x32_bf16 v[148:151], a[88:91], a[148:151], v[148:151]
    buffer_load_dwordx4 v3, s[12:15], s40 offen offset:3072 sc1 lds
    v_mfma_f32_16x16x32_bf16 v[148:151], a[60:63], a[144:147], v[148:151]
    s_add_u32 s40, s40, 16384
    v_mfma_f32_16x16x32_bf16 v[152:155], a[64:67], a[144:147], v[152:155]
    v_mfma_f32_16x16x32_bf16 v[152:155], a[92:95], a[148:151], v[152:155]
    v_mfma_f32_16x16x32_bf16 v[156:159], a[96:99], a[148:151], v[156:159]
    s_waitcnt vmcnt(8) lgkmcnt(0)
    v_cmp_gt_u32 vcc, 5, v7
    s_cbranch_vccnz interl_g1c38
interl_g1d39:
    v_mfma_f32_16x16x32_bf16 v[156:159], a[68:71], a[144:147], v[156:159]
    s_barrier
    v_mfma_f32_16x16x32_bf16 v[160:163], a[72:75], a[144:147], v[160:163]
    v_mfma_f32_16x16x32_bf16 v[160:163], a[100:103], a[148:151], v[160:163]
    ds_read_b128 a[112:115], v8 offset:0
    s_add_u32 s35, s51, 16384
    v_mfma_f32_16x16x32_bf16 v[164:167], a[104:107], a[148:151], v[164:167]
    ds_read_b128 a[116:119], v8 offset:33024
    s_add_u32 m0, s54, 16384
    v_mfma_f32_16x16x32_bf16 v[164:167], a[76:79], a[144:147], v[164:167]
    buffer_load_dwordx4 v3, s[28:31], s35 offen offset:0 sc1 lds
    v_mfma_f32_16x16x32_bf16 v[168:171], a[80:83], a[144:147], v[168:171]
    ds_read_b128 a[120:123], v8 offset:1024
    v_mfma_f32_16x16x32_bf16 v[168:171], a[108:111], a[148:151], v[168:171]
    ds_read_b128 a[124:127], v8 offset:34048
    v_mfma_f32_16x16x32_bf16 v[196:199], a[80:83], a[152:155], v[196:199]
iw_d6:
    s_cbranch_execz iw_d9
    v_mfma_f32_16x16x32_bf16 v[196:199], a[108:111], a[156:159], v[196:199]
    ds_read_b128 a[128:131], v8 offset:2048
    v_mfma_f32_16x16x32_bf16 v[192:195], a[104:107], a[156:159], v[192:195]
    ds_read_b128 a[132:135], v8 offset:35072
    buffer_load_dwordx4 v3, s[28:31], s35 offen offset:1024 sc1 lds
    v_mfma_f32_16x16x32_bf16 v[192:195], a[76:79], a[152:155], v[192:195]
    v_mfma_f32_16x16x32_bf16 v[188:191], a[72:75], a[152:155], v[188:191]
    ds_read_b128 a[136:139], v8 offset:3072
    v_mfma_f32_16x16x32_bf16 v[188:191], a[100:103], a[156:159], v[188:191]
    ds_read_b128 a[140:143], v8 offset:36096
    v_mfma_f32_16x16x32_bf16 v[184:187], a[96:99], a[156:159], v[184:187]
    v_mfma_f32_16x16x32_bf16 v[184:187], a[68:71], a[152:155], v[184:187]
    ds_read_b128 a[144:147], v8 offset:4096
    buffer_load_dwordx4 v3, s[28:31], s35 offen offset:2048 sc1 lds
    v_mfma_f32_16x16x32_bf16 v[180:183], a[64:67], a[152:155], v[180:183]
    ds_read_b128 a[148:151], v8 offset:37120
    v_mfma_f32_16x16x32_bf16 v[180:183], a[92:95], a[156:159], v[180:183]
    v_mfma_f32_16x16x32_bf16 v[176:179], a[88:91], a[156:159], v[176:179]
    v_mfma_f32_16x16x32_bf16 v[176:179], a[60:63], a[152:155], v[176:179]
    v_mfma_f32_16x16x32_bf16 v[172:175], a[56:59], a[152:155], v[172:175]
    buffer_load_dwordx4 v3, s[28:31], s35 offen offset:3072 sc1 lds
    v_mfma_f32_16x16x32_bf16 v[172:175], a[84:87], a[156:159], v[172:175]
    ds_read_b128 a[152:155], v8 offset:5120
    v_mfma_f32_16x16x32_bf16 v[200:203], a[56:59], a[160:163], v[200:203]
    ds_read_b128 a[156:159], v8 offset:38144
    v_mfma_f32_16x16x32_bf16 v[200:203], a[84:87], a[164:167], v[200:203]
    s_add_u32 s35, s51, 49152
    v_mfma_f32_16x16x32_bf16 v[204:207], a[88:91], a[164:167], v[204:207]
    s_add_u32 m0, s54, 49152
    v_mfma_f32_16x16x32_bf16 v[204:207], a[60:63], a[160:163], v[204:207]
    buffer_load_dwordx4 v3, s[28:31], s35 offen offset:0 sc1 lds
    v_mfma_f32_16x16x32_bf16 v[208:211], a[64:67], a[160:163], v[208:211]
    v_mfma_f32_16x16x32_bf16 v[208:211], a[92:95], a[164:167], v[208:211]
    v_mfma_f32_16x16x32_bf16 v[212:215], a[96:99], a[164:167], v[212:215]
    v_mfma_f32_16x16x32_bf16 v[212:215], a[68:71], a[160:163], v[212:215]
    v_mfma_f32_16x16x32_bf16 v[216:219], a[72:75], a[160:163], v[216:219]
    buffer_load_dwordx4 v3, s[28:31], s35 offen offset:1024 sc1 lds
    v_mfma_f32_16x16x32_bf16 v[216:219], a[100:103], a[164:167], v[216:219]
    v_mfma_f32_16x16x32_bf16 v[220:223], a[104:107], a[164:167], v[220:223]
    v_mfma_f32_16x16x32_bf16 v[220:223], a[76:79], a[160:163], v[220:223]
    v_mfma_f32_16x16x32_bf16 v[224:227], a[80:83], a[160:163], v[224:227]
    v_mfma_f32_16x16x32_bf16 v[224:227], a[108:111], a[164:167], v[224:227]
    ds_read_b128 a[160:163], v8 offset:6144
    buffer_load_dwordx4 v3, s[28:31], s35 offen offset:2048 sc1 lds
    v_mfma_f32_16x16x32_bf16 v[252:255], a[80:83], a[168:171], v[252:255]
    ds_read_b128 a[164:167], v8 offset:39168
    v_mfma_f32_16x16x32_bf16 v[252:255], a[108:111], a[172:175], v[252:255]
    v_mfma_f32_16x16x32_bf16 v[248:251], a[104:107], a[172:175], v[248:251]
    v_mfma_f32_16x16x32_bf16 v[248:251], a[76:79], a[168:171], v[248:251]
    v_mfma_f32_16x16x32_bf16 v[244:247], a[72:75], a[168:171], v[244:247]
    buffer_load_dwordx4 v3, s[28:31], s35 offen offset:3072 sc1 lds
    v_mfma_f32_16x16x32_bf16 v[244:247], a[100:103], a[172:175], v[244:247]
    v_mfma_f32_16x16x32_bf16 v[240:243], a[96:99], a[172:175], v[240:243]
    v_mfma_f32_16x16x32_bf16 v[240:243], a[68:71], a[168:171], v[240:243]
    v_mfma_f32_16x16x32_bf16 v[236:239], a[64:67], a[168:171], v[236:239]
    v_mfma_f32_16x16x32_bf16 v[236:239], a[92:95], a[172:175], v[236:239]
    v_mfma_f32_16x16x32_bf16 v[232:235], a[88:91], a[172:175], v[232:235]
    v_mfma_f32_16x16x32_bf16 v[232:235], a[60:63], a[168:171], v[232:235]
    v_mfma_f32_16x16x32_bf16 v[228:231], a[56:59], a[168:171], v[228:231]
    ds_read_b128 a[168:171], v8 offset:7168
    v_mfma_f32_16x16x32_bf16 v[228:231], a[84:87], a[172:175], v[228:231]
    ds_read_b128 a[172:175], v8 offset:40192
    s_waitcnt lgkmcnt(2)
    v_mfma_f32_16x16x32_bf16 v[32:35], a[0:3], a[112:115], v[32:35]
    v_mfma_f32_16x16x32_bf16 v[32:35], a[28:31], a[116:119], v[32:35]
    s_add_u32 s40, s51, 65536
    v_mfma_f32_16x16x32_bf16 v[36:39], a[32:35], a[116:119], v[36:39]
    v_mfma_f32_16x16x32_bf16 v[36:39], a[4:7], a[112:115], v[36:39]
    v_mfma_f32_16x16x32_bf16 v[40:43], a[8:11], a[112:115], v[40:43]
    v_mfma_f32_16x16x32_bf16 v[40:43], a[36:39], a[116:119], v[40:43]
    v_mfma_f32_16x16x32_bf16 v[44:47], a[40:43], a[116:119], v[44:47]
    s_waitcnt vmcnt(8) lgkmcnt(0)
    v_mfma_f32_16x16x32_bf16 v[44:47], a[12:15], a[112:115], v[44:47]
    s_barrier
    v_mfma_f32_16x16x32_bf16 v[48:51], a[16:19], a[112:115], v[48:51]
    ds_read_b64_tr_b16 a[56:57], v14 offset:0
    v_mfma_f32_16x16x32_bf16 v[48:51], a[44:47], a[116:119], v[48:51]
    ds_read_b64_tr_b16 a[58:59], v14 offset:1024
    s_add_u32 s35, s51, 0
    v_mfma_f32_16x16x32_bf16 v[52:55], a[48:51], a[116:119], v[52:55]
    ds_read_b64_tr_b16 a[60:61], v15 offset:0
    s_add_u32 m0, s54, 0
    v_mfma_f32_16x16x32_bf16 v[52:55], a[20:23], a[112:115], v[52:55]
    buffer_load_dwordx4 v3, s[28:31], s35 offen offset:0 sc1 lds
    v_mfma_f32_16x16x32_bf16 v[56:59], a[24:27], a[112:115], v[56:59]
    ds_read_b64_tr_b16 a[62:63], v15 offset:1024
    v_mfma_f32_16x16x32_bf16 v[56:59], a[52:55], a[116:119], v[56:59]
    ds_read_b64_tr_b16 a[64:65], v16 offset:0
    v_mfma_f32_16x16x32_bf16 v[84:87], a[24:27], a[120:123], v[84:87]
    ds_read_b64_tr_b16 a[66:67], v16 offset:1024
    v_mfma_f32_16x16x32_bf16 v[84:87], a[52:55], a[124:127], v[84:87]
    ds_read_b64_tr_b16 a[68:69], v14 offset:8208
    v_mfma_f32_16x16x32_bf16 v[80:83], a[48:51], a[124:127], v[80:83]
    buffer_load_dwordx4 v3, s[28:31], s35 offen offset:1024 sc1 lds
    v_mfma_f32_16x16x32_bf16 v[80:83], a[20:23], a[120:123], v[80:83]
    ds_read_b64_tr_b16 a[70:71], v14 offset:9232
    v_mfma_f32_16x16x32_bf16 v[76:79], a[16:19], a[120:123], v[76:79]
    v_mfma_f32_16x16x32_bf16 v[76:79], a[44:47], a[124:127], v[76:79]
    ds_read_b64_tr_b16 a[72:73], v15 offset:8208
    v_mfma_f32_16x16x32_bf16 v[72:75], a[40:43], a[124:127], v[72:75]
    ds_read_b64_tr_b16 a[74:75], v15 offset:9232
    v_mfma_f32_16x16x32_bf16 v[72:75], a[12:15], a[120:123], v[72:75]
    buffer_load_dwordx4 v3, s[28:31], s35 offen offset:2048 sc1 lds
    v_mfma_f32_16x16x32_bf16 v[68:71], a[8:11], a[120:123], v[68:71]
    ds_read_b64_tr_b16 a[76:77], v16 offset:8208
    v_mfma_f32_16x16x32_bf16 v[68:71], a[36:39], a[124:127], v[68:71]
    ds_read_b64_tr_b16 a[78:79], v16 offset:9232
    v_mfma_f32_16x16x32_bf16 v[64:67], a[32:35], a[124:127], v[64:67]
    ds_read_b64_tr_b16 a[80:81], v17 offset:0
    v_mfma_f32_16x16x32_bf16 v[64:67], a[4:7], a[120:123], v[64:67]
    ds_read_b64_tr_b16 a[82:83], v17 offset:1024
    v_mfma_f32_16x16x32_bf16 v[60:63], a[0:3], a[120:123], v[60:63]
    buffer_load_dwordx4 v3, s[28:31], s35 offen offset:3072 sc1 lds
    v_mfma_f32_16x16x32_bf16 v[60:63], a[28:31], a[124:127], v[60:63]
    ds_read_b64_tr_b16 a[84:85], v14 offset:33024
    v_mfma_f32_16x16x32_bf16 v[88:91], a[0:3], a[128:131], v[88:91]
    v_mfma_f32_16x16x32_bf16 v[88:91], a[28:31], a[132:135], v[88:91]
    ds_read_b64_tr_b16 a[86:87], v14 offset:34048
    s_add_u32 s35, s51, 32768
    v_mfma_f32_16x16x32_bf16 v[100:103], a[40:43], a[132:135], v[100:103]
    ds_read_b64_tr_b16 a[88:89], v15 offset:33024
    s_add_u32 m0, s54, 32768
    v_mfma_f32_16x16x32_bf16 v[100:103], a[12:15], a[128:131], v[100:103]
    buffer_load_dwordx4 v3, s[28:31], s35 offen offset:0 sc1 lds
    v_mfma_f32_16x16x32_bf16 v[92:95], a[4:7], a[128:131], v[92:95]
    ds_read_b64_tr_b16 a[90:91], v15 offset:34048
iw_c7:
    s_cbranch_execz iw_c10
    v_mfma_f32_16x16x32_bf16 v[92:95], a[32:35], a[132:135], v[92:95]
    ds_read_b64_tr_b16 a[92:93], v16 offset:33024
    v_mfma_f32_16x16x32_bf16 v[104:107], a[44:47], a[132:135], v[104:107]
    ds_read_b64_tr_b16 a[94:95], v16 offset:34048
    v_mfma_f32_16x16x32_bf16 v[104:107], a[16:19], a[128:131], v[104:107]
    ds_read_b64_tr_b16 a[96:97], v14 offset:41232
    v_mfma_f32_16x16x32_bf16 v[132:135], a[16:19], a[136:139], v[132:135]
    buffer_load_dwordx4 v3, s[28:31], s35 offen offset:1024 sc1 lds
    v_mfma_f32_16x16x32_bf16 v[132:135], a[44:47], a[140:143], v[132:135]
    ds_read_b64_tr_b16 a[98:99], v14 offset:42256
    v_mfma_f32_16x16x32_bf16 v[120:123], a[32:35], a[140:143], v[120:123]
    v_mfma_f32_16x16x32_bf16 v[120:123], a[4:7], a[136:139], v[120:123]
    ds_read_b64_tr_b16 a[100:101], v15 offset:41232
    v_mfma_f32_16x16x32_bf16 v[128:131], a[12:15], a[136:139], v[128:131]
    ds_read_b64_tr_b16 a[102:103], v15 offset:42256
    v_mfma_f32_16x16x32_bf16 v[128:131], a[40:43], a[140:143], v[128:131]
    buffer_load_dwordx4 v3, s[28:31], s35 offen offset:2048 sc1 lds
    v_mfma_f32_16x16x32_bf16 v[116:119], a[28:31], a[140:143], v[116:119]
    ds_read_b64_tr_b16 a[104:105], v16 offset:41232
    v_mfma_f32_16x16x32_bf16 v[116:119], a[0:3], a[136:139], v[116:119]
    ds_read_b64_tr_b16 a[106:107], v16 offset:42256
    v_mfma_f32_16x16x32_bf16 v[144:147], a[0:3], a[144:147], v[144:147]
    ds_read_b64_tr_b16 a[108:109], v17 offset:33024
    v_mfma_f32_16x16x32_bf16 v[144:147], a[28:31], a[148:151], v[144:147]
    ds_read_b64_tr_b16 a[110:111], v17 offset:34048
    v_mfma_f32_16x16x32_bf16 v[156:159], a[40:43], a[148:151], v[156:159]
    buffer_load_dwordx4 v3, s[28:31], s35 offen offset:3072 sc1 lds
    v_mfma_f32_16x16x32_bf16 v[156:159], a[12:15], a[144:147], v[156:159]
    ds_read_b128 a[176:179], v9 offset:2048
    v_mfma_f32_16x16x32_bf16 v[148:151], a[4:7], a[144:147], v[148:151]
    ds_read_b128 a[180:183], v9 offset:35072
    v_mfma_f32_16x16x32_bf16 v[148:151], a[32:35], a[148:151], v[148:151]
    s_add_u32 s35, s51, 442368
    v_mfma_f32_16x16x32_bf16 v[160:163], a[44:47], a[148:151], v[160:163]
    ds_read_b128 a[184:187], v9 offset:3072
    s_add_u32 m0, s54, 133120
    v_mfma_f32_16x16x32_bf16 v[160:163], a[16:19], a[144:147], v[160:163]
    buffer_load_dwordx4 v3, s[28:31], s35 offen offset:0 sc1 lds
    v_mfma_f32_16x16x32_bf16 v[188:191], a[16:19], a[152:155], v[188:191]
    ds_read_b128 a[188:191], v9 offset:36096
    v_mfma_f32_16x16x32_bf16 v[188:191], a[44:47], a[156:159], v[188:191]
    ds_read_b128 a[192:195], v9 offset:4096
    v_mfma_f32_16x16x32_bf16 v[176:179], a[32:35], a[156:159], v[176:179]
    ds_read_b128 a[196:199], v9 offset:37120
    v_mfma_f32_16x16x32_bf16 v[176:179], a[4:7], a[152:155], v[176:179]
    ds_read_b128 a[200:203], v9 offset:5120
    v_mfma_f32_16x16x32_bf16 v[184:187], a[12:15], a[152:155], v[184:187]
    buffer_load_dwordx4 v3, s[28:31], s35 offen offset:1024 sc1 lds
    v_mfma_f32_16x16x32_bf16 v[184:187], a[40:43], a[156:159], v[184:187]
    ds_read_b128 a[204:207], v9 offset:38144
    v_mfma_f32_16x16x32_bf16 v[172:175], a[28:31], a[156:159], v[172:175]
    ds_read_b128 a[208:211], v9 offset:6144
    v_mfma_f32_16x16x32_bf16 v[172:175], a[0:3], a[152:155], v[172:175]
    v_mfma_f32_16x16x32_bf16 v[200:203], a[0:3], a[160:163], v[200:203]
    ds_read_b128 a[212:215], v9 offset:39168
    v_mfma_f32_16x16x32_bf16 v[200:203], a[28:31], a[164:167], v[200:203]
    buffer_load_dwordx4 v3, s[28:31], s35 offen offset:2048 sc1 lds
    v_mfma_f32_16x16x32_bf16 v[212:215], a[40:43], a[164:167], v[212:215]
    ds_read_b128 a[216:219], v9 offset:7168
    v_mfma_f32_16x16x32_bf16 v[212:215], a[12:15], a[160:163], v[212:215]
    ds_read_b128 a[220:223], v9 offset:40192
    v_mfma_f32_16x16x32_bf16 v[204:207], a[4:7], a[160:163], v[204:207]
    ds_read_b128 a[112:115], v9 offset:0
    v_mfma_f32_16x16x32_bf16 v[204:207], a[32:35], a[164:167], v[204:207]
    ds_read_b128 a[116:119], v9 offset:33024
    v_mfma_f32_16x16x32_bf16 v[216:219], a[44:47], a[164:167], v[216:219]
    buffer_load_dwordx4 v3, s[28:31], s35 offen offset:3072 sc1 lds
    v_mfma_f32_16x16x32_bf16 v[216:219], a[16:19], a[160:163], v[216:219]
    ds_read_b128 a[120:123], v9 offset:1024
    v_mfma_f32_16x16x32_bf16 v[244:247], a[16:19], a[168:171], v[244:247]
    ds_read_b128 a[124:127], v9 offset:34048
    v_mfma_f32_16x16x32_bf16 v[244:247], a[44:47], a[172:175], v[244:247]
    v_mfma_f32_16x16x32_bf16 v[232:235], a[32:35], a[172:175], v[232:235]
    v_mfma_f32_16x16x32_bf16 v[232:235], a[4:7], a[168:171], v[232:235]
    v_mfma_f32_16x16x32_bf16 v[240:243], a[12:15], a[168:171], v[240:243]
    v_mfma_f32_16x16x32_bf16 v[240:243], a[40:43], a[172:175], v[240:243]
    v_mfma_f32_16x16x32_bf16 v[228:231], a[28:31], a[172:175], v[228:231]
    v_mfma_f32_16x16x32_bf16 v[228:231], a[0:3], a[168:171], v[228:231]
    s_waitcnt lgkmcnt(0)
    v_mfma_f32_16x16x32_bf16 v[32:35], a[56:59], a[112:115], v[32:35]
    v_mfma_f32_16x16x32_bf16 v[32:35], a[84:87], a[116:119], v[32:35]
    v_mfma_f32_16x16x32_bf16 v[44:47], a[96:99], a[116:119], v[44:47]
    v_mfma_f32_16x16x32_bf16 v[44:47], a[68:71], a[112:115], v[44:47]
    s_nop 1
    v_mfma_f32_16x16x32_bf16 v[36:39], a[60:63], a[112:115], v[36:39]
    s_nop 1
    v_mfma_f32_16x16x32_bf16 v[36:39], a[88:91], a[116:119], v[36:39]
    s_nop 1
    v_mfma_f32_16x16x32_bf16 v[48:51], a[100:103], a[116:119], v[48:51]
    v_mul_f32 v32, v32, v44
    v_mul_f32 v33, v33, v45
    v_mfma_f32_16x16x32_bf16 v[48:51], a[72:75], a[112:115], v[48:51]
    v_mul_f32 v34, v34, v46
    v_mul_f32 v35, v35, v47
    v_mfma_f32_16x16x32_bf16 v[96:99], a[8:11], a[128:131], v[96:99]
    v_cvt_pk_bf16_f32 v44, v32, v33
    v_cvt_pk_bf16_f32 v45, v34, v35
    v_mfma_f32_16x16x32_bf16 v[96:99], a[36:39], a[132:135], v[96:99]
    s_nop 1
    v_mfma_f32_16x16x32_bf16 v[108:111], a[20:23], a[128:131], v[108:111]
    v_mul_f32 v36, v36, v48
    v_mul_f32 v37, v37, v49
    v_mfma_f32_16x16x32_bf16 v[108:111], a[48:51], a[132:135], v[108:111]
    v_mul_f32 v38, v38, v50
    v_mul_f32 v39, v39, v51
    v_mfma_f32_16x16x32_bf16 v[60:63], a[56:59], a[120:123], v[60:63]
    v_cvt_pk_bf16_f32 v46, v36, v37
    v_cvt_pk_bf16_f32 v47, v38, v39
    v_mfma_f32_16x16x32_bf16 v[60:63], a[84:87], a[124:127], v[60:63]
    buffer_store_dwordx4 v[44:47], v24, s[12:15], s59 offen offset:0 sc1
    v_mfma_f32_16x16x32_bf16 v[72:75], a[96:99], a[124:127], v[72:75]
    v_mfma_f32_16x16x32_bf16 v[72:75], a[68:71], a[120:123], v[72:75]
    s_nop 1
    v_mfma_f32_16x16x32_bf16 v[64:67], a[60:63], a[120:123], v[64:67]
    s_nop 1
    v_mfma_f32_16x16x32_bf16 v[64:67], a[88:91], a[124:127], v[64:67]
    s_nop 1
    v_mfma_f32_16x16x32_bf16 v[76:79], a[100:103], a[124:127], v[76:79]
    v_mul_f32 v60, v60, v72
    v_mul_f32 v61, v61, v73
    v_mfma_f32_16x16x32_bf16 v[76:79], a[72:75], a[120:123], v[76:79]
    v_mul_f32 v62, v62, v74
    v_mul_f32 v63, v63, v75
    v_mfma_f32_16x16x32_bf16 v[112:115], a[24:27], a[128:131], v[112:115]
    v_cvt_pk_bf16_f32 v72, v60, v61
    v_cvt_pk_bf16_f32 v73, v62, v63
    v_mfma_f32_16x16x32_bf16 v[112:115], a[52:55], a[132:135], v[112:115]
    s_nop 1
    v_mfma_f32_16x16x32_bf16 v[124:127], a[8:11], a[136:139], v[124:127]
    v_mul_f32 v64, v64, v76
    v_mul_f32 v65, v65, v77
    v_mfma_f32_16x16x32_bf16 v[124:127], a[36:39], a[140:143], v[124:127]
    v_mul_f32 v66, v66, v78
    v_mul_f32 v67, v67, v79
    v_mfma_f32_16x16x32_bf16 v[88:91], a[56:59], a[176:179], v[88:91]
    v_cvt_pk_bf16_f32 v74, v64, v65
    v_cvt_pk_bf16_f32 v75, v66, v67
    v_mfma_f32_16x16x32_bf16 v[88:91], a[84:87], a[180:183], v[88:91]
    buffer_store_dwordx4 v[72:75], v24, s[12:15], s59 offen offset:1024 sc1
    s_add_u32 s59, s59, 229376
    v_mfma_f32_16x16x32_bf16 v[100:103], a[96:99], a[180:183], v[100:103]
iw_d7:
    s_cbranch_execz iw_d10
    v_mfma_f32_16x16x32_bf16 v[100:103], a[68:71], a[176:179], v[100:103]
    s_nop 1
    v_mfma_f32_16x16x32_bf16 v[92:95], a[60:63], a[176:179], v[92:95]
    s_nop 1
    v_mfma_f32_16x16x32_bf16 v[92:95], a[88:91], a[180:183], v[92:95]
    s_nop 1
    v_mfma_f32_16x16x32_bf16 v[104:107], a[100:103], a[180:183], v[104:107]
    v_mul_f32 v88, v88, v100
    v_mul_f32 v89, v89, v101
    v_mfma_f32_16x16x32_bf16 v[104:107], a[72:75], a[176:179], v[104:107]
    v_mul_f32 v90, v90, v102
    v_mul_f32 v91, v91, v103
    v_mfma_f32_16x16x32_bf16 v[136:139], a[20:23], a[136:139], v[136:139]
    v_cvt_pk_bf16_f32 v100, v88, v89
    v_cvt_pk_bf16_f32 v101, v90, v91
    v_mfma_f32_16x16x32_bf16 v[136:139], a[48:51], a[140:143], v[136:139]
    s_nop 1
    v_mfma_f32_16x16x32_bf16 v[140:143], a[24:27], a[136:139], v[140:143]
    v_mul_f32 v92, v92, v104
    v_mul_f32 v93, v93, v105
    v_mfma_f32_16x16x32_bf16 v[140:143], a[52:55], a[140:143], v[140:143]
    v_mul_f32 v94, v94, v106
    v_mul_f32 v95, v95, v107
    v_mfma_f32_16x16x32_bf16 v[116:119], a[56:59], a[184:187], v[116:119]
    v_cvt_pk_bf16_f32 v102, v92, v93
    v_cvt_pk_bf16_f32 v103, v94, v95
    v_mfma_f32_16x16x32_bf16 v[116:119], a[84:87], a[188:191], v[116:119]
    buffer_store_dwordx4 v[100:103], v24, s[12:15], s59 offen offset:0 sc1
    v_mfma_f32_16x16x32_bf16 v[128:131], a[96:99], a[188:191], v[128:131]
    v_mfma_f32_16x16x32_bf16 v[128:131], a[68:71], a[184:187], v[128:131]
    s_nop 1
    v_mfma_f32_16x16x32_bf16 v[120:123], a[60:63], a[184:187], v[120:123]
    s_nop 1
    v_mfma_f32_16x16x32_bf16 v[120:123], a[88:91], a[188:191], v[120:123]
    s_nop 1
    v_mfma_f32_16x16x32_bf16 v[132:135], a[100:103], a[188:191], v[132:135]
    v_mul_f32 v116, v116, v128
    v_mul_f32 v117, v117, v129
    v_mfma_f32_16x16x32_bf16 v[132:135], a[72:75], a[184:187], v[132:135]
    v_mul_f32 v118, v118, v130
    v_mul_f32 v119, v119, v131
    v_mfma_f32_16x16x32_bf16 v[152:155], a[8:11], a[144:147], v[152:155]
    v_cvt_pk_bf16_f32 v128, v116, v117
    v_cvt_pk_bf16_f32 v129, v118, v119
    v_mfma_f32_16x16x32_bf16 v[152:155], a[36:39], a[148:151], v[152:155]
    s_nop 1
    v_mfma_f32_16x16x32_bf16 v[164:167], a[20:23], a[144:147], v[164:167]
    v_mul_f32 v120, v120, v132
    v_mul_f32 v121, v121, v133
    v_mfma_f32_16x16x32_bf16 v[164:167], a[48:51], a[148:151], v[164:167]
    v_mul_f32 v122, v122, v134
    v_mul_f32 v123, v123, v135
    v_mfma_f32_16x16x32_bf16 v[144:147], a[56:59], a[192:195], v[144:147]
    v_cvt_pk_bf16_f32 v130, v120, v121
    v_cvt_pk_bf16_f32 v131, v122, v123
    v_mfma_f32_16x16x32_bf16 v[144:147], a[84:87], a[196:199], v[144:147]
    buffer_store_dwordx4 v[128:131], v24, s[12:15], s59 offen offset:1024 sc1
    s_add_u32 s59, s59, 229376
    v_mfma_f32_16x16x32_bf16 v[156:159], a[96:99], a[196:199], v[156:159]
    v_mfma_f32_16x16x32_bf16 v[156:159], a[68:71], a[192:195], v[156:159]
    s_nop 1
    v_mfma_f32_16x16x32_bf16 v[148:151], a[60:63], a[192:195], v[148:151]
    s_nop 1
    v_mfma_f32_16x16x32_bf16 v[148:151], a[88:91], a[196:199], v[148:151]
    s_nop 1
    v_mfma_f32_16x16x32_bf16 v[160:163], a[100:103], a[196:199], v[160:163]
    v_mul_f32 v144, v144, v156
    v_mul_f32 v145, v145, v157
    v_mfma_f32_16x16x32_bf16 v[160:163], a[72:75], a[192:195], v[160:163]
    v_mul_f32 v146, v146, v158
    v_mul_f32 v147, v147, v159
    v_mfma_f32_16x16x32_bf16 v[168:171], a[24:27], a[144:147], v[168:171]
    v_cvt_pk_bf16_f32 v156, v144, v145
    v_cvt_pk_bf16_f32 v157, v146, v147
    v_mfma_f32_16x16x32_bf16 v[168:171], a[52:55], a[148:151], v[168:171]
    s_nop 1
    v_mfma_f32_16x16x32_bf16 v[180:183], a[8:11], a[152:155], v[180:183]
    v_mul_f32 v148, v148, v160
    v_mul_f32 v149, v149, v161
    v_mfma_f32_16x16x32_bf16 v[180:183], a[36:39], a[156:159], v[180:183]
    v_mul_f32 v150, v150, v162
    v_mul_f32 v151, v151, v163
    v_mfma_f32_16x16x32_bf16 v[172:175], a[56:59], a[200:203], v[172:175]
    v_cvt_pk_bf16_f32 v158, v148, v149
    v_cvt_pk_bf16_f32 v159, v150, v151
    v_mfma_f32_16x16x32_bf16 v[172:175], a[84:87], a[204:207], v[172:175]
    buffer_store_dwordx4 v[156:159], v24, s[12:15], s59 offen offset:0 sc1
    v_mfma_f32_16x16x32_bf16 v[184:187], a[96:99], a[204:207], v[184:187]
    v_mfma_f32_16x16x32_bf16 v[184:187], a[68:71], a[200:203], v[184:187]
    s_nop 1
    v_mfma_f32_16x16x32_bf16 v[176:179], a[60:63], a[200:203], v[176:179]
    s_nop 1
    v_mfma_f32_16x16x32_bf16 v[176:179], a[88:91], a[204:207], v[176:179]
    s_nop 1
    v_mfma_f32_16x16x32_bf16 v[188:191], a[100:103], a[204:207], v[188:191]
    v_mul_f32 v172, v172, v184
    v_mul_f32 v173, v173, v185
    v_mfma_f32_16x16x32_bf16 v[188:191], a[72:75], a[200:203], v[188:191]
    v_mul_f32 v174, v174, v186
    v_mul_f32 v175, v175, v187
    v_mfma_f32_16x16x32_bf16 v[192:195], a[20:23], a[152:155], v[192:195]
    v_cvt_pk_bf16_f32 v184, v172, v173
    v_cvt_pk_bf16_f32 v185, v174, v175
    v_mfma_f32_16x16x32_bf16 v[192:195], a[48:51], a[156:159], v[192:195]
    s_nop 1
    v_mfma_f32_16x16x32_bf16 v[196:199], a[24:27], a[152:155], v[196:199]
    v_mul_f32 v176, v176, v188
    v_mul_f32 v177, v177, v189
    v_mfma_f32_16x16x32_bf16 v[196:199], a[52:55], a[156:159], v[196:199]
    v_mul_f32 v178, v178, v190
    v_mul_f32 v179, v179, v191
    v_mfma_f32_16x16x32_bf16 v[200:203], a[56:59], a[208:211], v[200:203]
    v_cvt_pk_bf16_f32 v186, v176, v177
    v_cvt_pk_bf16_f32 v187, v178, v179
    v_mfma_f32_16x16x32_bf16 v[200:203], a[84:87], a[212:215], v[200:203]
    buffer_store_dwordx4 v[184:187], v24, s[12:15], s59 offen offset:1024 sc1
    s_add_u32 s59, s59, 229376
    v_mfma_f32_16x16x32_bf16 v[212:215], a[96:99], a[212:215], v[212:215]
    v_mfma_f32_16x16x32_bf16 v[212:215], a[68:71], a[208:211], v[212:215]
    s_nop 1
    v_mfma_f32_16x16x32_bf16 v[204:207], a[60:63], a[208:211], v[204:207]
    s_nop 1
    v_mfma_f32_16x16x32_bf16 v[204:207], a[88:91], a[212:215], v[204:207]
    s_nop 1
    v_mfma_f32_16x16x32_bf16 v[216:219], a[100:103], a[212:215], v[216:219]
    v_mul_f32 v200, v200, v212
    v_mul_f32 v201, v201, v213
    v_mfma_f32_16x16x32_bf16 v[216:219], a[72:75], a[208:211], v[216:219]
    v_mul_f32 v202, v202, v214
    v_mul_f32 v203, v203, v215
    v_mfma_f32_16x16x32_bf16 v[208:211], a[8:11], a[160:163], v[208:211]
    v_cvt_pk_bf16_f32 v212, v200, v201
    v_cvt_pk_bf16_f32 v213, v202, v203
    v_mfma_f32_16x16x32_bf16 v[208:211], a[36:39], a[164:167], v[208:211]
    s_nop 1
    v_mfma_f32_16x16x32_bf16 v[220:223], a[20:23], a[160:163], v[220:223]
    v_mul_f32 v204, v204, v216
    v_mul_f32 v205, v205, v217
    v_mfma_f32_16x16x32_bf16 v[220:223], a[48:51], a[164:167], v[220:223]
    v_mul_f32 v206, v206, v218
    v_mul_f32 v207, v207, v219
    v_mfma_f32_16x16x32_bf16 v[228:231], a[56:59], a[216:219], v[228:231]
    v_cvt_pk_bf16_f32 v214, v204, v205
    v_cvt_pk_bf16_f32 v215, v206, v207
    v_mfma_f32_16x16x32_bf16 v[228:231], a[84:87], a[220:223], v[228:231]
    buffer_store_dwordx4 v[212:215], v24, s[12:15], s59 offen offset:0 sc1
    v_mfma_f32_16x16x32_bf16 v[240:243], a[96:99], a[220:223], v[240:243]
    v_mfma_f32_16x16x32_bf16 v[240:243], a[68:71], a[216:219], v[240:243]
    s_nop 1
    v_mfma_f32_16x16x32_bf16 v[232:235], a[60:63], a[216:219], v[232:235]
    s_nop 1
    v_mfma_f32_16x16x32_bf16 v[232:235], a[88:91], a[220:223], v[232:235]
    s_nop 1
    v_mfma_f32_16x16x32_bf16 v[244:247], a[100:103], a[220:223], v[244:247]
    v_mul_f32 v228, v228, v240
    v_mul_f32 v229, v229, v241
    v_mfma_f32_16x16x32_bf16 v[244:247], a[72:75], a[216:219], v[244:247]
    v_mul_f32 v230, v230, v242
    v_mul_f32 v231, v231, v243
    v_mfma_f32_16x16x32_bf16 v[40:43], a[64:67], a[112:115], v[40:43]
    v_cvt_pk_bf16_f32 v240, v228, v229
    v_cvt_pk_bf16_f32 v241, v230, v231
    v_mfma_f32_16x16x32_bf16 v[40:43], a[92:95], a[116:119], v[40:43]
iw_c8:
    s_cbranch_execz iw_c11
    s_nop 1
    v_mfma_f32_16x16x32_bf16 v[52:55], a[104:107], a[116:119], v[52:55]
    v_mul_f32 v232, v232, v244
    v_mul_f32 v233, v233, v245
    v_mfma_f32_16x16x32_bf16 v[52:55], a[76:79], a[112:115], v[52:55]
    v_mul_f32 v234, v234, v246
    v_mul_f32 v235, v235, v247
    v_mfma_f32_16x16x32_bf16 v[56:59], a[80:83], a[112:115], v[56:59]
    v_cvt_pk_bf16_f32 v242, v232, v233
    v_cvt_pk_bf16_f32 v243, v234, v235
    v_mfma_f32_16x16x32_bf16 v[56:59], a[108:111], a[116:119], v[56:59]
    buffer_store_dwordx4 v[240:243], v24, s[12:15], s59 offen offset:1024 sc1
    s_add_u32 s59, s59, 229376
    v_mfma_f32_16x16x32_bf16 v[68:71], a[92:95], a[124:127], v[68:71]
    v_mul_f32 v40, v40, v52
    v_mul_f32 v41, v41, v53
    v_mfma_f32_16x16x32_bf16 v[68:71], a[64:67], a[120:123], v[68:71]
    v_mul_f32 v42, v42, v54
    v_mul_f32 v43, v43, v55
    v_mfma_f32_16x16x32_bf16 v[80:83], a[76:79], a[120:123], v[80:83]
    v_cvt_pk_bf16_f32 v52, v40, v41
    v_cvt_pk_bf16_f32 v53, v42, v43
    v_mfma_f32_16x16x32_bf16 v[80:83], a[104:107], a[124:127], v[80:83]
    s_nop 1
    v_mfma_f32_16x16x32_bf16 v[84:87], a[108:111], a[124:127], v[84:87]
    s_nop 1
    v_mfma_f32_16x16x32_bf16 v[84:87], a[80:83], a[120:123], v[84:87]
    s_nop 1
    v_mfma_f32_16x16x32_bf16 v[96:99], a[64:67], a[176:179], v[96:99]
    v_mul_f32 v68, v68, v80
    v_mul_f32 v69, v69, v81
    v_mfma_f32_16x16x32_bf16 v[96:99], a[92:95], a[180:183], v[96:99]
    v_mul_f32 v70, v70, v82
    v_mul_f32 v71, v71, v83
    v_mfma_f32_16x16x32_bf16 v[108:111], a[104:107], a[180:183], v[108:111]
    v_cvt_pk_bf16_f32 v54, v68, v69
    v_cvt_pk_bf16_f32 v55, v70, v71
    v_mfma_f32_16x16x32_bf16 v[108:111], a[76:79], a[176:179], v[108:111]
    v_permlane32_swap_b32 v52, v54
    v_permlane32_swap_b32 v53, v55
    v_mfma_f32_16x16x32_bf16 v[112:115], a[80:83], a[176:179], v[112:115]
    buffer_store_dwordx4 v[52:55], v25, s[12:15], s53 offen sc1
    s_add_u32 s53, s53, 229376
    v_mfma_f32_16x16x32_bf16 v[112:115], a[108:111], a[180:183], v[112:115]
    v_permlane32_swap_b32 v56, v84
    v_permlane32_swap_b32 v57, v85
    v_mfma_f32_16x16x32_bf16 v[124:127], a[92:95], a[188:191], v[124:127]
    v_permlane32_swap_b32 v58, v86
    v_permlane32_swap_b32 v59, v87
    v_mfma_f32_16x16x32_bf16 v[124:127], a[64:67], a[184:187], v[124:127]
    v_mul_f32 v56, v56, v84
    v_mul_f32 v57, v57, v85
    v_mfma_f32_16x16x32_bf16 v[136:139], a[76:79], a[184:187], v[136:139]
    v_mul_f32 v58, v58, v86
    v_mul_f32 v59, v59, v87
    v_mfma_f32_16x16x32_bf16 v[136:139], a[104:107], a[188:191], v[136:139]
    v_cvt_pk_bf16_f32 v40, v56, v57
    v_cvt_pk_bf16_f32 v41, v58, v59
    v_mfma_f32_16x16x32_bf16 v[140:143], a[108:111], a[188:191], v[140:143]
    v_mul_f32 v96, v96, v108
    v_mul_f32 v97, v97, v109
    v_mfma_f32_16x16x32_bf16 v[140:143], a[80:83], a[184:187], v[140:143]
    v_mul_f32 v98, v98, v110
    v_mul_f32 v99, v99, v111
    v_mfma_f32_16x16x32_bf16 v[152:155], a[64:67], a[192:195], v[152:155]
    v_cvt_pk_bf16_f32 v108, v96, v97
    v_cvt_pk_bf16_f32 v109, v98, v99
    v_mfma_f32_16x16x32_bf16 v[152:155], a[92:95], a[196:199], v[152:155]
    v_mul_f32 v124, v124, v136
    v_mul_f32 v125, v125, v137
    v_mfma_f32_16x16x32_bf16 v[164:167], a[104:107], a[196:199], v[164:167]
    v_mul_f32 v126, v126, v138
    v_mul_f32 v127, v127, v139
    v_mfma_f32_16x16x32_bf16 v[164:167], a[76:79], a[192:195], v[164:167]
    v_cvt_pk_bf16_f32 v110, v124, v125
    v_cvt_pk_bf16_f32 v111, v126, v127
    v_mfma_f32_16x16x32_bf16 v[168:171], a[80:83], a[192:195], v[168:171]
    v_permlane32_swap_b32 v108, v110
    v_permlane32_swap_b32 v109, v111
    v_mfma_f32_16x16x32_bf16 v[168:171], a[108:111], a[196:199], v[168:171]
    v_permlane32_swap_b32 v112, v140
    v_permlane32_swap_b32 v113, v141
    v_mfma_f32_16x16x32_bf16 v[180:183], a[92:95], a[204:207], v[180:183]
    v_permlane32_swap_b32 v114, v142
    v_permlane32_swap_b32 v115, v143
    v_mfma_f32_16x16x32_bf16 v[180:183], a[64:67], a[200:203], v[180:183]
    v_mul_f32 v112, v112, v140
    v_mul_f32 v113, v113, v141
    v_mfma_f32_16x16x32_bf16 v[192:195], a[76:79], a[200:203], v[192:195]
    v_mul_f32 v114, v114, v142
    v_mul_f32 v115, v115, v143
    v_mfma_f32_16x16x32_bf16 v[192:195], a[104:107], a[204:207], v[192:195]
    v_cvt_pk_bf16_f32 v42, v112, v113
    v_cvt_pk_bf16_f32 v43, v114, v115
    v_mfma_f32_16x16x32_bf16 v[196:199], a[108:111], a[204:207], v[196:199]
    v_permlane16_swap_b32 v40, v42
    v_permlane16_swap_b32 v41, v43
    v_mfma_f32_16x16x32_bf16 v[196:199], a[80:83], a[200:203], v[196:199]
    v_mul_f32 v152, v152, v164
    v_mul_f32 v153, v153, v165
    v_mfma_f32_16x16x32_bf16 v[208:211], a[64:67], a[208:211], v[208:211]
    v_mul_f32 v154, v154, v166
    v_mul_f32 v155, v155, v167
    v_mfma_f32_16x16x32_bf16 v[208:211], a[92:95], a[212:215], v[208:211]
    v_cvt_pk_bf16_f32 v164, v152, v153
    v_cvt_pk_bf16_f32 v165, v154, v155
    v_mfma_f32_16x16x32_bf16 v[220:223], a[104:107], a[212:215], v[220:223]
    v_mul_f32 v180, v180, v192
    v_mul_f32 v181, v181, v193
    v_mfma_f32_16x16x32_bf16 v[220:223], a[76:79], a[208:211], v[220:223]
    v_mul_f32 v182, v182, v194
    v_mul_f32 v183, v183, v195
    v_mfma_f32_16x16x32_bf16 v[224:227], a[24:27], a[160:163], v[224:227]
    v_cvt_pk_bf16_f32 v166, v180, v181
    v_cvt_pk_bf16_f32 v167, v182, v183
    v_mfma_f32_16x16x32_bf16 v[224:227], a[52:55], a[164:167], v[224:227]
    s_add_u32 s63, s63, 1
    s_lshl_b32 s33, s3, 29
    v_mfma_f32_16x16x32_bf16 v[224:227], a[80:83], a[208:211], v[224:227]
    v_mov_b32 v5, s63
    v_mov_b32 v4, s33
    v_mfma_f32_16x16x32_bf16 v[224:227], a[108:111], a[212:215], v[224:227]
    s_waitcnt vmcnt(1)
    s_barrier
    v_mfma_f32_16x16x32_bf16 v[236:239], a[92:95], a[220:223], v[236:239]
    buffer_store_dword v5, v4, s[12:15], s94 offen sc1
    v_mfma_f32_16x16x32_bf16 v[236:239], a[64:67], a[216:219], v[236:239]
    v_permlane32_swap_b32 v164, v166
    v_permlane32_swap_b32 v165, v167
    v_mfma_f32_16x16x32_bf16 v[236:239], a[36:39], a[172:175], v[236:239]
    buffer_store_dwordx4 v[108:111], v25, s[12:15], s53 offen sc1
    s_add_u32 s53, s53, 229376
    v_mfma_f32_16x16x32_bf16 v[236:239], a[8:11], a[168:171], v[236:239]
    v_permlane32_swap_b32 v168, v196
    v_permlane32_swap_b32 v169, v197
    v_mfma_f32_16x16x32_bf16 v[248:251], a[20:23], a[168:171], v[248:251]
    v_permlane32_swap_b32 v170, v198
    v_permlane32_swap_b32 v171, v199
    v_mfma_f32_16x16x32_bf16 v[248:251], a[48:51], a[172:175], v[248:251]
    v_mul_f32 v168, v168, v196
    v_mul_f32 v169, v169, v197
    v_mfma_f32_16x16x32_bf16 v[248:251], a[76:79], a[216:219], v[248:251]
    v_mul_f32 v170, v170, v198
    v_mul_f32 v171, v171, v199
    v_mfma_f32_16x16x32_bf16 v[248:251], a[104:107], a[220:223], v[248:251]
    buffer_store_dwordx4 v[40:43], v26, s[12:15], s52 offen sc1
    s_add_u32 s52, s52, 458752
    v_mfma_f32_16x16x32_bf16 v[252:255], a[108:111], a[220:223], v[252:255]
    v_cvt_pk_bf16_f32 v152, v168, v169
    v_cvt_pk_bf16_f32 v153, v170, v171
    v_mfma_f32_16x16x32_bf16 v[252:255], a[80:83], a[216:219], v[252:255]
    v_mul_f32 v208, v208, v220
    v_mul_f32 v209, v209, v221
    v_mfma_f32_16x16x32_bf16 v[252:255], a[52:55], a[172:175], v[252:255]
    v_mul_f32 v210, v210, v222
    v_mul_f32 v211, v211, v223
    v_mfma_f32_16x16x32_bf16 v[252:255], a[24:27], a[168:171], v[252:255]
    v_cvt_pk_bf16_f32 v220, v208, v209
    v_cvt_pk_bf16_f32 v221, v210, v211
    buffer_store_dwordx4 v[164:167], v25, s[12:15], s53 offen sc1
    s_add_u32 s53, s53, 229376
    v_mul_f32 v236, v236, v248
iw_d8:
    s_cbranch_execz iw_d11
    v_mul_f32 v237, v237, v249
    v_mul_f32 v238, v238, v250
    v_mul_f32 v239, v239, v251
    v_cvt_pk_bf16_f32 v222, v236, v237
    v_cvt_pk_bf16_f32 v223, v238, v239
    s_nop 0
    v_permlane32_swap_b32 v220, v222
    v_permlane32_swap_b32 v221, v223
    buffer_store_dwordx4 v[220:223], v25, s[12:15], s53 offen sc1
    s_add_u32 s53, s53, 229376
    v_permlane32_swap_b32 v224, v252
    v_permlane32_swap_b32 v225, v253
    v_permlane32_swap_b32 v226, v254
    v_permlane32_swap_b32 v227, v255
    v_mul_f32 v224, v224, v252
    v_mul_f32 v225, v225, v253
    v_mul_f32 v226, v226, v254
    v_mul_f32 v227, v227, v255
    v_cvt_pk_bf16_f32 v154, v224, v225
    v_cvt_pk_bf16_f32 v155, v226, v227
    s_nop 0
    v_permlane16_swap_b32 v152, v154
    v_permlane16_swap_b32 v153, v155
    buffer_store_dwordx4 v[152:155], v26, s[12:15], s52 offen sc1
    s_add_u32 s52, s52, 458752
    s_xor_b32 s54, s54, 0x10000
    v_add_u32 v8, 256, v3
    v_add_u32 v12, 133376, v3
    s_lshl_b32 s58, s4, 3
    s_bfe_u32 s35, s5, 0x10003
    s_lshl_b32 s35, s35, 2
    s_add_u32 s58, s58, s35
    s_add_u32 s58, s58, s3
    s_mul_i32 s55, s58, 229376
    s_mul_i32 s36, s57, 114688
    s_add_u32 s55, s55, s36
    s_add_u32 s55, s55, s7
    s_add_u32 s55, s55, 12582912
    s_lshl_b32 s35, s57, 10
    v_add_u32 v17, s35, v3
    v_xor_b32 v18, 1024, v17
    ds_read_b128 v[160:163], v8 offset:0
    ds_read_b128 v[164:167], v8 offset:8192
    ds_read_b128 v[168:171], v8 offset:1024
    ds_read_b128 v[172:175], v8 offset:9216
    ds_read_b128 v[176:179], v8 offset:2048
    ds_read_b128 v[180:183], v8 offset:10240
    ds_read_b128 v[184:187], v8 offset:3072
    ds_read_b128 v[188:191], v8 offset:11264
    ds_read_b128 v[192:195], v8 offset:4096
    ds_read_b128 v[196:199], v8 offset:12288
    ds_read_b128 v[200:203], v8 offset:5120
    ds_read_b128 v[204:207], v8 offset:13312
    ds_read_b128 v[208:211], v8 offset:6144
    ds_read_b128 v[212:215], v8 offset:14336
    ds_read_b128 v[216:219], v8 offset:7168
    ds_read_b128 v[220:223], v8 offset:15360
    v_mov_b64 v[32:33], 0
    v_mov_b64 v[34:35], 0
    v_mov_b64 v[36:37], 0
    v_mov_b64 v[38:39], 0
    v_mov_b64 v[40:41], 0
    v_mov_b64 v[42:43], 0
    v_mov_b64 v[44:45], 0
    v_mov_b64 v[46:47], 0
    v_mov_b64 v[48:49], 0
    v_mov_b64 v[50:51], 0
    v_mov_b64 v[52:53], 0
    v_mov_b64 v[54:55], 0
    v_mov_b64 v[56:57], 0
    v_mov_b64 v[58:59], 0
    v_mov_b64 v[60:61], 0
    v_mov_b64 v[62:63], 0
    v_mov_b64 v[64:65], 0
    v_mov_b64 v[66:67], 0
    v_mov_b64 v[68:69], 0
    v_mov_b64 v[70:71], 0
    v_mov_b64 v[72:73], 0
    v_mov_b64 v[74:75], 0
    v_mov_b64 v[76:77], 0
    v_mov_b64 v[78:79], 0
    v_mov_b64 v[80:81], 0
    v_mov_b64 v[82:83], 0
    v_mov_b64 v[84:85], 0
    v_mov_b64 v[86:87], 0
    v_mov_b64 v[88:89], 0
    v_mov_b64 v[90:91], 0
    v_mov_b64 v[92:93], 0
    v_mov_b64 v[94:95], 0
    s_lshl_b32 s39, s58, 1
    s_add_u32 s39, s39, s57
    s_lshl_b32 s39, s39, 15
    s_and_b32 s35, s5, 7
    v_and_b32 v6, 15, v2
    v_and_b32 v7, 48, v2
    v_lshl_add_u32 v24, v6, 11, v7
    s_lshl_b32 s36, s35, 12
    s_add_u32 s36, s36, s39
    s_lshl_b32 s35, s35, 8
    s_add_u32 s39, s39, s35
    s_lshl_b32 s35, s6, 31
    v_or_b32 v26, s35, v3
    v_xor_b32 v27, 0x80000000, v26
    s_lshl_b32 s33, s4, 19
    s_and_b32 s35, s5, 7
    s_lshl_b32 s35, s35, 16
    s_add_u32 s33, s33, s35
    s_bfe_u32 s35, s39, 0x4000f
    s_lshl_b32 s35, s35, 10
    s_add_u32 s33, s33, s35
    s_add_u32 s33, s33, 48234496
    s_lshr_b32 s38, s39, 15
    s_lshl_b32 s38, s38, 8
    s_add_u32 s38, s38, 8388608
    v_lshlrev_b32 v7, 4, v6
    v_and_b32 v7, 0x80, v7
    v_lshl_add_u32 v25, v6, 3, v7
    v_and_b32 v7, 0x80000000, v27
    v_or_b32 v25, v25, v7
    s_add_u32 s34, s36, 52428800
    s_lshl_b32 s35, s57, 22
    s_add_u32 s35, s35, 23068672
    s_cmp_eq_u32 s6, 0
    s_cselect_b32 s35, s35, 52428800
    s_xor_b32 s37, s36, 0x8000
    s_add_u32 s36, s36, s35
    s_add_u32 s37, s37, s35
    v_and_b32 v4, 7, v2
    v_bfe_u32 v5, v2, 3, 1
    v_lshlrev_b32 v4, 5, v4
    v_lshl_or_b32 v4, v5, 1, v4
    s_and_b32 s35, s2, 0x1d
    v_or_b32 v4, s35, v4
    v_lshlrev_b32 v9, 7, v4
    s_cmp_lg_u32 s3, 0
    s_cbranch_scc1 interl_wt56
    s_and_b32 s62, s5, 16
    s_lshl_b32 exec_lo, 0xffff, s62
    s_mov_b32 exec_hi, 0
    s_mov_b32 s62, 4000000
interl_poll57:
    buffer_load_dword v7, v0, s[12:15], s95 offen sc1
    s_sub_u32 s62, s62, 1
    s_cbranch_scc1 interl_pd58
    s_waitcnt vmcnt(0)
    v_cmp_gt_u32 vcc, s63, v7
    s_cbranch_vccnz interl_poll57
interl_pd58:
    s_mov_b64 exec, -1
interl_wt56:
    s_waitcnt vmcnt(0)
    s_barrier
    buffer_load_dwordx4 v[96:99], v17, s[12:15], s55 offen offset:0 sc1
    buffer_load_dwordx4 v[100:103], v18, s[12:15], s55 offen offset:0 sc1
    buffer_load_dwordx4 v[104:107], v17, s[12:15], s55 offen offset:2048 sc1
    buffer_load_dwordx4 v[108:111], v18, s[12:15], s55 offen offset:2048 sc1
    s_add_u32 s55, s55, 4096
    buffer_load_dwordx4 v[112:115], v17, s[12:15], s55 offen offset:0 sc1
    buffer_load_dwordx4 v[116:119], v18, s[12:15], s55 offen offset:0 sc1
    buffer_load_dwordx4 v[120:123], v17, s[12:15], s55 offen offset:2048 sc1
    buffer_load_dwordx4 v[124:127], v18, s[12:15], s55 offen offset:2048 sc1
    s_add_u32 s55, s55, 4096
    buffer_load_dwordx4 v[128:131], v17, s[12:15], s55 offen offset:0 sc1
    buffer_load_dwordx4 v[132:135], v18, s[12:15], s55 offen offset:0 sc1
    buffer_load_dwordx4 v[136:139], v17, s[12:15], s55 offen offset:2048 sc1
    buffer_load_dwordx4 v[140:143], v18, s[12:15], s55 offen offset:2048 sc1
    s_add_u32 s55, s55, 4096
    s_add_u32 s63, s63, 1
    v_mov_b32 v4, 0
    v_mov_b32 v5, s63
    s_cmp_lg_u32 s3, 0
    s_waitcnt vmcnt(8)
    s_cbranch_scc1 interl_sg59
    s_mov_b64 exec, 1
    buffer_store_dword v5, v4, s[12:15], s94 offen sc1
    s_mov_b64 exec, -1
interl_sg59:
    s_mov_b32 s56, 6
    s_mov_b32 s41, 1
    s_lshl_b32 s42, s3, 3
    s_add_u32 s42, s42, 3
    s_xor_b32 s48, s57, 1
    s_lshl_b32 s48, s48, 4
    v_mov_b32 v7, 0
    s_mov_b64 s[24:25], s[12:13]
interl_g2loop61:
    s_waitcnt vmcnt(16) lgkmcnt(12)
    v_mfma_f32_16x16x32_bf16 v[32:35], v[160:163], v[96:99], v[32:35]
    s_barrier
    v_mfma_f32_16x16x32_bf16 v[32:35], v[164:167], v[104:107], v[32:35]
    buffer_load_dwordx4 v[144:147], v17, s[12:15], s55 offen offset:0 sc1
    v_mfma_f32_16x16x32_bf16 v[64:67], v[164:167], v[108:111], v[64:67]
    ds_read_b128 v[164:167], v8 offset:24576
    v_mfma_f32_16x16x32_bf16 v[64:67], v[160:163], v[100:103], v[64:67]
    ds_read_b128 v[160:163], v8 offset:16384
    v_mfma_f32_16x16x32_bf16 v[68:71], v[168:171], v[100:103], v[68:71]
iw_c9:
    s_cbranch_execz iw_c12
    v_mfma_f32_16x16x32_bf16 v[68:71], v[172:175], v[108:111], v[68:71]
    buffer_load_dwordx4 v[148:151], v18, s[12:15], s55 offen offset:0 sc1
    v_mfma_f32_16x16x32_bf16 v[36:39], v[172:175], v[104:107], v[36:39]
    ds_read_b128 v[172:175], v8 offset:25600
    v_mfma_f32_16x16x32_bf16 v[36:39], v[168:171], v[96:99], v[36:39]
    ds_read_b128 v[168:171], v8 offset:17408
    s_waitcnt lgkmcnt(12)
    v_mfma_f32_16x16x32_bf16 v[40:43], v[176:179], v[96:99], v[40:43]
    v_mfma_f32_16x16x32_bf16 v[40:43], v[180:183], v[104:107], v[40:43]
    buffer_load_dwordx4 v[152:155], v17, s[12:15], s55 offen offset:2048 sc1
    v_mfma_f32_16x16x32_bf16 v[72:75], v[180:183], v[108:111], v[72:75]
    ds_read_b128 v[180:183], v8 offset:26624
    v_mfma_f32_16x16x32_bf16 v[72:75], v[176:179], v[100:103], v[72:75]
    ds_read_b128 v[176:179], v8 offset:18432
    v_mfma_f32_16x16x32_bf16 v[76:79], v[184:187], v[100:103], v[76:79]
    v_mfma_f32_16x16x32_bf16 v[76:79], v[188:191], v[108:111], v[76:79]
    buffer_load_dwordx4 v[156:159], v18, s[12:15], s55 offen offset:2048 sc1
    v_mfma_f32_16x16x32_bf16 v[44:47], v[188:191], v[104:107], v[44:47]
    ds_read_b128 v[188:191], v8 offset:27648
    s_add_u32 s55, s55, 4096
    v_mfma_f32_16x16x32_bf16 v[44:47], v[184:187], v[96:99], v[44:47]
    ds_read_b128 v[184:187], v8 offset:19456
    s_waitcnt lgkmcnt(12)
    v_mfma_f32_16x16x32_bf16 v[48:51], v[192:195], v[96:99], v[48:51]
    s_add_u32 m0, s54, 0
    v_mfma_f32_16x16x32_bf16 v[48:51], v[196:199], v[104:107], v[48:51]
    buffer_load_dwordx4 v3, s[28:31], s40 offen offset:0 sc1 lds
    v_mfma_f32_16x16x32_bf16 v[80:83], v[196:199], v[108:111], v[80:83]
    ds_read_b128 v[196:199], v8 offset:28672
    v_mfma_f32_16x16x32_bf16 v[80:83], v[192:195], v[100:103], v[80:83]
    ds_read_b128 v[192:195], v8 offset:20480
    v_mfma_f32_16x16x32_bf16 v[84:87], v[200:203], v[100:103], v[84:87]
    v_mfma_f32_16x16x32_bf16 v[84:87], v[204:207], v[108:111], v[84:87]
    buffer_load_dwordx4 v3, s[28:31], s40 offen offset:1024 sc1 lds
    v_mfma_f32_16x16x32_bf16 v[52:55], v[204:207], v[104:107], v[52:55]
    ds_read_b128 v[204:207], v8 offset:29696
    v_mfma_f32_16x16x32_bf16 v[52:55], v[200:203], v[96:99], v[52:55]
    ds_read_b128 v[200:203], v8 offset:21504
    s_waitcnt lgkmcnt(12)
    v_mfma_f32_16x16x32_bf16 v[56:59], v[208:211], v[96:99], v[56:59]
    v_cmp_gt_u32 vcc, s41, v7
    v_mfma_f32_16x16x32_bf16 v[56:59], v[212:215], v[104:107], v[56:59]
    buffer_load_dwordx4 v3, s[28:31], s40 offen offset:2048 sc1 lds
    v_mfma_f32_16x16x32_bf16 v[88:91], v[212:215], v[108:111], v[88:91]
    ds_read_b128 v[212:215], v8 offset:30720
    v_mfma_f32_16x16x32_bf16 v[88:91], v[208:211], v[100:103], v[88:91]
    ds_read_b128 v[208:211], v8 offset:22528
    v_mfma_f32_16x16x32_bf16 v[92:95], v[216:219], v[100:103], v[92:95]
    v_mfma_f32_16x16x32_bf16 v[92:95], v[220:223], v[108:111], v[92:95]
    buffer_load_dwordx4 v3, s[28:31], s40 offen offset:3072 sc1 lds
    s_cbranch_vccnz interl_g2f63
interl_g2b64:
    v_mfma_f32_16x16x32_bf16 v[60:63], v[220:223], v[104:107], v[60:63]
    ds_read_b128 v[220:223], v8 offset:31744
    s_add_u32 s40, s40, 16384
    v_mfma_f32_16x16x32_bf16 v[60:63], v[216:219], v[96:99], v[60:63]
    ds_read_b128 v[216:219], v8 offset:23552
    s_waitcnt vmcnt(16) lgkmcnt(12)
    v_mfma_f32_16x16x32_bf16 v[32:35], v[160:163], v[112:115], v[32:35]
    s_barrier
    s_sub_u32 s56, s56, 1
    v_mfma_f32_16x16x32_bf16 v[32:35], v[164:167], v[120:123], v[32:35]
    buffer_load_dwordx4 v[96:99], v17, s[12:15], s55 offen offset:0 sc1
    v_mfma_f32_16x16x32_bf16 v[64:67], v[164:167], v[124:127], v[64:67]
    ds_read_b128 v[164:167], v8 offset:40960
    v_mfma_f32_16x16x32_bf16 v[64:67], v[160:163], v[116:119], v[64:67]
    ds_read_b128 v[160:163], v8 offset:32768
    v_mfma_f32_16x16x32_bf16 v[68:71], v[168:171], v[116:119], v[68:71]
    s_cmp_eq_u32 s56, s42
    s_cselect_b32 s41, s63, 0
    v_mfma_f32_16x16x32_bf16 v[68:71], v[172:175], v[124:127], v[68:71]
    buffer_load_dwordx4 v[100:103], v18, s[12:15], s55 offen offset:0 sc1
    v_mfma_f32_16x16x32_bf16 v[36:39], v[172:175], v[120:123], v[36:39]
    ds_read_b128 v[172:175], v8 offset:41984
    v_mfma_f32_16x16x32_bf16 v[36:39], v[168:171], v[112:115], v[36:39]
    ds_read_b128 v[168:171], v8 offset:33792
    s_waitcnt lgkmcnt(12)
    v_mfma_f32_16x16x32_bf16 v[40:43], v[176:179], v[112:115], v[40:43]
    s_cselect_b32 s26, s14, 0
    v_mfma_f32_16x16x32_bf16 v[40:43], v[180:183], v[120:123], v[40:43]
    buffer_load_dwordx4 v[104:107], v17, s[12:15], s55 offen offset:2048 sc1
    v_mfma_f32_16x16x32_bf16 v[72:75], v[180:183], v[124:127], v[72:75]
    ds_read_b128 v[180:183], v8 offset:43008
    v_mfma_f32_16x16x32_bf16 v[72:75], v[176:179], v[116:119], v[72:75]
    ds_read_b128 v[176:179], v8 offset:34816
    v_mfma_f32_16x16x32_bf16 v[76:79], v[184:187], v[116:119], v[76:79]
    v_mfma_f32_16x16x32_bf16 v[76:79], v[188:191], v[124:127], v[76:79]
    buffer_load_dwordx4 v[108:111], v18, s[12:15], s55 offen offset:2048 sc1
    v_mfma_f32_16x16x32_bf16 v[44:47], v[188:191], v[120:123], v[44:47]
    ds_read_b128 v[188:191], v8 offset:44032
    s_add_u32 s55, s55, 4096
    v_mfma_f32_16x16x32_bf16 v[44:47], v[184:187], v[112:115], v[44:47]
    ds_read_b128 v[184:187], v8 offset:35840
    s_waitcnt lgkmcnt(12)
    v_mfma_f32_16x16x32_bf16 v[48:51], v[192:195], v[112:115], v[48:51]
    s_add_u32 m0, s54, 16384
    v_mfma_f32_16x16x32_bf16 v[48:51], v[196:199], v[120:123], v[48:51]
    buffer_load_dwordx4 v3, s[28:31], s40 offen offset:0 sc1 lds
    v_mfma_f32_16x16x32_bf16 v[80:83], v[196:199], v[124:127], v[80:83]
    ds_read_b128 v[196:199], v8 offset:45056
    v_mfma_f32_16x16x32_bf16 v[80:83], v[192:195], v[116:119], v[80:83]
    ds_read_b128 v[192:195], v8 offset:36864
    v_mfma_f32_16x16x32_bf16 v[84:87], v[200:203], v[116:119], v[84:87]
    v_mfma_f32_16x16x32_bf16 v[84:87], v[204:207], v[124:127], v[84:87]
    buffer_load_dwordx4 v3, s[28:31], s40 offen offset:1024 sc1 lds
    v_mfma_f32_16x16x32_bf16 v[52:55], v[204:207], v[120:123], v[52:55]
    ds_read_b128 v[204:207], v8 offset:46080
    v_mfma_f32_16x16x32_bf16 v[52:55], v[200:203], v[112:115], v[52:55]
    ds_read_b128 v[200:203], v8 offset:37888
    s_waitcnt lgkmcnt(12)
    v_mfma_f32_16x16x32_bf16 v[56:59], v[208:211], v[112:115], v[56:59]
    v_mfma_f32_16x16x32_bf16 v[56:59], v[212:215], v[120:123], v[56:59]
    buffer_load_dwordx4 v3, s[28:31], s40 offen offset:2048 sc1 lds
    v_mfma_f32_16x16x32_bf16 v[88:91], v[212:215], v[124:127], v[88:91]
    ds_read_b128 v[212:215], v8 offset:47104
    v_mfma_f32_16x16x32_bf16 v[88:91], v[208:211], v[116:119], v[88:91]
    ds_read_b128 v[208:211], v8 offset:38912
    v_mfma_f32_16x16x32_bf16 v[92:95], v[216:219], v[116:119], v[92:95]
    v_mfma_f32_16x16x32_bf16 v[92:95], v[220:223], v[124:127], v[92:95]
    buffer_load_dwordx4 v3, s[28:31], s40 offen offset:3072 sc1 lds
    v_mfma_f32_16x16x32_bf16 v[60:63], v[220:223], v[120:123], v[60:63]
    ds_read_b128 v[220:223], v8 offset:48128
    s_add_u32 s40, s40, 16384
    v_mfma_f32_16x16x32_bf16 v[60:63], v[216:219], v[112:115], v[60:63]
    ds_read_b128 v[216:219], v8 offset:39936
    buffer_load_dword v7, v9, s[24:27], s95 offen sc1
    s_waitcnt vmcnt(17) lgkmcnt(12)
    v_mfma_f32_16x16x32_bf16 v[32:35], v[160:163], v[128:131], v[32:35]
    s_barrier
    v_mfma_f32_16x16x32_bf16 v[32:35], v[164:167], v[136:139], v[32:35]
    buffer_load_dwordx4 v[112:115], v17, s[12:15], s55 offen offset:0 sc1
    v_mfma_f32_16x16x32_bf16 v[64:67], v[164:167], v[140:143], v[64:67]
    ds_read_b128 v[164:167], v8 offset:57344
    v_mfma_f32_16x16x32_bf16 v[64:67], v[160:163], v[132:135], v[64:67]
    ds_read_b128 v[160:163], v8 offset:49152
    v_mfma_f32_16x16x32_bf16 v[68:71], v[168:171], v[132:135], v[68:71]
iw_d9:
    s_cbranch_execz iw_d12
    v_mfma_f32_16x16x32_bf16 v[68:71], v[172:175], v[140:143], v[68:71]
    buffer_load_dwordx4 v[116:119], v18, s[12:15], s55 offen offset:0 sc1
    v_mfma_f32_16x16x32_bf16 v[36:39], v[172:175], v[136:139], v[36:39]
    ds_read_b128 v[172:175], v8 offset:58368
    v_mfma_f32_16x16x32_bf16 v[36:39], v[168:171], v[128:131], v[36:39]
    ds_read_b128 v[168:171], v8 offset:50176
    s_waitcnt lgkmcnt(12)
    v_mfma_f32_16x16x32_bf16 v[40:43], v[176:179], v[128:131], v[40:43]
    v_mfma_f32_16x16x32_bf16 v[40:43], v[180:183], v[136:139], v[40:43]
    buffer_load_dwordx4 v[120:123], v17, s[12:15], s55 offen offset:2048 sc1
    v_mfma_f32_16x16x32_bf16 v[72:75], v[180:183], v[140:143], v[72:75]
    ds_read_b128 v[180:183], v8 offset:59392
    v_mfma_f32_16x16x32_bf16 v[72:75], v[176:179], v[132:135], v[72:75]
    ds_read_b128 v[176:179], v8 offset:51200
    v_mfma_f32_16x16x32_bf16 v[76:79], v[184:187], v[132:135], v[76:79]
    v_mfma_f32_16x16x32_bf16 v[76:79], v[188:191], v[140:143], v[76:79]
    buffer_load_dwordx4 v[124:127], v18, s[12:15], s55 offen offset:2048 sc1
    v_mfma_f32_16x16x32_bf16 v[44:47], v[188:191], v[136:139], v[44:47]
    ds_read_b128 v[188:191], v8 offset:60416
    s_add_u32 s55, s55, 4096
    v_mfma_f32_16x16x32_bf16 v[44:47], v[184:187], v[128:131], v[44:47]
    ds_read_b128 v[184:187], v8 offset:52224
    s_waitcnt lgkmcnt(12)
    v_mfma_f32_16x16x32_bf16 v[48:51], v[192:195], v[128:131], v[48:51]
    s_add_u32 m0, s54, 32768
    v_mfma_f32_16x16x32_bf16 v[48:51], v[196:199], v[136:139], v[48:51]
    buffer_load_dwordx4 v3, s[28:31], s40 offen offset:0 sc1 lds
    v_mfma_f32_16x16x32_bf16 v[80:83], v[196:199], v[140:143], v[80:83]
    ds_read_b128 v[196:199], v8 offset:61440
    v_mfma_f32_16x16x32_bf16 v[80:83], v[192:195], v[132:135], v[80:83]
    ds_read_b128 v[192:195], v8 offset:53248
    v_mfma_f32_16x16x32_bf16 v[84:87], v[200:203], v[132:135], v[84:87]
    v_mfma_f32_16x16x32_bf16 v[84:87], v[204:207], v[140:143], v[84:87]
    buffer_load_dwordx4 v3, s[28:31], s40 offen offset:1024 sc1 lds
    v_mfma_f32_16x16x32_bf16 v[52:55], v[204:207], v[136:139], v[52:55]
    ds_read_b128 v[204:207], v8 offset:62464
    v_mfma_f32_16x16x32_bf16 v[52:55], v[200:203], v[128:131], v[52:55]
    ds_read_b128 v[200:203], v8 offset:54272
    s_waitcnt lgkmcnt(12)
    v_mfma_f32_16x16x32_bf16 v[56:59], v[208:211], v[128:131], v[56:59]
    v_mfma_f32_16x16x32_bf16 v[56:59], v[212:215], v[136:139], v[56:59]
    buffer_load_dwordx4 v3, s[28:31], s40 offen offset:2048 sc1 lds
    v_mfma_f32_16x16x32_bf16 v[88:91], v[212:215], v[140:143], v[88:91]
    ds_read_b128 v[212:215], v8 offset:63488
    v_mfma_f32_16x16x32_bf16 v[88:91], v[208:211], v[132:135], v[88:91]
    ds_read_b128 v[208:211], v8 offset:55296
    v_mfma_f32_16x16x32_bf16 v[92:95], v[216:219], v[132:135], v[92:95]
    v_mfma_f32_16x16x32_bf16 v[92:95], v[220:223], v[140:143], v[92:95]
    buffer_load_dwordx4 v3, s[28:31], s40 offen offset:3072 sc1 lds
    v_mfma_f32_16x16x32_bf16 v[60:63], v[220:223], v[136:139], v[60:63]
    ds_read_b128 v[220:223], v8 offset:64512
    s_add_u32 s40, s40, 16384
    v_mfma_f32_16x16x32_bf16 v[60:63], v[216:219], v[128:131], v[60:63]
    ds_read_b128 v[216:219], v8 offset:56320
    s_waitcnt vmcnt(17) lgkmcnt(12)
    v_mfma_f32_16x16x32_bf16 v[32:35], v[160:163], v[144:147], v[32:35]
    s_barrier
    v_mfma_f32_16x16x32_bf16 v[32:35], v[164:167], v[152:155], v[32:35]
    v_xor_b32 v8, 0x10000, v8
    buffer_load_dwordx4 v[128:131], v17, s[12:15], s55 offen offset:0 sc1
    v_mfma_f32_16x16x32_bf16 v[64:67], v[164:167], v[156:159], v[64:67]
    ds_read_b128 v[164:167], v8 offset:8192
    v_mfma_f32_16x16x32_bf16 v[64:67], v[160:163], v[148:151], v[64:67]
    ds_read_b128 v[160:163], v8 offset:0
    v_mfma_f32_16x16x32_bf16 v[68:71], v[168:171], v[148:151], v[68:71]
    v_mfma_f32_16x16x32_bf16 v[68:71], v[172:175], v[156:159], v[68:71]
    buffer_load_dwordx4 v[132:135], v18, s[12:15], s55 offen offset:0 sc1
    v_mfma_f32_16x16x32_bf16 v[36:39], v[172:175], v[152:155], v[36:39]
    ds_read_b128 v[172:175], v8 offset:9216
    v_mfma_f32_16x16x32_bf16 v[36:39], v[168:171], v[144:147], v[36:39]
    ds_read_b128 v[168:171], v8 offset:1024
    s_waitcnt lgkmcnt(12)
    v_mfma_f32_16x16x32_bf16 v[40:43], v[176:179], v[144:147], v[40:43]
    v_mfma_f32_16x16x32_bf16 v[40:43], v[180:183], v[152:155], v[40:43]
    buffer_load_dwordx4 v[136:139], v17, s[12:15], s55 offen offset:2048 sc1
    v_mfma_f32_16x16x32_bf16 v[72:75], v[180:183], v[156:159], v[72:75]
    ds_read_b128 v[180:183], v8 offset:10240
    v_mfma_f32_16x16x32_bf16 v[72:75], v[176:179], v[148:151], v[72:75]
    ds_read_b128 v[176:179], v8 offset:2048
    v_mfma_f32_16x16x32_bf16 v[76:79], v[184:187], v[148:151], v[76:79]
    v_mfma_f32_16x16x32_bf16 v[76:79], v[188:191], v[156:159], v[76:79]
    buffer_load_dwordx4 v[140:143], v18, s[12:15], s55 offen offset:2048 sc1
    v_mfma_f32_16x16x32_bf16 v[44:47], v[188:191], v[152:155], v[44:47]
    ds_read_b128 v[188:191], v8 offset:11264
    s_add_u32 s55, s55, 4096
    v_mfma_f32_16x16x32_bf16 v[44:47], v[184:187], v[144:147], v[44:47]
    ds_read_b128 v[184:187], v8 offset:3072
    s_waitcnt lgkmcnt(12)
    v_mfma_f32_16x16x32_bf16 v[48:51], v[192:195], v[144:147], v[48:51]
    s_add_u32 m0, s54, 49152
    v_mfma_f32_16x16x32_bf16 v[48:51], v[196:199], v[152:155], v[48:51]
    buffer_load_dwordx4 v3, s[28:31], s40 offen offset:0 sc1 lds
    v_mfma_f32_16x16x32_bf16 v[80:83], v[196:199], v[156:159], v[80:83]
    ds_read_b128 v[196:199], v8 offset:12288
    v_mfma_f32_16x16x32_bf16 v[80:83], v[192:195], v[148:151], v[80:83]
    ds_read_b128 v[192:195], v8 offset:4096
    v_mfma_f32_16x16x32_bf16 v[84:87], v[200:203], v[148:151], v[84:87]
    s_xor_b32 s54, s54, 0x10000
    v_mfma_f32_16x16x32_bf16 v[84:87], v[204:207], v[156:159], v[84:87]
    buffer_load_dwordx4 v3, s[28:31], s40 offen offset:1024 sc1 lds
    v_mfma_f32_16x16x32_bf16 v[52:55], v[204:207], v[152:155], v[52:55]
    ds_read_b128 v[204:207], v8 offset:13312
    v_mfma_f32_16x16x32_bf16 v[52:55], v[200:203], v[144:147], v[52:55]
    ds_read_b128 v[200:203], v8 offset:5120
    s_waitcnt lgkmcnt(12)
    v_mfma_f32_16x16x32_bf16 v[56:59], v[208:211], v[144:147], v[56:59]
    v_mfma_f32_16x16x32_bf16 v[56:59], v[212:215], v[152:155], v[56:59]
    buffer_load_dwordx4 v3, s[28:31], s40 offen offset:2048 sc1 lds
    v_mfma_f32_16x16x32_bf16 v[88:91], v[212:215], v[156:159], v[88:91]
    ds_read_b128 v[212:215], v8 offset:14336
    v_mfma_f32_16x16x32_bf16 v[88:91], v[208:211], v[148:151], v[88:91]
    ds_read_b128 v[208:211], v8 offset:6144
    v_mfma_f32_16x16x32_bf16 v[92:95], v[216:219], v[148:151], v[92:95]
    v_mfma_f32_16x16x32_bf16 v[92:95], v[220:223], v[156:159], v[92:95]
    buffer_load_dwordx4 v3, s[28:31], s40 offen offset:3072 sc1 lds
    v_mfma_f32_16x16x32_bf16 v[60:63], v[220:223], v[152:155], v[60:63]
    ds_read_b128 v[220:223], v8 offset:15360
    s_add_u32 s40, s40, 16384
    s_cmp_lg_u32 s56, 1
    v_mfma_f32_16x16x32_bf16 v[60:63], v[216:219], v[144:147], v[60:63]
    ds_read_b128 v[216:219], v8 offset:7168
    s_cbranch_scc1 interl_g2loop61
interl_g2z60:
    s_waitcnt vmcnt(17) lgkmcnt(12)
    v_mfma_f32_16x16x32_bf16 v[32:35], v[160:163], v[96:99], v[32:35]
    s_barrier
    v_mfma_f32_16x16x32_bf16 v[32:35], v[164:167], v[104:107], v[32:35]
    buffer_load_dwordx4 v[144:147], v17, s[12:15], s55 offen offset:0 sc1
    v_mfma_f32_16x16x32_bf16 v[64:67], v[164:167], v[108:111], v[64:67]
    ds_read_b128 v[164:167], v8 offset:24576
    v_mfma_f32_16x16x32_bf16 v[64:67], v[160:163], v[100:103], v[64:67]
    ds_read_b128 v[160:163], v8 offset:16384
    v_mfma_f32_16x16x32_bf16 v[68:71], v[168:171], v[100:103], v[68:71]
iw_c10:
    s_cbranch_execz iw_c13
    v_mfma_f32_16x16x32_bf16 v[68:71], v[172:175], v[108:111], v[68:71]
    buffer_load_dwordx4 v[148:151], v18, s[12:15], s55 offen offset:0 sc1
    v_mfma_f32_16x16x32_bf16 v[36:39], v[172:175], v[104:107], v[36:39]
    ds_read_b128 v[172:175], v8 offset:25600
    v_mfma_f32_16x16x32_bf16 v[36:39], v[168:171], v[96:99], v[36:39]
    ds_read_b128 v[168:171], v8 offset:17408
    s_waitcnt lgkmcnt(12)
    v_mfma_f32_16x16x32_bf16 v[40:43], v[176:179], v[96:99], v[40:43]
    v_mfma_f32_16x16x32_bf16 v[40:43], v[180:183], v[104:107], v[40:43]
    buffer_load_dwordx4 v[152:155], v17, s[12:15], s55 offen offset:2048 sc1
    v_mfma_f32_16x16x32_bf16 v[72:75], v[180:183], v[108:111], v[72:75]
    ds_read_b128 v[180:183], v8 offset:26624
    v_mfma_f32_16x16x32_bf16 v[72:75], v[176:179], v[100:103], v[72:75]
    ds_read_b128 v[176:179], v8 offset:18432
    v_mfma_f32_16x16x32_bf16 v[76:79], v[184:187], v[100:103], v[76:79]
    v_mfma_f32_16x16x32_bf16 v[76:79], v[188:191], v[108:111], v[76:79]
    buffer_load_dwordx4 v[156:159], v18, s[12:15], s55 offen offset:2048 sc1
    v_mfma_f32_16x16x32_bf16 v[44:47], v[188:191], v[104:107], v[44:47]
    ds_read_b128 v[188:191], v8 offset:27648
    s_add_u32 s55, s55, 4096
    v_mfma_f32_16x16x32_bf16 v[44:47], v[184:187], v[96:99], v[44:47]
    ds_read_b128 v[184:187], v8 offset:19456
    s_waitcnt lgkmcnt(12)
    v_mfma_f32_16x16x32_bf16 v[48:51], v[192:195], v[96:99], v[48:51]
    s_add_u32 m0, s54, 0
    v_mfma_f32_16x16x32_bf16 v[48:51], v[196:199], v[104:107], v[48:51]
    buffer_load_dwordx4 v3, s[28:31], s40 offen offset:0 sc1 lds
    v_mfma_f32_16x16x32_bf16 v[80:83], v[196:199], v[108:111], v[80:83]
    ds_read_b128 v[196:199], v8 offset:28672
    v_mfma_f32_16x16x32_bf16 v[80:83], v[192:195], v[100:103], v[80:83]
    ds_read_b128 v[192:195], v8 offset:20480
    v_mfma_f32_16x16x32_bf16 v[84:87], v[200:203], v[100:103], v[84:87]
    v_mfma_f32_16x16x32_bf16 v[84:87], v[204:207], v[108:111], v[84:87]
    buffer_load_dwordx4 v3, s[28:31], s40 offen offset:1024 sc1 lds
    v_mfma_f32_16x16x32_bf16 v[52:55], v[204:207], v[104:107], v[52:55]
    ds_read_b128 v[204:207], v8 offset:29696
    v_mfma_f32_16x16x32_bf16 v[52:55], v[200:203], v[96:99], v[52:55]
    ds_read_b128 v[200:203], v8 offset:21504
    s_waitcnt lgkmcnt(12)
    v_mfma_f32_16x16x32_bf16 v[56:59], v[208:211], v[96:99], v[56:59]
    v_mfma_f32_16x16x32_bf16 v[56:59], v[212:215], v[104:107], v[56:59]
    buffer_load_dwordx4 v3, s[28:31], s40 offen offset:2048 sc1 lds
    v_mfma_f32_16x16x32_bf16 v[88:91], v[212:215], v[108:111], v[88:91]
    ds_read_b128 v[212:215], v8 offset:30720
    v_mfma_f32_16x16x32_bf16 v[88:91], v[208:211], v[100:103], v[88:91]
    ds_read_b128 v[208:211], v8 offset:22528
    v_mfma_f32_16x16x32_bf16 v[92:95], v[216:219], v[100:103], v[92:95]
    v_mfma_f32_16x16x32_bf16 v[92:95], v[220:223], v[108:111], v[92:95]
    buffer_load_dwordx4 v3, s[28:31], s40 offen offset:3072 sc1 lds
    v_mfma_f32_16x16x32_bf16 v[60:63], v[220:223], v[104:107], v[60:63]
    ds_read_b128 v[220:223], v8 offset:31744
    s_add_u32 s40, s40, 16384
    v_mfma_f32_16x16x32_bf16 v[60:63], v[216:219], v[96:99], v[60:63]
    ds_read_b128 v[216:219], v8 offset:23552
    s_waitcnt vmcnt(16) lgkmcnt(12)
    v_mfma_f32_16x16x32_bf16 v[32:35], v[160:163], v[112:115], v[32:35]
    s_barrier
    v_mfma_f32_16x16x32_bf16 v[32:35], v[164:167], v[120:123], v[32:35]
    buffer_load_dwordx4 v[96:99], v17, s[12:15], s55 offen offset:0 sc1
    v_mfma_f32_16x16x32_bf16 v[64:67], v[164:167], v[124:127], v[64:67]
    ds_read_b128 v[164:167], v8 offset:40960
    v_mfma_f32_16x16x32_bf16 v[64:67], v[160:163], v[116:119], v[64:67]
    ds_read_b128 v[160:163], v8 offset:32768
    v_mfma_f32_16x16x32_bf16 v[68:71], v[168:171], v[116:119], v[68:71]
    v_mfma_f32_16x16x32_bf16 v[68:71], v[172:175], v[124:127], v[68:71]
    buffer_load_dwordx4 v[100:103], v18, s[12:15], s55 offen offset:0 sc1
    v_mfma_f32_16x16x32_bf16 v[36:39], v[172:175], v[120:123], v[36:39]
    ds_read_b128 v[172:175], v8 offset:41984
    v_mfma_f32_16x16x32_bf16 v[36:39], v[168:171], v[112:115], v[36:39]
    ds_read_b128 v[168:171], v8 offset:33792
    s_waitcnt lgkmcnt(12)
    v_mfma_f32_16x16x32_bf16 v[40:43], v[176:179], v[112:115], v[40:43]
    v_mfma_f32_16x16x32_bf16 v[40:43], v[180:183], v[120:123], v[40:43]
    buffer_load_dwordx4 v[104:107], v17, s[12:15], s55 offen offset:2048 sc1
    v_mfma_f32_16x16x32_bf16 v[72:75], v[180:183], v[124:127], v[72:75]
    ds_read_b128 v[180:183], v8 offset:43008
    v_mfma_f32_16x16x32_bf16 v[72:75], v[176:179], v[116:119], v[72:75]
    ds_read_b128 v[176:179], v8 offset:34816
    v_mfma_f32_16x16x32_bf16 v[76:79], v[184:187], v[116:119], v[76:79]
    v_mfma_f32_16x16x32_bf16 v[76:79], v[188:191], v[124:127], v[76:79]
    buffer_load_dwordx4 v[108:111], v18, s[12:15], s55 offen offset:2048 sc1
    v_mfma_f32_16x16x32_bf16 v[44:47], v[188:191], v[120:123], v[44:47]
    ds_read_b128 v[188:191], v8 offset:44032
    s_add_u32 s55, s55, 4096
    v_mfma_f32_16x16x32_bf16 v[44:47], v[184:187], v[112:115], v[44:47]
    ds_read_b128 v[184:187], v8 offset:35840
    s_waitcnt lgkmcnt(12)
    v_mfma_f32_16x16x32_bf16 v[48:51], v[192:195], v[112:115], v[48:51]
    s_add_u32 m0, s54, 16384
    v_mfma_f32_16x16x32_bf16 v[48:51], v[196:199], v[120:123], v[48:51]
    buffer_load_dwordx4 v3, s[28:31], s40 offen offset:0 sc1 lds
    v_mfma_f32_16x16x32_bf16 v[80:83], v[196:199], v[124:127], v[80:83]
    ds_read_b128 v[196:199], v8 offset:45056
    v_mfma_f32_16x16x32_bf16 v[80:83], v[192:195], v[116:119], v[80:83]
    ds_read_b128 v[192:195], v8 offset:36864
    v_mfma_f32_16x16x32_bf16 v[84:87], v[200:203], v[116:119], v[84:87]
    v_mfma_f32_16x16x32_bf16 v[84:87], v[204:207], v[124:127], v[84:87]
    buffer_load_dwordx4 v3, s[28:31], s40 offen offset:1024 sc1 lds
    v_mfma_f32_16x16x32_bf16 v[52:55], v[204:207], v[120:123], v[52:55]
    ds_read_b128 v[204:207], v8 offset:46080
    v_mfma_f32_16x16x32_bf16 v[52:55], v[200:203], v[112:115], v[52:55]
    ds_read_b128 v[200:203], v8 offset:37888
    s_waitcnt lgkmcnt(12)
    v_mfma_f32_16x16x32_bf16 v[56:59], v[208:211], v[112:115], v[56:59]
    v_mfma_f32_16x16x32_bf16 v[56:59], v[212:215], v[120:123], v[56:59]
    buffer_load_dwordx4 v3, s[28:31], s40 offen offset:2048 sc1 lds
    v_mfma_f32_16x16x32_bf16 v[88:91], v[212:215], v[124:127], v[88:91]
    ds_read_b128 v[212:215], v8 offset:47104
    v_mfma_f32_16x16x32_bf16 v[88:91], v[208:211], v[116:119], v[88:91]
    ds_read_b128 v[208:211], v8 offset:38912
    v_mfma_f32_16x16x32_bf16 v[92:95], v[216:219], v[116:119], v[92:95]
    v_mfma_f32_16x16x32_bf16 v[92:95], v[220:223], v[124:127], v[92:95]
    buffer_load_dwordx4 v3, s[28:31], s40 offen offset:3072 sc1 lds
    v_mfma_f32_16x16x32_bf16 v[60:63], v[220:223], v[120:123], v[60:63]
    ds_read_b128 v[220:223], v8 offset:48128
    s_add_u32 s40, s40, 16384
    v_mfma_f32_16x16x32_bf16 v[60:63], v[216:219], v[112:115], v[60:63]
    ds_read_b128 v[216:219], v8 offset:39936
    s_waitcnt vmcnt(16) lgkmcnt(12)
    v_mfma_f32_16x16x32_bf16 v[32:35], v[160:163], v[128:131], v[32:35]
    s_barrier
    v_mfma_f32_16x16x32_bf16 v[32:35], v[164:167], v[136:139], v[32:35]
    buffer_load_dwordx4 v[112:115], v17, s[12:15], s55 offen offset:0 sc1
    v_mfma_f32_16x16x32_bf16 v[64:67], v[164:167], v[140:143], v[64:67]
    ds_read_b128 v[164:167], v8 offset:57344
    v_mfma_f32_16x16x32_bf16 v[64:67], v[160:163], v[132:135], v[64:67]
    ds_read_b128 v[160:163], v8 offset:49152
    v_mfma_f32_16x16x32_bf16 v[68:71], v[168:171], v[132:135], v[68:71]
    v_mfma_f32_16x16x32_bf16 v[68:71], v[172:175], v[140:143], v[68:71]
    buffer_load_dwordx4 v[116:119], v18, s[12:15], s55 offen offset:0 sc1
    v_mfma_f32_16x16x32_bf16 v[36:39], v[172:175], v[136:139], v[36:39]
    ds_read_b128 v[172:175], v8 offset:58368
    v_mfma_f32_16x16x32_bf16 v[36:39], v[168:171], v[128:131], v[36:39]
    ds_read_b128 v[168:171], v8 offset:50176
    s_waitcnt lgkmcnt(12)
    v_mfma_f32_16x16x32_bf16 v[40:43], v[176:179], v[128:131], v[40:43]
iw_d10:
    s_cbranch_execz iw_d13
    v_mfma_f32_16x16x32_bf16 v[40:43], v[180:183], v[136:139], v[40:43]
    buffer_load_dwordx4 v[120:123], v17, s[12:15], s55 offen offset:2048 sc1
    v_mfma_f32_16x16x32_bf16 v[72:75], v[180:183], v[140:143], v[72:75]
    ds_read_b128 v[180:183], v8 offset:59392
    v_mfma_f32_16x16x32_bf16 v[72:75], v[176:179], v[132:135], v[72:75]
    ds_read_b128 v[176:179], v8 offset:51200
    v_mfma_f32_16x16x32_bf16 v[76:79], v[184:187], v[132:135], v[76:79]
    v_mfma_f32_16x16x32_bf16 v[76:79], v[188:191], v[140:143], v[76:79]
    buffer_load_dwordx4 v[124:127], v18, s[12:15], s55 offen offset:2048 sc1
    v_mfma_f32_16x16x32_bf16 v[44:47], v[188:191], v[136:139], v[44:47]
    ds_read_b128 v[188:191], v8 offset:60416
    s_add_u32 s55, s55, 4096
    v_mfma_f32_16x16x32_bf16 v[44:47], v[184:187], v[128:131], v[44:47]
    ds_read_b128 v[184:187], v8 offset:52224
    s_waitcnt lgkmcnt(12)
    v_mfma_f32_16x16x32_bf16 v[48:51], v[192:195], v[128:131], v[48:51]
    s_add_u32 m0, s54, 32768
    v_mfma_f32_16x16x32_bf16 v[48:51], v[196:199], v[136:139], v[48:51]
    buffer_load_dwordx4 v3, s[28:31], s40 offen offset:0 sc1 lds
    v_mfma_f32_16x16x32_bf16 v[80:83], v[196:199], v[140:143], v[80:83]
    ds_read_b128 v[196:199], v8 offset:61440
    v_mfma_f32_16x16x32_bf16 v[80:83], v[192:195], v[132:135], v[80:83]
    ds_read_b128 v[192:195], v8 offset:53248
    v_mfma_f32_16x16x32_bf16 v[84:87], v[200:203], v[132:135], v[84:87]
    v_mfma_f32_16x16x32_bf16 v[84:87], v[204:207], v[140:143], v[84:87]
    buffer_load_dwordx4 v3, s[28:31], s40 offen offset:1024 sc1 lds
    v_mfma_f32_16x16x32_bf16 v[52:55], v[204:207], v[136:139], v[52:55]
    ds_read_b128 v[204:207], v8 offset:62464
    v_mfma_f32_16x16x32_bf16 v[52:55], v[200:203], v[128:131], v[52:55]
    ds_read_b128 v[200:203], v8 offset:54272
    s_waitcnt lgkmcnt(12)
    v_mfma_f32_16x16x32_bf16 v[56:59], v[208:211], v[128:131], v[56:59]
    v_mfma_f32_16x16x32_bf16 v[56:59], v[212:215], v[136:139], v[56:59]
    buffer_load_dwordx4 v3, s[28:31], s40 offen offset:2048 sc1 lds
    v_mfma_f32_16x16x32_bf16 v[88:91], v[212:215], v[140:143], v[88:91]
    ds_read_b128 v[212:215], v8 offset:63488
    v_mfma_f32_16x16x32_bf16 v[88:91], v[208:211], v[132:135], v[88:91]
    ds_read_b128 v[208:211], v8 offset:55296
    v_mfma_f32_16x16x32_bf16 v[92:95], v[216:219], v[132:135], v[92:95]
    v_mfma_f32_16x16x32_bf16 v[92:95], v[220:223], v[140:143], v[92:95]
    buffer_load_dwordx4 v3, s[28:31], s40 offen offset:3072 sc1 lds
    v_mfma_f32_16x16x32_bf16 v[60:63], v[220:223], v[136:139], v[60:63]
    ds_read_b128 v[220:223], v8 offset:64512
    s_add_u32 s40, s40, 16384
    v_mfma_f32_16x16x32_bf16 v[60:63], v[216:219], v[128:131], v[60:63]
    ds_read_b128 v[216:219], v8 offset:56320
    s_waitcnt vmcnt(16) lgkmcnt(12)
    v_mfma_f32_16x16x32_bf16 v[32:35], v[160:163], v[144:147], v[32:35]
    s_barrier
    v_mfma_f32_16x16x32_bf16 v[32:35], v[164:167], v[152:155], v[32:35]
    v_xor_b32 v8, 0x10000, v8
    buffer_load_dwordx4 v[128:131], v17, s[12:15], s55 offen offset:0 sc1
    v_mfma_f32_16x16x32_bf16 v[64:67], v[164:167], v[156:159], v[64:67]
    ds_read_b128 v[164:167], v8 offset:8192
    v_mfma_f32_16x16x32_bf16 v[64:67], v[160:163], v[148:151], v[64:67]
    ds_read_b128 v[160:163], v8 offset:0
    v_mfma_f32_16x16x32_bf16 v[68:71], v[168:171], v[148:151], v[68:71]
    v_mfma_f32_16x16x32_bf16 v[68:71], v[172:175], v[156:159], v[68:71]
    buffer_load_dwordx4 v[132:135], v18, s[12:15], s55 offen offset:0 sc1
    v_mfma_f32_16x16x32_bf16 v[36:39], v[172:175], v[152:155], v[36:39]
    ds_read_b128 v[172:175], v8 offset:9216
    v_mfma_f32_16x16x32_bf16 v[36:39], v[168:171], v[144:147], v[36:39]
    ds_read_b128 v[168:171], v8 offset:1024
    s_waitcnt lgkmcnt(12)
    v_mfma_f32_16x16x32_bf16 v[40:43], v[176:179], v[144:147], v[40:43]
    v_mfma_f32_16x16x32_bf16 v[40:43], v[180:183], v[152:155], v[40:43]
    buffer_load_dwordx4 v[136:139], v17, s[12:15], s55 offen offset:2048 sc1
    v_mfma_f32_16x16x32_bf16 v[72:75], v[180:183], v[156:159], v[72:75]
    ds_read_b128 v[180:183], v8 offset:10240
    v_mfma_f32_16x16x32_bf16 v[72:75], v[176:179], v[148:151], v[72:75]
    ds_read_b128 v[176:179], v8 offset:2048
    v_mfma_f32_16x16x32_bf16 v[76:79], v[184:187], v[148:151], v[76:79]
    v_mfma_f32_16x16x32_bf16 v[76:79], v[188:191], v[156:159], v[76:79]
    buffer_load_dwordx4 v[140:143], v18, s[12:15], s55 offen offset:2048 sc1
    v_mfma_f32_16x16x32_bf16 v[44:47], v[188:191], v[152:155], v[44:47]
    ds_read_b128 v[188:191], v8 offset:11264
    s_add_u32 s55, s55, 4096
    v_mfma_f32_16x16x32_bf16 v[44:47], v[184:187], v[144:147], v[44:47]
    ds_read_b128 v[184:187], v8 offset:3072
    s_waitcnt lgkmcnt(12)
    v_mfma_f32_16x16x32_bf16 v[48:51], v[192:195], v[144:147], v[48:51]
    v_mfma_f32_16x16x32_bf16 v[48:51], v[196:199], v[152:155], v[48:51]
    v_mfma_f32_16x16x32_bf16 v[80:83], v[196:199], v[156:159], v[80:83]
    ds_read_b128 v[196:199], v8 offset:12288
    v_mfma_f32_16x16x32_bf16 v[80:83], v[192:195], v[148:151], v[80:83]
    ds_read_b128 v[192:195], v8 offset:4096
    v_mfma_f32_16x16x32_bf16 v[84:87], v[200:203], v[148:151], v[84:87]
    v_mfma_f32_16x16x32_bf16 v[84:87], v[204:207], v[156:159], v[84:87]
    v_mfma_f32_16x16x32_bf16 v[52:55], v[204:207], v[152:155], v[52:55]
    ds_read_b128 v[204:207], v8 offset:13312
    v_mfma_f32_16x16x32_bf16 v[52:55], v[200:203], v[144:147], v[52:55]
    ds_read_b128 v[200:203], v8 offset:5120
    s_waitcnt lgkmcnt(12)
    v_mfma_f32_16x16x32_bf16 v[56:59], v[208:211], v[144:147], v[56:59]
    v_mfma_f32_16x16x32_bf16 v[56:59], v[212:215], v[152:155], v[56:59]
    v_mfma_f32_16x16x32_bf16 v[88:91], v[212:215], v[156:159], v[88:91]
    ds_read_b128 v[212:215], v8 offset:14336
    v_mfma_f32_16x16x32_bf16 v[88:91], v[208:211], v[148:151], v[88:91]
    ds_read_b128 v[208:211], v8 offset:6144
    v_mfma_f32_16x16x32_bf16 v[92:95], v[216:219], v[148:151], v[92:95]
    v_mfma_f32_16x16x32_bf16 v[92:95], v[220:223], v[156:159], v[92:95]
    v_mfma_f32_16x16x32_bf16 v[60:63], v[220:223], v[152:155], v[60:63]
    ds_read_b128 v[220:223], v8 offset:15360
    v_mfma_f32_16x16x32_bf16 v[60:63], v[216:219], v[144:147], v[60:63]
    ds_read_b128 v[216:219], v8 offset:7168
    s_cmp_lg_u32 s6, 0
    s_cbranch_scc1 interl_g2e68
    s_waitcnt vmcnt(12) lgkmcnt(12)
    v_mfma_f32_16x16x32_bf16 v[32:35], v[160:163], v[96:99], v[32:35]
    s_barrier
    v_mfma_f32_16x16x32_bf16 v[32:35], v[164:167], v[104:107], v[32:35]
    buffer_load_dwordx4 v[144:147], v17, s[12:15], s55 offen offset:0 sc1
    v_mfma_f32_16x16x32_bf16 v[64:67], v[164:167], v[108:111], v[64:67]
    ds_read_b128 v[164:167], v8 offset:24576
    v_mfma_f32_16x16x32_bf16 v[64:67], v[160:163], v[100:103], v[64:67]
    ds_read_b128 v[160:163], v8 offset:16384
    v_mfma_f32_16x16x32_bf16 v[68:71], v[168:171], v[100:103], v[68:71]
    v_mfma_f32_16x16x32_bf16 v[68:71], v[172:175], v[108:111], v[68:71]
    buffer_load_dwordx4 v[148:151], v18, s[12:15], s55 offen offset:0 sc1
    v_mfma_f32_16x16x32_bf16 v[36:39], v[172:175], v[104:107], v[36:39]
    ds_read_b128 v[172:175], v8 offset:25600
    v_mfma_f32_16x16x32_bf16 v[36:39], v[168:171], v[96:99], v[36:39]
    ds_read_b128 v[168:171], v8 offset:17408
    s_waitcnt lgkmcnt(12)
    v_mfma_f32_16x16x32_bf16 v[40:43], v[176:179], v[96:99], v[40:43]
    v_mfma_f32_16x16x32_bf16 v[40:43], v[180:183], v[104:107], v[40:43]
    buffer_load_dwordx4 v[152:155], v17, s[12:15], s55 offen offset:2048 sc1
    v_mfma_f32_16x16x32_bf16 v[72:75], v[180:183], v[108:111], v[72:75]
    ds_read_b128 v[180:183], v8 offset:26624
iw_c11:
    s_cbranch_execz iw_c14
    v_mfma_f32_16x16x32_bf16 v[72:75], v[176:179], v[100:103], v[72:75]
    ds_read_b128 v[176:179], v8 offset:18432
    v_mfma_f32_16x16x32_bf16 v[76:79], v[184:187], v[100:103], v[76:79]
    s_add_u32 s41, s92, 458752
    v_mfma_f32_16x16x32_bf16 v[76:79], v[188:191], v[108:111], v[76:79]
    buffer_load_dwordx4 v[156:159], v18, s[12:15], s55 offen offset:2048 sc1
    v_mfma_f32_16x16x32_bf16 v[44:47], v[188:191], v[104:107], v[44:47]
    ds_read_b128 v[188:191], v8 offset:27648
    s_add_u32 s55, s55, 4096
    v_mfma_f32_16x16x32_bf16 v[44:47], v[184:187], v[96:99], v[44:47]
    ds_read_b128 v[184:187], v8 offset:19456
    s_waitcnt lgkmcnt(12)
    v_mfma_f32_16x16x32_bf16 v[48:51], v[192:195], v[96:99], v[48:51]
    s_add_u32 m0, s43, 66048
    v_mfma_f32_16x16x32_bf16 v[48:51], v[196:199], v[104:107], v[48:51]
    buffer_load_dwordx4 v19, s[8:11], s41 offen offset:0 lds
    v_mfma_f32_16x16x32_bf16 v[80:83], v[196:199], v[108:111], v[80:83]
    ds_read_b128 v[196:199], v8 offset:28672
    v_mfma_f32_16x16x32_bf16 v[80:83], v[192:195], v[100:103], v[80:83]
    ds_read_b128 v[192:195], v8 offset:20480
    v_mfma_f32_16x16x32_bf16 v[84:87], v[200:203], v[100:103], v[84:87]
    v_mfma_f32_16x16x32_bf16 v[84:87], v[204:207], v[108:111], v[84:87]
    buffer_load_dwordx4 v20, s[8:11], s41 offen offset:1024 lds
    v_mfma_f32_16x16x32_bf16 v[52:55], v[204:207], v[104:107], v[52:55]
    ds_read_b128 v[204:207], v8 offset:29696
    v_mfma_f32_16x16x32_bf16 v[52:55], v[200:203], v[96:99], v[52:55]
    ds_read_b128 v[200:203], v8 offset:21504
    s_waitcnt lgkmcnt(12)
    v_mfma_f32_16x16x32_bf16 v[56:59], v[208:211], v[96:99], v[56:59]
    v_mfma_f32_16x16x32_bf16 v[56:59], v[212:215], v[104:107], v[56:59]
    buffer_load_dwordx4 v21, s[8:11], s41 offen offset:2048 lds
    v_mfma_f32_16x16x32_bf16 v[88:91], v[212:215], v[108:111], v[88:91]
    ds_read_b128 v[212:215], v8 offset:30720
    v_mfma_f32_16x16x32_bf16 v[88:91], v[208:211], v[100:103], v[88:91]
    ds_read_b128 v[208:211], v8 offset:22528
    v_mfma_f32_16x16x32_bf16 v[92:95], v[216:219], v[100:103], v[92:95]
    v_mfma_f32_16x16x32_bf16 v[92:95], v[220:223], v[108:111], v[92:95]
    buffer_load_dwordx4 v22, s[8:11], s41 offen offset:3072 lds
    v_mfma_f32_16x16x32_bf16 v[60:63], v[220:223], v[104:107], v[60:63]
    ds_read_b128 v[220:223], v8 offset:31744
    s_add_u32 s41, s41, 229376
    v_mfma_f32_16x16x32_bf16 v[60:63], v[216:219], v[96:99], v[60:63]
    ds_read_b128 v[216:219], v8 offset:23552
    s_waitcnt vmcnt(12) lgkmcnt(12)
    v_mfma_f32_16x16x32_bf16 v[64:67], v[160:163], v[116:119], v[64:67]
    s_barrier
    ds_read_b128 a[0:3], v8 offset:32768
    v_mfma_f32_16x16x32_bf16 v[64:67], v[164:167], v[124:127], v[64:67]
    ds_read_b128 a[4:7], v8 offset:40960
    s_add_u32 m0, s43, 99072
    v_mfma_f32_16x16x32_bf16 v[68:71], v[172:175], v[124:127], v[68:71]
    ds_read_b128 a[8:11], v12 offset:0
    buffer_load_dwordx4 v19, s[8:11], s41 offen offset:0 lds
    v_mfma_f32_16x16x32_bf16 v[68:71], v[168:171], v[116:119], v[68:71]
    ds_read_b128 a[12:15], v12 offset:8192
    s_waitcnt lgkmcnt(12)
    v_mfma_f32_16x16x32_bf16 v[72:75], v[176:179], v[116:119], v[72:75]
    ds_read_b128 a[16:19], v8 offset:33792
    v_mfma_f32_16x16x32_bf16 v[72:75], v[180:183], v[124:127], v[72:75]
    ds_read_b128 a[20:23], v8 offset:41984
    v_mfma_f32_16x16x32_bf16 v[76:79], v[188:191], v[124:127], v[76:79]
    ds_read_b128 a[24:27], v12 offset:1024
    buffer_load_dwordx4 v20, s[8:11], s41 offen offset:1024 lds
    v_mfma_f32_16x16x32_bf16 v[76:79], v[184:187], v[116:119], v[76:79]
    ds_read_b128 a[28:31], v12 offset:9216
    s_waitcnt lgkmcnt(12)
    v_mfma_f32_16x16x32_bf16 v[80:83], v[192:195], v[116:119], v[80:83]
    ds_read_b128 a[32:35], v8 offset:34816
    v_mfma_f32_16x16x32_bf16 v[80:83], v[196:199], v[124:127], v[80:83]
    ds_read_b128 a[36:39], v8 offset:43008
    v_mfma_f32_16x16x32_bf16 v[84:87], v[204:207], v[124:127], v[84:87]
    ds_read_b128 a[40:43], v12 offset:2048
    buffer_load_dwordx4 v21, s[8:11], s41 offen offset:2048 lds
    v_mfma_f32_16x16x32_bf16 v[84:87], v[200:203], v[116:119], v[84:87]
    ds_read_b128 a[44:47], v12 offset:10240
    s_waitcnt lgkmcnt(12)
    v_mfma_f32_16x16x32_bf16 v[88:91], v[208:211], v[116:119], v[88:91]
    ds_read_b128 a[48:51], v8 offset:35840
    v_mfma_f32_16x16x32_bf16 v[88:91], v[212:215], v[124:127], v[88:91]
    ds_read_b128 a[52:55], v8 offset:44032
    v_mfma_f32_16x16x32_bf16 v[92:95], v[220:223], v[124:127], v[92:95]
    ds_read_b128 a[56:59], v12 offset:3072
    buffer_load_dwordx4 v22, s[8:11], s41 offen offset:3072 lds
    v_mfma_f32_16x16x32_bf16 v[92:95], v[216:219], v[116:119], v[92:95]
    ds_read_b128 a[60:63], v12 offset:11264
    s_add_u32 s41, s41, 229376
    s_waitcnt vmcnt(8) lgkmcnt(12)
    v_mfma_f32_16x16x32_bf16 v[64:67], a[0:3], v[132:135], v[64:67]
    ds_read_b128 a[64:67], v8 offset:36864
    v_mfma_f32_16x16x32_bf16 v[64:67], a[4:7], v[140:143], v[64:67]
    ds_read_b128 a[68:71], v8 offset:45056
    v_mfma_f32_16x16x32_bf16 v[64:67], a[8:11], v[148:151], v[64:67]
    ds_read_b128 a[72:75], v12 offset:4096
    v_mfma_f32_16x16x32_bf16 v[64:67], a[12:15], v[156:159], v[64:67]
    ds_read_b128 a[76:79], v12 offset:12288
    s_nop 0
    s_waitcnt lgkmcnt(12)
    v_mfma_f32_16x16x32_bf16 v[68:71], a[28:31], v[156:159], v[68:71]
    ds_read_b128 a[80:83], v8 offset:37888
    s_nop 0
    v_mfma_f32_16x16x32_bf16 v[68:71], a[24:27], v[148:151], v[68:71]
    ds_read_b128 a[84:87], v8 offset:46080
    v_cvt_pk_bf16_f32 v240, v64, v65
    v_mfma_f32_16x16x32_bf16 v[68:71], a[20:23], v[140:143], v[68:71]
    ds_read_b128 a[88:91], v12 offset:5120
    v_cvt_pk_bf16_f32 v241, v66, v67
    v_mfma_f32_16x16x32_bf16 v[68:71], a[16:19], v[132:135], v[68:71]
    ds_read_b128 a[92:95], v12 offset:13312
    s_nop 0
    s_waitcnt lgkmcnt(12)
    v_mfma_f32_16x16x32_bf16 v[72:75], a[32:35], v[132:135], v[72:75]
    ds_read_b128 a[96:99], v8 offset:38912
    s_nop 0
    v_mfma_f32_16x16x32_bf16 v[72:75], a[36:39], v[140:143], v[72:75]
    ds_read_b128 a[100:103], v8 offset:47104
    v_cvt_pk_bf16_f32 v242, v68, v69
    v_mfma_f32_16x16x32_bf16 v[72:75], a[40:43], v[148:151], v[72:75]
    ds_read_b128 a[104:107], v12 offset:6144
    v_cvt_pk_bf16_f32 v243, v70, v71
    v_mfma_f32_16x16x32_bf16 v[72:75], a[44:47], v[156:159], v[72:75]
    ds_read_b128 a[108:111], v12 offset:14336
    buffer_store_dwordx4 v[240:243], v3, s[12:15], s37 offen offset:0 sc1
    s_waitcnt lgkmcnt(12)
    v_mfma_f32_16x16x32_bf16 v[76:79], a[60:63], v[156:159], v[76:79]
    ds_read_b128 a[112:115], v8 offset:39936
    s_nop 0
    v_mfma_f32_16x16x32_bf16 v[76:79], a[56:59], v[148:151], v[76:79]
    ds_read_b128 a[116:119], v8 offset:48128
    v_cvt_pk_bf16_f32 v244, v72, v73
    v_mfma_f32_16x16x32_bf16 v[76:79], a[52:55], v[140:143], v[76:79]
    ds_read_b128 a[120:123], v12 offset:7168
    v_cvt_pk_bf16_f32 v245, v74, v75
    v_mfma_f32_16x16x32_bf16 v[76:79], a[48:51], v[132:135], v[76:79]
    ds_read_b128 a[124:127], v12 offset:15360
    s_nop 0
    s_waitcnt lgkmcnt(12)
    v_mfma_f32_16x16x32_bf16 v[80:83], a[64:67], v[132:135], v[80:83]
iw_d11:
    s_cbranch_execz iw_d14
    s_nop 1
    v_mfma_f32_16x16x32_bf16 v[80:83], a[68:71], v[140:143], v[80:83]
    s_nop 0
    v_cvt_pk_bf16_f32 v246, v76, v77
    v_mfma_f32_16x16x32_bf16 v[80:83], a[72:75], v[148:151], v[80:83]
    v_cvt_pk_bf16_f32 v247, v78, v79
    buffer_store_dwordx4 v[244:247], v3, s[12:15], s37 offen offset:1024 sc1
    v_mfma_f32_16x16x32_bf16 v[80:83], a[76:79], v[156:159], v[80:83]
    s_nop 1
    s_waitcnt lgkmcnt(8)
    v_mfma_f32_16x16x32_bf16 v[84:87], a[92:95], v[156:159], v[84:87]
    s_nop 1
    v_mfma_f32_16x16x32_bf16 v[84:87], a[88:91], v[148:151], v[84:87]
    s_nop 0
    v_cvt_pk_bf16_f32 v248, v80, v81
    v_mfma_f32_16x16x32_bf16 v[84:87], a[84:87], v[140:143], v[84:87]
    v_cvt_pk_bf16_f32 v249, v82, v83
    v_mfma_f32_16x16x32_bf16 v[84:87], a[80:83], v[132:135], v[84:87]
    s_nop 1
    s_waitcnt lgkmcnt(4)
    v_mfma_f32_16x16x32_bf16 v[88:91], a[96:99], v[132:135], v[88:91]
    s_nop 1
    v_mfma_f32_16x16x32_bf16 v[88:91], a[100:103], v[140:143], v[88:91]
    s_nop 0
    v_cvt_pk_bf16_f32 v250, v84, v85
    v_mfma_f32_16x16x32_bf16 v[88:91], a[104:107], v[148:151], v[88:91]
    v_cvt_pk_bf16_f32 v251, v86, v87
    buffer_store_dwordx4 v[248:251], v3, s[12:15], s37 offen offset:2048 sc1
    v_mfma_f32_16x16x32_bf16 v[88:91], a[108:111], v[156:159], v[88:91]
    s_nop 1
    s_waitcnt lgkmcnt(0)
    v_mfma_f32_16x16x32_bf16 v[92:95], a[124:127], v[156:159], v[92:95]
    s_nop 1
    v_mfma_f32_16x16x32_bf16 v[92:95], a[120:123], v[148:151], v[92:95]
    s_nop 0
    v_cvt_pk_bf16_f32 v252, v88, v89
    v_mfma_f32_16x16x32_bf16 v[92:95], a[116:119], v[140:143], v[92:95]
    v_cvt_pk_bf16_f32 v253, v90, v91
    v_mfma_f32_16x16x32_bf16 v[92:95], a[112:115], v[132:135], v[92:95]
    s_nop 1
    v_mfma_f32_16x16x32_bf16 v[32:35], v[160:163], v[112:115], v[32:35]
    s_nop 1
    v_mfma_f32_16x16x32_bf16 v[32:35], v[164:167], v[120:123], v[32:35]
    s_nop 1
    v_mfma_f32_16x16x32_bf16 v[32:35], a[0:3], v[128:131], v[32:35]
    v_cvt_pk_bf16_f32 v254, v92, v93
    v_cvt_pk_bf16_f32 v255, v94, v95
    v_mfma_f32_16x16x32_bf16 v[32:35], a[4:7], v[136:139], v[32:35]
    buffer_store_dwordx4 v[252:255], v3, s[12:15], s37 offen offset:3072 sc1
    v_mfma_f32_16x16x32_bf16 v[32:35], a[8:11], v[144:147], v[32:35]
    v_mfma_f32_16x16x32_bf16 v[32:35], a[12:15], v[152:155], v[32:35]
    s_nop 1
    v_mfma_f32_16x16x32_bf16 v[36:39], a[28:31], v[152:155], v[36:39]
    s_nop 1
    v_mfma_f32_16x16x32_bf16 v[36:39], a[24:27], v[144:147], v[36:39]
    s_nop 1
    v_mfma_f32_16x16x32_bf16 v[36:39], a[20:23], v[136:139], v[36:39]
    v_cvt_pk_bf16_f32 v96, v32, v33
    v_cvt_pk_bf16_f32 v97, v34, v35
    v_mfma_f32_16x16x32_bf16 v[36:39], a[16:19], v[128:131], v[36:39]
    v_mfma_f32_16x16x32_bf16 v[36:39], v[172:175], v[120:123], v[36:39]
    v_mfma_f32_16x16x32_bf16 v[36:39], v[168:171], v[112:115], v[36:39]
    s_nop 1
    v_mfma_f32_16x16x32_bf16 v[40:43], v[176:179], v[112:115], v[40:43]
    s_nop 1
    v_mfma_f32_16x16x32_bf16 v[40:43], v[180:183], v[120:123], v[40:43]
    s_nop 1
    v_mfma_f32_16x16x32_bf16 v[40:43], a[32:35], v[128:131], v[40:43]
    v_cvt_pk_bf16_f32 v98, v36, v37
    v_cvt_pk_bf16_f32 v99, v38, v39
    v_mfma_f32_16x16x32_bf16 v[40:43], a[36:39], v[136:139], v[40:43]
    buffer_store_dwordx4 v[96:99], v3, s[12:15], s36 offen offset:0 sc1
    v_mfma_f32_16x16x32_bf16 v[40:43], a[40:43], v[144:147], v[40:43]
    v_mfma_f32_16x16x32_bf16 v[40:43], a[44:47], v[152:155], v[40:43]
    s_nop 1
    v_mfma_f32_16x16x32_bf16 v[44:47], a[60:63], v[152:155], v[44:47]
    s_nop 1
    v_mfma_f32_16x16x32_bf16 v[44:47], a[56:59], v[144:147], v[44:47]
    s_nop 1
    v_mfma_f32_16x16x32_bf16 v[44:47], a[52:55], v[136:139], v[44:47]
    v_cvt_pk_bf16_f32 v100, v40, v41
    v_cvt_pk_bf16_f32 v101, v42, v43
    v_mfma_f32_16x16x32_bf16 v[44:47], a[48:51], v[128:131], v[44:47]
    v_mfma_f32_16x16x32_bf16 v[44:47], v[188:191], v[120:123], v[44:47]
    v_mfma_f32_16x16x32_bf16 v[44:47], v[184:187], v[112:115], v[44:47]
    s_nop 1
    v_mfma_f32_16x16x32_bf16 v[48:51], v[192:195], v[112:115], v[48:51]
    s_nop 1
    v_mfma_f32_16x16x32_bf16 v[48:51], v[196:199], v[120:123], v[48:51]
    s_nop 1
    v_mfma_f32_16x16x32_bf16 v[48:51], a[64:67], v[128:131], v[48:51]
    v_cvt_pk_bf16_f32 v102, v44, v45
    v_cvt_pk_bf16_f32 v103, v46, v47
    v_mfma_f32_16x16x32_bf16 v[48:51], a[68:71], v[136:139], v[48:51]
    buffer_store_dwordx4 v[100:103], v3, s[12:15], s36 offen offset:1024 sc1
    v_mfma_f32_16x16x32_bf16 v[48:51], a[72:75], v[144:147], v[48:51]
    v_mfma_f32_16x16x32_bf16 v[48:51], a[76:79], v[152:155], v[48:51]
    s_nop 1
    v_mfma_f32_16x16x32_bf16 v[52:55], a[92:95], v[152:155], v[52:55]
    s_nop 1
    v_mfma_f32_16x16x32_bf16 v[52:55], a[88:91], v[144:147], v[52:55]
    s_nop 1
    v_mfma_f32_16x16x32_bf16 v[52:55], a[84:87], v[136:139], v[52:55]
    v_cvt_pk_bf16_f32 v104, v48, v49
    v_cvt_pk_bf16_f32 v105, v50, v51
    v_mfma_f32_16x16x32_bf16 v[52:55], a[80:83], v[128:131], v[52:55]
    v_mfma_f32_16x16x32_bf16 v[52:55], v[204:207], v[120:123], v[52:55]
    v_mfma_f32_16x16x32_bf16 v[52:55], v[200:203], v[112:115], v[52:55]
    s_nop 1
    v_mfma_f32_16x16x32_bf16 v[56:59], v[208:211], v[112:115], v[56:59]
    s_nop 1
    v_mfma_f32_16x16x32_bf16 v[56:59], v[212:215], v[120:123], v[56:59]
    s_nop 1
    v_mfma_f32_16x16x32_bf16 v[56:59], a[96:99], v[128:131], v[56:59]
    v_cvt_pk_bf16_f32 v106, v52, v53
    v_cvt_pk_bf16_f32 v107, v54, v55
    v_mfma_f32_16x16x32_bf16 v[56:59], a[100:103], v[136:139], v[56:59]
    buffer_store_dwordx4 v[104:107], v3, s[12:15], s36 offen offset:2048 sc1
    v_mfma_f32_16x16x32_bf16 v[56:59], a[104:107], v[144:147], v[56:59]
    v_mfma_f32_16x16x32_bf16 v[56:59], a[108:111], v[152:155], v[56:59]
    s_nop 1
    v_mfma_f32_16x16x32_bf16 v[60:63], a[124:127], v[152:155], v[60:63]
    s_nop 1
    v_mfma_f32_16x16x32_bf16 v[60:63], a[120:123], v[144:147], v[60:63]
    s_nop 1
    v_mfma_f32_16x16x32_bf16 v[60:63], a[116:119], v[136:139], v[60:63]
    v_cvt_pk_bf16_f32 v108, v56, v57
    v_cvt_pk_bf16_f32 v109, v58, v59
    v_mfma_f32_16x16x32_bf16 v[60:63], a[112:115], v[128:131], v[60:63]
    v_mfma_f32_16x16x32_bf16 v[60:63], v[220:223], v[120:123], v[60:63]
    v_mfma_f32_16x16x32_bf16 v[60:63], v[216:219], v[112:115], v[60:63]
    s_nop 1
    s_nop 5
    v_cvt_pk_bf16_f32 v110, v60, v61
    v_cvt_pk_bf16_f32 v111, v62, v63
    buffer_store_dwordx4 v[108:111], v3, s[12:15], s36 offen offset:3072 sc1
    s_mov_b32 s6, 1
    s_mov_b32 s7, 48234496
    s_branch interleave_layers__ssm_conv_h3__glu_gated_bilinear__prompt_kernel_layer
interl_g2e68:
    s_waitcnt vmcnt(12) lgkmcnt(12)
    v_mfma_f32_16x16x32_bf16 v[32:35], v[160:163], v[96:99], v[32:35]
    s_barrier
    v_mfma_f32_16x16x32_bf16 v[32:35], v[164:167], v[104:107], v[32:35]
    buffer_load_dwordx4 v[144:147], v17, s[12:15], s55 offen offset:0 sc1
    v_mfma_f32_16x16x32_bf16 v[64:67], v[164:167], v[108:111], v[64:67]
    ds_read_b128 v[164:167], v8 offset:24576
    v_mfma_f32_16x16x32_bf16 v[64:67], v[160:163], v[100:103], v[64:67]
    ds_read_b128 v[160:163], v8 offset:16384
    v_mfma_f32_16x16x32_bf16 v[68:71], v[168:171], v[100:103], v[68:71]
iw_c12:
    s_cbranch_execz iw_c15
    v_mfma_f32_16x16x32_bf16 v[68:71], v[172:175], v[108:111], v[68:71]
    buffer_load_dwordx4 v[148:151], v18, s[12:15], s55 offen offset:0 sc1
    v_mfma_f32_16x16x32_bf16 v[36:39], v[172:175], v[104:107], v[36:39]
    ds_read_b128 v[172:175], v8 offset:25600
    v_mfma_f32_16x16x32_bf16 v[36:39], v[168:171], v[96:99], v[36:39]
    ds_read_b128 v[168:171], v8 offset:17408
    s_waitcnt lgkmcnt(12)
    v_mfma_f32_16x16x32_bf16 v[40:43], v[176:179], v[96:99], v[40:43]
    v_mfma_f32_16x16x32_bf16 v[40:43], v[180:183], v[104:107], v[40:43]
    buffer_load_dwordx4 v[152:155], v17, s[12:15], s55 offen offset:2048 sc1
    v_mfma_f32_16x16x32_bf16 v[72:75], v[180:183], v[108:111], v[72:75]
    ds_read_b128 v[180:183], v8 offset:26624
    v_mfma_f32_16x16x32_bf16 v[72:75], v[176:179], v[100:103], v[72:75]
    ds_read_b128 v[176:179], v8 offset:18432
    v_mfma_f32_16x16x32_bf16 v[76:79], v[184:187], v[100:103], v[76:79]
    v_mfma_f32_16x16x32_bf16 v[76:79], v[188:191], v[108:111], v[76:79]
    buffer_load_dwordx4 v[156:159], v18, s[12:15], s55 offen offset:2048 sc1
    v_mfma_f32_16x16x32_bf16 v[44:47], v[188:191], v[104:107], v[44:47]
    ds_read_b128 v[188:191], v8 offset:27648
    s_add_u32 s55, s55, 4096
    v_mfma_f32_16x16x32_bf16 v[44:47], v[184:187], v[96:99], v[44:47]
    ds_read_b128 v[184:187], v8 offset:19456
    s_waitcnt lgkmcnt(12)
    v_mfma_f32_16x16x32_bf16 v[48:51], v[192:195], v[96:99], v[48:51]
    v_mfma_f32_16x16x32_bf16 v[48:51], v[196:199], v[104:107], v[48:51]
    buffer_load_dwordx4 v[224:227], v3, s[12:15], s33 offen sc1
    v_mfma_f32_16x16x32_bf16 v[80:83], v[196:199], v[108:111], v[80:83]
    ds_read_b128 v[196:199], v8 offset:28672
    s_add_u32 s33, s33, 16384
    v_mfma_f32_16x16x32_bf16 v[80:83], v[192:195], v[100:103], v[80:83]
    ds_read_b128 v[192:195], v8 offset:20480
    v_mfma_f32_16x16x32_bf16 v[84:87], v[200:203], v[100:103], v[84:87]
    v_mfma_f32_16x16x32_bf16 v[84:87], v[204:207], v[108:111], v[84:87]
    buffer_load_dwordx4 v[228:231], v3, s[12:15], s33 offen sc1
    v_mfma_f32_16x16x32_bf16 v[52:55], v[204:207], v[104:107], v[52:55]
    ds_read_b128 v[204:207], v8 offset:29696
    s_add_u32 s33, s33, 16384
    v_mfma_f32_16x16x32_bf16 v[52:55], v[200:203], v[96:99], v[52:55]
    ds_read_b128 v[200:203], v8 offset:21504
    s_waitcnt lgkmcnt(12)
    v_mfma_f32_16x16x32_bf16 v[56:59], v[208:211], v[96:99], v[56:59]
    v_mfma_f32_16x16x32_bf16 v[56:59], v[212:215], v[104:107], v[56:59]
    buffer_load_dwordx4 v[232:235], v3, s[12:15], s33 offen sc1
    v_mfma_f32_16x16x32_bf16 v[88:91], v[212:215], v[108:111], v[88:91]
    ds_read_b128 v[212:215], v8 offset:30720
    s_add_u32 s33, s33, 16384
    v_mfma_f32_16x16x32_bf16 v[88:91], v[208:211], v[100:103], v[88:91]
    ds_read_b128 v[208:211], v8 offset:22528
    v_mfma_f32_16x16x32_bf16 v[92:95], v[216:219], v[100:103], v[92:95]
    v_mfma_f32_16x16x32_bf16 v[92:95], v[220:223], v[108:111], v[92:95]
    buffer_load_dwordx4 v[236:239], v3, s[12:15], s33 offen sc1
    v_mfma_f32_16x16x32_bf16 v[60:63], v[220:223], v[104:107], v[60:63]
    ds_read_b128 v[220:223], v8 offset:31744
    v_mfma_f32_16x16x32_bf16 v[60:63], v[216:219], v[96:99], v[60:63]
    ds_read_b128 v[216:219], v8 offset:23552
    buffer_load_dwordx2 v[28:29], v25, s[12:15], s38 offen sc1
    s_waitcnt vmcnt(13) lgkmcnt(12)
    v_mfma_f32_16x16x32_bf16 v[64:67], v[160:163], v[116:119], v[64:67]
    s_barrier
    ds_read_b128 a[0:3], v8 offset:32768
    v_mfma_f32_16x16x32_bf16 v[64:67], v[164:167], v[124:127], v[64:67]
    ds_read_b128 a[4:7], v8 offset:40960
    v_mfma_f32_16x16x32_bf16 v[68:71], v[172:175], v[124:127], v[68:71]
    ds_read_b128 a[8:11], v12 offset:0
    v_mfma_f32_16x16x32_bf16 v[68:71], v[168:171], v[116:119], v[68:71]
    ds_read_b128 a[12:15], v12 offset:8192
    s_waitcnt lgkmcnt(12)
    v_mfma_f32_16x16x32_bf16 v[72:75], v[176:179], v[116:119], v[72:75]
    ds_read_b128 a[16:19], v8 offset:33792
    v_mfma_f32_16x16x32_bf16 v[72:75], v[180:183], v[124:127], v[72:75]
    ds_read_b128 a[20:23], v8 offset:41984
    v_mfma_f32_16x16x32_bf16 v[76:79], v[188:191], v[124:127], v[76:79]
    ds_read_b128 a[24:27], v12 offset:1024
    v_mfma_f32_16x16x32_bf16 v[76:79], v[184:187], v[116:119], v[76:79]
    ds_read_b128 a[28:31], v12 offset:9216
    s_waitcnt lgkmcnt(12)
    v_mfma_f32_16x16x32_bf16 v[80:83], v[192:195], v[116:119], v[80:83]
    ds_read_b128 a[32:35], v8 offset:34816
    v_mfma_f32_16x16x32_bf16 v[80:83], v[196:199], v[124:127], v[80:83]
    ds_read_b128 a[36:39], v8 offset:43008
    v_mfma_f32_16x16x32_bf16 v[84:87], v[204:207], v[124:127], v[84:87]
    ds_read_b128 a[40:43], v12 offset:2048
    v_mfma_f32_16x16x32_bf16 v[84:87], v[200:203], v[116:119], v[84:87]
    ds_read_b128 a[44:47], v12 offset:10240
    s_waitcnt lgkmcnt(12)
    v_mfma_f32_16x16x32_bf16 v[88:91], v[208:211], v[116:119], v[88:91]
    ds_read_b128 a[48:51], v8 offset:35840
    v_mfma_f32_16x16x32_bf16 v[88:91], v[212:215], v[124:127], v[88:91]
    ds_read_b128 a[52:55], v8 offset:44032
    v_mfma_f32_16x16x32_bf16 v[92:95], v[220:223], v[124:127], v[92:95]
    ds_read_b128 a[56:59], v12 offset:3072
    v_mfma_f32_16x16x32_bf16 v[92:95], v[216:219], v[116:119], v[92:95]
    ds_read_b128 a[60:63], v12 offset:11264
    s_waitcnt vmcnt(5) lgkmcnt(12)
    v_mfma_f32_16x16x32_bf16 v[64:67], a[0:3], v[132:135], v[64:67]
    ds_read_b128 a[64:67], v8 offset:36864
    v_mfma_f32_16x16x32_bf16 v[64:67], a[4:7], v[140:143], v[64:67]
    ds_read_b128 a[68:71], v8 offset:45056
    v_mfma_f32_16x16x32_bf16 v[64:67], a[8:11], v[148:151], v[64:67]
    ds_read_b128 a[72:75], v12 offset:4096
    v_mfma_f32_16x16x32_bf16 v[64:67], a[12:15], v[156:159], v[64:67]
    ds_read_b128 a[76:79], v12 offset:12288
    s_nop 0
    s_waitcnt lgkmcnt(12)
    v_mfma_f32_16x16x32_bf16 v[68:71], a[28:31], v[156:159], v[68:71]
    ds_read_b128 a[80:83], v8 offset:37888
    s_nop 0
    v_mfma_f32_16x16x32_bf16 v[68:71], a[24:27], v[148:151], v[68:71]
    ds_read_b128 a[84:87], v8 offset:46080
    v_cvt_pk_bf16_f32 v240, v64, v65
    v_mfma_f32_16x16x32_bf16 v[68:71], a[20:23], v[140:143], v[68:71]
    ds_read_b128 a[88:91], v12 offset:5120
    v_cvt_pk_bf16_f32 v241, v66, v67
    v_mfma_f32_16x16x32_bf16 v[68:71], a[16:19], v[132:135], v[68:71]
    ds_read_b128 a[92:95], v12 offset:13312
    s_nop 0
    s_waitcnt lgkmcnt(12)
    v_mfma_f32_16x16x32_bf16 v[72:75], a[32:35], v[132:135], v[72:75]
    ds_read_b128 a[96:99], v8 offset:38912
    s_nop 0
    v_mfma_f32_16x16x32_bf16 v[72:75], a[36:39], v[140:143], v[72:75]
    ds_read_b128 a[100:103], v8 offset:47104
    v_cvt_pk_bf16_f32 v242, v68, v69
    v_mfma_f32_16x16x32_bf16 v[72:75], a[40:43], v[148:151], v[72:75]
    ds_read_b128 a[104:107], v12 offset:6144
    v_cvt_pk_bf16_f32 v243, v70, v71
    v_mfma_f32_16x16x32_bf16 v[72:75], a[44:47], v[156:159], v[72:75]
    ds_read_b128 a[108:111], v12 offset:14336
    buffer_store_dwordx4 v[240:243], v3, s[12:15], s37 offen offset:0 sc1
    s_waitcnt lgkmcnt(12)
    v_mfma_f32_16x16x32_bf16 v[76:79], a[60:63], v[156:159], v[76:79]
    ds_read_b128 a[112:115], v8 offset:39936
    s_nop 0
    v_mfma_f32_16x16x32_bf16 v[76:79], a[56:59], v[148:151], v[76:79]
    ds_read_b128 a[116:119], v8 offset:48128
    v_cvt_pk_bf16_f32 v244, v72, v73
    v_mfma_f32_16x16x32_bf16 v[76:79], a[52:55], v[140:143], v[76:79]
    ds_read_b128 a[120:123], v12 offset:7168
    v_cvt_pk_bf16_f32 v245, v74, v75
    v_mfma_f32_16x16x32_bf16 v[76:79], a[48:51], v[132:135], v[76:79]
    ds_read_b128 a[124:127], v12 offset:15360
    s_nop 0
    s_waitcnt lgkmcnt(12)
    v_mfma_f32_16x16x32_bf16 v[80:83], a[64:67], v[132:135], v[80:83]
iw_d12:
    s_cbranch_execz iw_d15
    s_nop 1
    v_mfma_f32_16x16x32_bf16 v[80:83], a[68:71], v[140:143], v[80:83]
    s_nop 0
    v_cvt_pk_bf16_f32 v246, v76, v77
    v_mfma_f32_16x16x32_bf16 v[80:83], a[72:75], v[148:151], v[80:83]
    v_cvt_pk_bf16_f32 v247, v78, v79
    buffer_store_dwordx4 v[244:247], v3, s[12:15], s37 offen offset:1024 sc1
    v_mfma_f32_16x16x32_bf16 v[80:83], a[76:79], v[156:159], v[80:83]
    s_nop 1
    s_waitcnt lgkmcnt(8)
    v_mfma_f32_16x16x32_bf16 v[84:87], a[92:95], v[156:159], v[84:87]
    s_nop 1
    v_mfma_f32_16x16x32_bf16 v[84:87], a[88:91], v[148:151], v[84:87]
    s_nop 0
    v_cvt_pk_bf16_f32 v248, v80, v81
    v_mfma_f32_16x16x32_bf16 v[84:87], a[84:87], v[140:143], v[84:87]
    v_cvt_pk_bf16_f32 v249, v82, v83
    v_mfma_f32_16x16x32_bf16 v[84:87], a[80:83], v[132:135], v[84:87]
    s_nop 1
    s_waitcnt lgkmcnt(4)
    v_mfma_f32_16x16x32_bf16 v[88:91], a[96:99], v[132:135], v[88:91]
    s_nop 1
    v_mfma_f32_16x16x32_bf16 v[88:91], a[100:103], v[140:143], v[88:91]
    s_nop 0
    v_cvt_pk_bf16_f32 v250, v84, v85
    v_mfma_f32_16x16x32_bf16 v[88:91], a[104:107], v[148:151], v[88:91]
    v_cvt_pk_bf16_f32 v251, v86, v87
    buffer_store_dwordx4 v[248:251], v3, s[12:15], s37 offen offset:2048 sc1
    v_mfma_f32_16x16x32_bf16 v[88:91], a[108:111], v[156:159], v[88:91]
    s_nop 1
    s_waitcnt lgkmcnt(0)
    v_mfma_f32_16x16x32_bf16 v[92:95], a[124:127], v[156:159], v[92:95]
    s_nop 1
    v_mfma_f32_16x16x32_bf16 v[92:95], a[120:123], v[148:151], v[92:95]
    s_nop 0
    v_cvt_pk_bf16_f32 v252, v88, v89
    v_mfma_f32_16x16x32_bf16 v[92:95], a[116:119], v[140:143], v[92:95]
    v_cvt_pk_bf16_f32 v253, v90, v91
    v_mfma_f32_16x16x32_bf16 v[92:95], a[112:115], v[132:135], v[92:95]
    s_nop 1
    v_mfma_f32_16x16x32_bf16 v[32:35], v[160:163], v[112:115], v[32:35]
    s_nop 1
    v_mfma_f32_16x16x32_bf16 v[32:35], v[164:167], v[120:123], v[32:35]
    s_nop 1
    v_mfma_f32_16x16x32_bf16 v[32:35], a[0:3], v[128:131], v[32:35]
    v_cvt_pk_bf16_f32 v254, v92, v93
    v_cvt_pk_bf16_f32 v255, v94, v95
    v_mfma_f32_16x16x32_bf16 v[32:35], a[4:7], v[136:139], v[32:35]
    buffer_store_dwordx4 v[252:255], v3, s[12:15], s37 offen offset:3072 sc1
    v_mfma_f32_16x16x32_bf16 v[32:35], a[8:11], v[144:147], v[32:35]
    v_mfma_f32_16x16x32_bf16 v[32:35], a[12:15], v[152:155], v[32:35]
    v_mfma_f32_16x16x32_bf16 v[36:39], a[28:31], v[152:155], v[36:39]
    v_mfma_f32_16x16x32_bf16 v[36:39], a[24:27], v[144:147], v[36:39]
    v_mfma_f32_16x16x32_bf16 v[36:39], a[20:23], v[136:139], v[36:39]
    v_mfma_f32_16x16x32_bf16 v[36:39], a[16:19], v[128:131], v[36:39]
    v_mfma_f32_16x16x32_bf16 v[36:39], v[172:175], v[120:123], v[36:39]
    v_mfma_f32_16x16x32_bf16 v[36:39], v[168:171], v[112:115], v[36:39]
    v_mfma_f32_16x16x32_bf16 v[40:43], v[176:179], v[112:115], v[40:43]
    v_mfma_f32_16x16x32_bf16 v[40:43], v[180:183], v[120:123], v[40:43]
    v_mfma_f32_16x16x32_bf16 v[40:43], a[32:35], v[128:131], v[40:43]
    v_mfma_f32_16x16x32_bf16 v[40:43], a[36:39], v[136:139], v[40:43]
    v_mfma_f32_16x16x32_bf16 v[40:43], a[40:43], v[144:147], v[40:43]
    v_mfma_f32_16x16x32_bf16 v[40:43], a[44:47], v[152:155], v[40:43]
    v_mfma_f32_16x16x32_bf16 v[44:47], a[60:63], v[152:155], v[44:47]
    v_mfma_f32_16x16x32_bf16 v[44:47], a[56:59], v[144:147], v[44:47]
    v_mfma_f32_16x16x32_bf16 v[44:47], a[52:55], v[136:139], v[44:47]
    v_mfma_f32_16x16x32_bf16 v[44:47], a[48:51], v[128:131], v[44:47]
    v_mfma_f32_16x16x32_bf16 v[44:47], v[188:191], v[120:123], v[44:47]
    v_mfma_f32_16x16x32_bf16 v[44:47], v[184:187], v[112:115], v[44:47]
    v_mfma_f32_16x16x32_bf16 v[48:51], v[192:195], v[112:115], v[48:51]
    v_mfma_f32_16x16x32_bf16 v[48:51], v[196:199], v[120:123], v[48:51]
    v_mfma_f32_16x16x32_bf16 v[48:51], a[64:67], v[128:131], v[48:51]
    v_mfma_f32_16x16x32_bf16 v[48:51], a[68:71], v[136:139], v[48:51]
    v_mfma_f32_16x16x32_bf16 v[48:51], a[72:75], v[144:147], v[48:51]
    v_mfma_f32_16x16x32_bf16 v[48:51], a[76:79], v[152:155], v[48:51]
    v_mfma_f32_16x16x32_bf16 v[52:55], a[92:95], v[152:155], v[52:55]
    v_mfma_f32_16x16x32_bf16 v[52:55], a[88:91], v[144:147], v[52:55]
    v_mfma_f32_16x16x32_bf16 v[52:55], a[84:87], v[136:139], v[52:55]
    v_mfma_f32_16x16x32_bf16 v[52:55], a[80:83], v[128:131], v[52:55]
    v_mfma_f32_16x16x32_bf16 v[52:55], v[204:207], v[120:123], v[52:55]
    v_mfma_f32_16x16x32_bf16 v[52:55], v[200:203], v[112:115], v[52:55]
    v_mfma_f32_16x16x32_bf16 v[56:59], v[208:211], v[112:115], v[56:59]
    v_mfma_f32_16x16x32_bf16 v[56:59], v[212:215], v[120:123], v[56:59]
    v_mfma_f32_16x16x32_bf16 v[56:59], a[96:99], v[128:131], v[56:59]
    v_mfma_f32_16x16x32_bf16 v[56:59], a[100:103], v[136:139], v[56:59]
    v_mfma_f32_16x16x32_bf16 v[56:59], a[104:107], v[144:147], v[56:59]
    v_mfma_f32_16x16x32_bf16 v[56:59], a[108:111], v[152:155], v[56:59]
    v_mfma_f32_16x16x32_bf16 v[60:63], a[124:127], v[152:155], v[60:63]
    v_mfma_f32_16x16x32_bf16 v[60:63], a[120:123], v[144:147], v[60:63]
    v_mfma_f32_16x16x32_bf16 v[60:63], a[116:119], v[136:139], v[60:63]
    v_mfma_f32_16x16x32_bf16 v[60:63], a[112:115], v[128:131], v[60:63]
    v_mfma_f32_16x16x32_bf16 v[60:63], v[220:223], v[120:123], v[60:63]
    v_mfma_f32_16x16x32_bf16 v[60:63], v[216:219], v[112:115], v[60:63]
interl_g2fin67:
    s_mov_b32 s32, 0x3f80
    s_mov_b32 s35, 0x3f800000
    s_add_u32 s63, s63, 1
    v_mov_b32 v4, 0
    v_mov_b32 v5, s63
    s_cmp_lg_u32 s3, 0
    s_waitcnt vmcnt(0)
    s_barrier
    s_cbranch_scc1 interl_sig69
    s_mov_b64 exec, 1
    buffer_store_dword v5, v4, s[12:15], s94 offen sc1
    s_mov_b64 exec, -1
interl_sig69:
    v_rcp_f32 v28, v28
    s_nop 0
    v_mul_f32 v29, -v29, v28
    v_lshlrev_b32 v4, 16, v224
    v_and_b32 v5, s61, v224
    v_pk_fma_f32 v[4:5], v[4:5], v[28:29], v[28:29] op_sel:[0,0,1] op_sel_hi:[1,0,1]
    v_pk_add_f32 v[32:33], v[32:33], v[4:5]
    v_lshlrev_b32 v4, 16, v225
    v_and_b32 v5, s61, v225
    v_pk_fma_f32 v[4:5], v[4:5], v[28:29], v[28:29] op_sel:[0,0,1] op_sel_hi:[1,0,1]
    v_pk_add_f32 v[34:35], v[34:35], v[4:5]
    v_lshlrev_b32 v4, 16, v226
    v_and_b32 v5, s61, v226
    v_pk_fma_f32 v[4:5], v[4:5], v[28:29], v[28:29] op_sel:[0,0,1] op_sel_hi:[1,0,1]
    v_pk_add_f32 v[36:37], v[36:37], v[4:5]
    v_lshlrev_b32 v4, 16, v227
    v_and_b32 v5, s61, v227
    v_pk_fma_f32 v[4:5], v[4:5], v[28:29], v[28:29] op_sel:[0,0,1] op_sel_hi:[1,0,1]
    v_pk_add_f32 v[38:39], v[38:39], v[4:5]
    v_lshlrev_b32 v4, 16, v228
    v_and_b32 v5, s61, v228
    v_pk_fma_f32 v[4:5], v[4:5], v[28:29], v[28:29] op_sel:[0,0,1] op_sel_hi:[1,0,1]
    v_pk_add_f32 v[40:41], v[40:41], v[4:5]
    v_lshlrev_b32 v4, 16, v229
    v_and_b32 v5, s61, v229
    v_pk_fma_f32 v[4:5], v[4:5], v[28:29], v[28:29] op_sel:[0,0,1] op_sel_hi:[1,0,1]
    v_pk_add_f32 v[42:43], v[42:43], v[4:5]
    v_lshlrev_b32 v4, 16, v230
    v_and_b32 v5, s61, v230
    v_pk_fma_f32 v[4:5], v[4:5], v[28:29], v[28:29] op_sel:[0,0,1] op_sel_hi:[1,0,1]
    v_pk_add_f32 v[44:45], v[44:45], v[4:5]
    v_lshlrev_b32 v4, 16, v231
    v_and_b32 v5, s61, v231
    v_pk_fma_f32 v[4:5], v[4:5], v[28:29], v[28:29] op_sel:[0,0,1] op_sel_hi:[1,0,1]
    v_pk_add_f32 v[46:47], v[46:47], v[4:5]
    v_lshlrev_b32 v4, 16, v232
    v_and_b32 v5, s61, v232
    v_pk_fma_f32 v[4:5], v[4:5], v[28:29], v[28:29] op_sel:[0,0,1] op_sel_hi:[1,0,1]
    v_pk_add_f32 v[48:49], v[48:49], v[4:5]
iw_c13:
    s_cbranch_execz iw_c16
    v_lshlrev_b32 v4, 16, v233
    v_and_b32 v5, s61, v233
    v_pk_fma_f32 v[4:5], v[4:5], v[28:29], v[28:29] op_sel:[0,0,1] op_sel_hi:[1,0,1]
    v_pk_add_f32 v[50:51], v[50:51], v[4:5]
    v_lshlrev_b32 v4, 16, v234
    v_and_b32 v5, s61, v234
    v_pk_fma_f32 v[4:5], v[4:5], v[28:29], v[28:29] op_sel:[0,0,1] op_sel_hi:[1,0,1]
    v_pk_add_f32 v[52:53], v[52:53], v[4:5]
    v_lshlrev_b32 v4, 16, v235
    v_and_b32 v5, s61, v235
    v_pk_fma_f32 v[4:5], v[4:5], v[28:29], v[28:29] op_sel:[0,0,1] op_sel_hi:[1,0,1]
    v_pk_add_f32 v[54:55], v[54:55], v[4:5]
    v_lshlrev_b32 v4, 16, v236
    v_and_b32 v5, s61, v236
    v_pk_fma_f32 v[4:5], v[4:5], v[28:29], v[28:29] op_sel:[0,0,1] op_sel_hi:[1,0,1]
    v_pk_add_f32 v[56:57], v[56:57], v[4:5]
    v_lshlrev_b32 v4, 16, v237
    v_and_b32 v5, s61, v237
    v_pk_fma_f32 v[4:5], v[4:5], v[28:29], v[28:29] op_sel:[0,0,1] op_sel_hi:[1,0,1]
    v_pk_add_f32 v[58:59], v[58:59], v[4:5]
    v_lshlrev_b32 v4, 16, v238
    v_and_b32 v5, s61, v238
    v_pk_fma_f32 v[4:5], v[4:5], v[28:29], v[28:29] op_sel:[0,0,1] op_sel_hi:[1,0,1]
    v_pk_add_f32 v[60:61], v[60:61], v[4:5]
    v_lshlrev_b32 v4, 16, v239
    v_and_b32 v5, s61, v239
    v_pk_fma_f32 v[4:5], v[4:5], v[28:29], v[28:29] op_sel:[0,0,1] op_sel_hi:[1,0,1]
    v_pk_add_f32 v[62:63], v[62:63], v[4:5]
    s_mul_i32 s33, s3, 4352
    v_and_b32 v4, 15, v2
    v_lshrrev_b32 v5, 4, v2
    v_mul_u32_u24 v6, 272, v4
    v_lshl_add_u32 v6, v5, 4, v6
    v_add_u32 v10, s33, v6
    v_mul_u32_u24 v6, 272, v5
    v_lshl_add_u32 v6, v4, 4, v6
    v_add_u32 v11, s33, v6
    v_lshlrev_b32 v4, 4, v4
    v_lshl_add_u32 v24, v5, 11, v4
    s_cmp_lg_u32 s3, 0
    s_cbranch_scc1 interl_wt70
    s_xor_b32 s62, s5, 16
    s_lshl_b32 exec_lo, 1, s62
    s_mov_b32 exec_hi, 0
    s_mov_b32 s62, 4000000
interl_poll71:
    buffer_load_dword v7, v0, s[12:15], s95 offen sc1
    s_sub_u32 s62, s62, 1
    s_cbranch_scc1 interl_pd72
    s_waitcnt vmcnt(0)
    v_cmp_gt_u32 vcc, s63, v7
    s_cbranch_vccnz interl_poll71
interl_pd72:
    s_mov_b64 exec, -1
interl_wt70:
    s_barrier
    buffer_load_dwordx4 v[160:163], v3, s[12:15], s34 offen offset:0 sc1
    buffer_load_dwordx4 v[164:167], v3, s[12:15], s34 offen offset:1024 sc1
    buffer_load_dwordx4 v[168:171], v3, s[12:15], s34 offen offset:2048 sc1
    buffer_load_dwordx4 v[172:175], v3, s[12:15], s34 offen offset:3072 sc1
    s_waitcnt vmcnt(3)
    v_dot2_f32_bf16 v32, v160, s32, v32
    v_dot2_f32_bf16 v33, v160, s35, v33
    v_dot2_f32_bf16 v34, v161, s32, v34
    v_dot2_f32_bf16 v35, v161, s35, v35
    v_dot2_f32_bf16 v36, v162, s32, v36
    v_dot2_f32_bf16 v37, v162, s35, v37
    v_dot2_f32_bf16 v38, v163, s32, v38
    v_dot2_f32_bf16 v39, v163, s35, v39
    s_nop 0
    v_cvt_pk_bf16_f32 v224, v32, v33
    v_cvt_pk_bf16_f32 v225, v34, v35
    v_cvt_pk_bf16_f32 v226, v36, v37
    v_cvt_pk_bf16_f32 v227, v38, v39
    ds_write_b128 v10, v[224:227] offset:0
    s_waitcnt vmcnt(2)
    v_dot2_f32_bf16 v40, v164, s32, v40
    v_dot2_f32_bf16 v41, v164, s35, v41
    v_dot2_f32_bf16 v42, v165, s32, v42
    v_dot2_f32_bf16 v43, v165, s35, v43
    v_dot2_f32_bf16 v44, v166, s32, v44
    v_dot2_f32_bf16 v45, v166, s35, v45
    v_dot2_f32_bf16 v46, v167, s32, v46
    v_dot2_f32_bf16 v47, v167, s35, v47
    s_nop 0
    v_cvt_pk_bf16_f32 v228, v40, v41
    v_cvt_pk_bf16_f32 v229, v42, v43
    v_cvt_pk_bf16_f32 v230, v44, v45
    v_cvt_pk_bf16_f32 v231, v46, v47
    ds_write_b128 v10, v[228:231] offset:64
    s_waitcnt vmcnt(1)
    v_dot2_f32_bf16 v48, v168, s32, v48
    v_dot2_f32_bf16 v49, v168, s35, v49
    v_dot2_f32_bf16 v50, v169, s32, v50
    v_dot2_f32_bf16 v51, v169, s35, v51
    v_dot2_f32_bf16 v52, v170, s32, v52
    v_dot2_f32_bf16 v53, v170, s35, v53
    v_dot2_f32_bf16 v54, v171, s32, v54
    v_dot2_f32_bf16 v55, v171, s35, v55
    s_nop 0
    v_cvt_pk_bf16_f32 v232, v48, v49
    v_cvt_pk_bf16_f32 v233, v50, v51
    v_cvt_pk_bf16_f32 v234, v52, v53
    v_cvt_pk_bf16_f32 v235, v54, v55
    ds_write_b128 v10, v[232:235] offset:128
    s_waitcnt vmcnt(0)
    v_dot2_f32_bf16 v56, v172, s32, v56
    v_dot2_f32_bf16 v57, v172, s35, v57
    v_dot2_f32_bf16 v58, v173, s32, v58
    v_dot2_f32_bf16 v59, v173, s35, v59
    v_dot2_f32_bf16 v60, v174, s32, v60
    v_dot2_f32_bf16 v61, v174, s35, v61
    v_dot2_f32_bf16 v62, v175, s32, v62
    v_dot2_f32_bf16 v63, v175, s35, v63
    s_nop 0
    v_cvt_pk_bf16_f32 v236, v56, v57
    v_cvt_pk_bf16_f32 v237, v58, v59
    v_cvt_pk_bf16_f32 v238, v60, v61
    v_cvt_pk_bf16_f32 v239, v62, v63
    ds_write_b128 v10, v[236:239] offset:192
    ds_read_b128 v[160:163], v11 offset:0
    ds_read_b128 v[164:167], v11 offset:1088
    ds_read_b128 v[168:171], v11 offset:2176
    ds_read_b128 v[172:175], v11 offset:3264
    s_waitcnt lgkmcnt(3)
    buffer_store_dwordx4 v[160:163], v24, s[20:23], s39 offen nt
    s_add_u32 s39, s39, 8192
    s_waitcnt lgkmcnt(2)
    buffer_store_dwordx4 v[164:167], v24, s[20:23], s39 offen nt
    s_add_u32 s39, s39, 8192
    s_waitcnt lgkmcnt(1)
    buffer_store_dwordx4 v[168:171], v24, s[20:23], s39 offen nt
    s_add_u32 s39, s39, 8192
    s_waitcnt lgkmcnt(0)
    buffer_store_dwordx4 v[172:175], v24, s[20:23], s39 offen nt
    s_add_u32 s39, s39, 8192
interleave_layers__ssm_conv_h3__glu_gated_bilinear__prompt_kernel_end:
    s_endpgm
interl_g1c38:
    s_mov_b32 s62, 4000000
interl_poll40:
    buffer_load_dword v7, v23, s[12:15], s95 offen sc1
    s_sub_u32 s62, s62, 1
    s_cbranch_scc1 interl_pd41
    s_waitcnt vmcnt(0)
    v_cmp_gt_u32 vcc, 5, v7
    s_cbranch_vccnz interl_poll40
interl_pd41:
    s_mov_b64 exec, -1
    s_branch interl_g1d39
interl_g1k47:
    s_cmp_eq_u32 s3, 0
    s_cbranch_scc1 interl_g1a48
    s_cmp_eq_u32 s3, 2
    s_cbranch_scc1 interl_g1a48
    s_branch interl_g1a49
interl_g1b50:
    s_waitcnt lgkmcnt(2)
    v_mfma_f32_16x16x32_bf16 v[32:35], a[0:3], a[112:115], v[32:35]
    v_lshl_add_u32 v4, v1, s65, v5
    v_mfma_f32_16x16x32_bf16 v[32:35], a[28:31], a[116:119], v[32:35]
    s_and_b32 s50, s65, 0xffffff80
    s_add_u32 m0, s72, 0
    v_mfma_f32_16x16x32_bf16 v[36:39], a[32:35], a[116:119], v[36:39]
    s_sub_u32 s47, s47, 1
    v_mfma_f32_16x16x32_bf16 v[36:39], a[4:7], a[112:115], v[36:39]
    s_cmp_lg_u32 s65, 0
    s_cselect_b32 s18, 7340032, 0
    v_mfma_f32_16x16x32_bf16 v[40:43], a[8:11], a[112:115], v[40:43]
    s_cmp_lg_u32 s75, 0
    s_cselect_b32 s26, s14, 0
    v_mfma_f32_16x16x32_bf16 v[40:43], a[36:39], a[116:119], v[40:43]
iw_d13:
    s_cbranch_execz iw_d16
    v_mfma_f32_16x16x32_bf16 v[44:47], a[40:43], a[116:119], v[44:47]
    s_waitcnt vmcnt(19) lgkmcnt(0)
    v_mfma_f32_16x16x32_bf16 v[44:47], a[12:15], a[112:115], v[44:47]
    s_barrier
    v_mfma_f32_16x16x32_bf16 v[48:51], a[16:19], a[112:115], v[48:51]
    ds_read_b64_tr_b16 a[56:57], v14 offset:0
    v_mfma_f32_16x16x32_bf16 v[48:51], a[44:47], a[116:119], v[48:51]
    ds_read_b64_tr_b16 a[58:59], v14 offset:1024
    v_mfma_f32_16x16x32_bf16 v[52:55], a[48:51], a[116:119], v[52:55]
    buffer_load_dwordx4 v4, s[16:19], s50 offen nt lds
    v_mfma_f32_16x16x32_bf16 v[52:55], a[20:23], a[112:115], v[52:55]
    ds_read_b64_tr_b16 a[60:61], v15 offset:0
    v_mfma_f32_16x16x32_bf16 v[56:59], a[24:27], a[112:115], v[56:59]
    ds_read_b64_tr_b16 a[62:63], v15 offset:1024
    v_mfma_f32_16x16x32_bf16 v[56:59], a[52:55], a[116:119], v[56:59]
    buffer_store_dwordx4 a[176:179], v3, s[24:27], s75 offen sc1
    v_mfma_f32_16x16x32_bf16 v[84:87], a[24:27], a[120:123], v[84:87]
    ds_read_b64_tr_b16 a[64:65], v16 offset:0
    v_mfma_f32_16x16x32_bf16 v[84:87], a[52:55], a[124:127], v[84:87]
    ds_read_b64_tr_b16 a[66:67], v16 offset:1024
    s_add_u32 m0, s42, 0
    v_mfma_f32_16x16x32_bf16 v[80:83], a[48:51], a[124:127], v[80:83]
    buffer_load_dwordx4 v3, s[12:15], s40 offen offset:0 sc1 lds
    v_mfma_f32_16x16x32_bf16 v[80:83], a[20:23], a[120:123], v[80:83]
    ds_read_b64_tr_b16 a[68:69], v14 offset:8208
    v_mfma_f32_16x16x32_bf16 v[76:79], a[16:19], a[120:123], v[76:79]
    ds_read_b64_tr_b16 a[70:71], v14 offset:9232
    v_mfma_f32_16x16x32_bf16 v[76:79], a[44:47], a[124:127], v[76:79]
    v_mfma_f32_16x16x32_bf16 v[72:75], a[40:43], a[124:127], v[72:75]
    ds_read_b64_tr_b16 a[72:73], v15 offset:8208
    v_mfma_f32_16x16x32_bf16 v[72:75], a[12:15], a[120:123], v[72:75]
    ds_read_b64_tr_b16 a[74:75], v15 offset:9232
    v_mfma_f32_16x16x32_bf16 v[68:71], a[8:11], a[120:123], v[68:71]
    buffer_load_dwordx4 v3, s[12:15], s40 offen offset:1024 sc1 lds
    v_mfma_f32_16x16x32_bf16 v[68:71], a[36:39], a[124:127], v[68:71]
    ds_read_b64_tr_b16 a[76:77], v16 offset:8208
    v_mfma_f32_16x16x32_bf16 v[64:67], a[32:35], a[124:127], v[64:67]
    ds_read_b64_tr_b16 a[78:79], v16 offset:9232
    v_mfma_f32_16x16x32_bf16 v[64:67], a[4:7], a[120:123], v[64:67]
    v_mfma_f32_16x16x32_bf16 v[60:63], a[0:3], a[120:123], v[60:63]
    ds_read_b64_tr_b16 a[80:81], v17 offset:0
    v_mfma_f32_16x16x32_bf16 v[60:63], a[28:31], a[124:127], v[60:63]
    ds_read_b64_tr_b16 a[82:83], v17 offset:1024
    v_mfma_f32_16x16x32_bf16 v[88:91], a[0:3], a[128:131], v[88:91]
    buffer_load_dwordx4 v3, s[12:15], s40 offen offset:2048 sc1 lds
    v_mfma_f32_16x16x32_bf16 v[88:91], a[28:31], a[132:135], v[88:91]
    ds_read_b64_tr_b16 a[84:85], v14 offset:33024
    v_mfma_f32_16x16x32_bf16 v[92:95], a[32:35], a[132:135], v[92:95]
    ds_read_b64_tr_b16 a[86:87], v14 offset:34048
    v_mfma_f32_16x16x32_bf16 v[92:95], a[4:7], a[128:131], v[92:95]
    v_mfma_f32_16x16x32_bf16 v[96:99], a[8:11], a[128:131], v[96:99]
    ds_read_b64_tr_b16 a[88:89], v15 offset:33024
    v_mfma_f32_16x16x32_bf16 v[96:99], a[36:39], a[132:135], v[96:99]
    ds_read_b64_tr_b16 a[90:91], v15 offset:34048
    v_mfma_f32_16x16x32_bf16 v[100:103], a[40:43], a[132:135], v[100:103]
    buffer_load_dwordx4 v3, s[12:15], s40 offen offset:3072 sc1 lds
    v_mfma_f32_16x16x32_bf16 v[100:103], a[12:15], a[128:131], v[100:103]
    ds_read_b64_tr_b16 a[92:93], v16 offset:33024
    s_add_u32 s40, s40, 16384
    v_mfma_f32_16x16x32_bf16 v[104:107], a[16:19], a[128:131], v[104:107]
    ds_read_b64_tr_b16 a[94:95], v16 offset:34048
    v_mfma_f32_16x16x32_bf16 v[104:107], a[44:47], a[132:135], v[104:107]
    v_mfma_f32_16x16x32_bf16 v[108:111], a[48:51], a[132:135], v[108:111]
    ds_read_b64_tr_b16 a[96:97], v14 offset:41232
    v_mfma_f32_16x16x32_bf16 v[108:111], a[20:23], a[128:131], v[108:111]
    ds_read_b64_tr_b16 a[98:99], v14 offset:42256
    s_add_u32 m0, s42, 33024
    v_mfma_f32_16x16x32_bf16 v[112:115], a[24:27], a[128:131], v[112:115]
    buffer_load_dwordx4 v3, s[12:15], s40 offen offset:0 sc1 lds
    v_mfma_f32_16x16x32_bf16 v[112:115], a[52:55], a[132:135], v[112:115]
    ds_read_b64_tr_b16 a[100:101], v15 offset:41232
    v_mfma_f32_16x16x32_bf16 v[140:143], a[24:27], a[136:139], v[140:143]
    ds_read_b64_tr_b16 a[102:103], v15 offset:42256
    v_mfma_f32_16x16x32_bf16 v[140:143], a[52:55], a[140:143], v[140:143]
    v_mfma_f32_16x16x32_bf16 v[136:139], a[48:51], a[140:143], v[136:139]
    ds_read_b64_tr_b16 a[104:105], v16 offset:41232
    v_mfma_f32_16x16x32_bf16 v[136:139], a[20:23], a[136:139], v[136:139]
    ds_read_b64_tr_b16 a[106:107], v16 offset:42256
    v_mfma_f32_16x16x32_bf16 v[132:135], a[16:19], a[136:139], v[132:135]
    buffer_load_dwordx4 v3, s[12:15], s40 offen offset:1024 sc1 lds
    v_mfma_f32_16x16x32_bf16 v[132:135], a[44:47], a[140:143], v[132:135]
    ds_read_b64_tr_b16 a[108:109], v17 offset:33024
    v_mfma_f32_16x16x32_bf16 v[128:131], a[40:43], a[140:143], v[128:131]
    ds_read_b64_tr_b16 a[110:111], v17 offset:34048
    v_mfma_f32_16x16x32_bf16 v[128:131], a[12:15], a[136:139], v[128:131]
    v_mfma_f32_16x16x32_bf16 v[124:127], a[8:11], a[136:139], v[124:127]
    s_mov_b64 s[64:65], s[66:67]
    v_mfma_f32_16x16x32_bf16 v[124:127], a[36:39], a[140:143], v[124:127]
    s_mov_b64 s[66:67], s[68:69]
    v_mfma_f32_16x16x32_bf16 v[120:123], a[32:35], a[140:143], v[120:123]
    buffer_load_dwordx4 v3, s[12:15], s40 offen offset:2048 sc1 lds
    v_mfma_f32_16x16x32_bf16 v[120:123], a[4:7], a[136:139], v[120:123]
    s_mov_b64 s[68:69], s[70:71]
    v_mfma_f32_16x16x32_bf16 v[116:119], a[0:3], a[136:139], v[116:119]
    s_mov_b64 s[74:75], s[76:77]
    v_mfma_f32_16x16x32_bf16 v[116:119], a[28:31], a[140:143], v[116:119]
    v_mfma_f32_16x16x32_bf16 v[144:147], a[0:3], a[144:147], v[144:147]
    s_mov_b64 s[76:77], s[78:79]
    v_mfma_f32_16x16x32_bf16 v[144:147], a[28:31], a[148:151], v[144:147]
    s_mov_b64 s[78:79], s[80:81]
    v_mfma_f32_16x16x32_bf16 v[148:151], a[32:35], a[148:151], v[148:151]
    buffer_load_dwordx4 v3, s[12:15], s40 offen offset:3072 sc1 lds
    v_mfma_f32_16x16x32_bf16 v[148:151], a[4:7], a[144:147], v[148:151]
    s_add_u32 s40, s40, 16384
    v_mfma_f32_16x16x32_bf16 v[152:155], a[8:11], a[144:147], v[152:155]
    s_mov_b64 s[80:81], s[82:83]
    v_mfma_f32_16x16x32_bf16 v[152:155], a[36:39], a[148:151], v[152:155]
    s_mov_b64 s[70:71], 0
    v_mfma_f32_16x16x32_bf16 v[156:159], a[40:43], a[148:151], v[156:159]
    s_waitcnt vmcnt(19) lgkmcnt(0)
    v_mfma_f32_16x16x32_bf16 v[156:159], a[12:15], a[144:147], v[156:159]
    s_barrier
    v_mfma_f32_16x16x32_bf16 v[160:163], a[16:19], a[144:147], v[160:163]
    v_mfma_f32_16x16x32_bf16 v[160:163], a[44:47], a[148:151], v[160:163]
    ds_read_b128 a[112:115], v9 offset:0
    v_mfma_f32_16x16x32_bf16 v[164:167], a[48:51], a[148:151], v[164:167]
    ds_read_b128 a[116:119], v9 offset:33024
    s_add_u32 m0, s43, 66048
    v_mfma_f32_16x16x32_bf16 v[164:167], a[20:23], a[144:147], v[164:167]
    buffer_load_dwordx4 v19, s[8:11], s41 offen offset:0 lds
    v_mfma_f32_16x16x32_bf16 v[168:171], a[24:27], a[144:147], v[168:171]
    ds_read_b128 a[120:123], v9 offset:1024
    v_mfma_f32_16x16x32_bf16 v[168:171], a[52:55], a[148:151], v[168:171]
    ds_read_b128 a[124:127], v9 offset:34048
    v_mfma_f32_16x16x32_bf16 v[196:199], a[24:27], a[152:155], v[196:199]
    v_mfma_f32_16x16x32_bf16 v[196:199], a[52:55], a[156:159], v[196:199]
    ds_read_b128 a[128:131], v9 offset:2048
    v_mfma_f32_16x16x32_bf16 v[192:195], a[48:51], a[156:159], v[192:195]
    ds_read_b128 a[132:135], v9 offset:35072
    buffer_load_dwordx4 v20, s[8:11], s41 offen offset:1024 lds
    v_mfma_f32_16x16x32_bf16 v[192:195], a[20:23], a[152:155], v[192:195]
iw_c14:
    s_cbranch_execz iw_ret
    v_mfma_f32_16x16x32_bf16 v[188:191], a[16:19], a[152:155], v[188:191]
    ds_read_b128 a[136:139], v9 offset:3072
    v_mfma_f32_16x16x32_bf16 v[188:191], a[44:47], a[156:159], v[188:191]
    ds_read_b128 a[140:143], v9 offset:36096
    v_mfma_f32_16x16x32_bf16 v[184:187], a[40:43], a[156:159], v[184:187]
    v_mfma_f32_16x16x32_bf16 v[184:187], a[12:15], a[152:155], v[184:187]
    ds_read_b128 a[144:147], v9 offset:4096
    buffer_load_dwordx4 v21, s[8:11], s41 offen offset:2048 lds
    v_mfma_f32_16x16x32_bf16 v[180:183], a[8:11], a[152:155], v[180:183]
    ds_read_b128 a[148:151], v9 offset:37120
    v_mfma_f32_16x16x32_bf16 v[180:183], a[36:39], a[156:159], v[180:183]
    v_mfma_f32_16x16x32_bf16 v[176:179], a[32:35], a[156:159], v[176:179]
    v_mfma_f32_16x16x32_bf16 v[176:179], a[4:7], a[152:155], v[176:179]
    v_mfma_f32_16x16x32_bf16 v[172:175], a[0:3], a[152:155], v[172:175]
    buffer_load_dwordx4 v22, s[8:11], s41 offen offset:3072 lds
    v_mfma_f32_16x16x32_bf16 v[172:175], a[28:31], a[156:159], v[172:175]
    ds_read_b128 a[152:155], v9 offset:5120
    s_add_u32 s41, s41, 229376
    v_mfma_f32_16x16x32_bf16 v[200:203], a[0:3], a[160:163], v[200:203]
    ds_read_b128 a[156:159], v9 offset:38144
    v_mfma_f32_16x16x32_bf16 v[200:203], a[28:31], a[164:167], v[200:203]
    v_mfma_f32_16x16x32_bf16 v[204:207], a[32:35], a[164:167], v[204:207]
    s_add_u32 m0, s43, 99072
    v_mfma_f32_16x16x32_bf16 v[204:207], a[4:7], a[160:163], v[204:207]
    buffer_load_dwordx4 v19, s[8:11], s41 offen offset:0 lds
    v_mfma_f32_16x16x32_bf16 v[208:211], a[8:11], a[160:163], v[208:211]
    v_mfma_f32_16x16x32_bf16 v[208:211], a[36:39], a[164:167], v[208:211]
    v_mfma_f32_16x16x32_bf16 v[212:215], a[40:43], a[164:167], v[212:215]
    v_mfma_f32_16x16x32_bf16 v[212:215], a[12:15], a[160:163], v[212:215]
    v_mfma_f32_16x16x32_bf16 v[216:219], a[16:19], a[160:163], v[216:219]
    buffer_load_dwordx4 v20, s[8:11], s41 offen offset:1024 lds
    v_mfma_f32_16x16x32_bf16 v[216:219], a[44:47], a[164:167], v[216:219]
    ds_read_b64_tr_b16 a[176:177], v6 offset:4096
    v_mfma_f32_16x16x32_bf16 v[220:223], a[48:51], a[164:167], v[220:223]
    ds_read_b64_tr_b16 a[178:179], v6 offset:4608
    v_mfma_f32_16x16x32_bf16 v[220:223], a[20:23], a[160:163], v[220:223]
    v_mfma_f32_16x16x32_bf16 v[224:227], a[24:27], a[160:163], v[224:227]
    v_mfma_f32_16x16x32_bf16 v[224:227], a[52:55], a[164:167], v[224:227]
    ds_read_b128 a[160:163], v9 offset:6144
    buffer_load_dwordx4 v21, s[8:11], s41 offen offset:2048 lds
    v_mfma_f32_16x16x32_bf16 v[252:255], a[24:27], a[168:171], v[252:255]
    ds_read_b128 a[164:167], v9 offset:39168
    v_mfma_f32_16x16x32_bf16 v[252:255], a[52:55], a[172:175], v[252:255]
    v_mfma_f32_16x16x32_bf16 v[248:251], a[48:51], a[172:175], v[248:251]
    v_mfma_f32_16x16x32_bf16 v[248:251], a[20:23], a[168:171], v[248:251]
    v_mfma_f32_16x16x32_bf16 v[244:247], a[16:19], a[168:171], v[244:247]
    buffer_load_dwordx4 v22, s[8:11], s41 offen offset:3072 lds
    v_mfma_f32_16x16x32_bf16 v[244:247], a[44:47], a[172:175], v[244:247]
    s_add_u32 s41, s41, 229376
    v_mfma_f32_16x16x32_bf16 v[240:243], a[40:43], a[172:175], v[240:243]
    v_mfma_f32_16x16x32_bf16 v[240:243], a[12:15], a[168:171], v[240:243]
    v_mfma_f32_16x16x32_bf16 v[236:239], a[8:11], a[168:171], v[236:239]
    v_mfma_f32_16x16x32_bf16 v[236:239], a[36:39], a[172:175], v[236:239]
    v_mfma_f32_16x16x32_bf16 v[232:235], a[32:35], a[172:175], v[232:235]
    v_mfma_f32_16x16x32_bf16 v[232:235], a[4:7], a[168:171], v[232:235]
    v_mfma_f32_16x16x32_bf16 v[228:231], a[0:3], a[168:171], v[228:231]
    ds_read_b128 a[168:171], v9 offset:7168
    v_mfma_f32_16x16x32_bf16 v[228:231], a[28:31], a[172:175], v[228:231]
    ds_read_b128 a[172:175], v9 offset:40192
interl_g1a48:
    s_waitcnt lgkmcnt(2)
    v_mfma_f32_16x16x32_bf16 v[32:35], a[56:59], a[112:115], v[32:35]
    v_lshl_add_u32 v4, v1, s64, v5
    v_mfma_f32_16x16x32_bf16 v[32:35], a[84:87], a[116:119], v[32:35]
    s_and_b32 s50, s64, 0xffffff80
    s_add_u32 m0, s72, 4096
    v_mfma_f32_16x16x32_bf16 v[36:39], a[88:91], a[116:119], v[36:39]
    v_mfma_f32_16x16x32_bf16 v[36:39], a[60:63], a[112:115], v[36:39]
    s_cmp_lg_u32 s64, 0
    s_cselect_b32 s18, 7340032, 0
    v_mfma_f32_16x16x32_bf16 v[40:43], a[64:67], a[112:115], v[40:43]
    s_cmp_lg_u32 s74, 0
    s_cselect_b32 s26, s14, 0
    v_mfma_f32_16x16x32_bf16 v[40:43], a[92:95], a[116:119], v[40:43]
    v_mfma_f32_16x16x32_bf16 v[44:47], a[96:99], a[116:119], v[44:47]
    s_waitcnt vmcnt(19) lgkmcnt(0)
    v_mfma_f32_16x16x32_bf16 v[44:47], a[68:71], a[112:115], v[44:47]
    s_barrier
    v_mfma_f32_16x16x32_bf16 v[48:51], a[72:75], a[112:115], v[48:51]
    ds_read_b64_tr_b16 a[0:1], v10 offset:0
    v_mfma_f32_16x16x32_bf16 v[48:51], a[100:103], a[116:119], v[48:51]
    ds_read_b64_tr_b16 a[2:3], v10 offset:1024
    v_mfma_f32_16x16x32_bf16 v[52:55], a[104:107], a[116:119], v[52:55]
    buffer_load_dwordx4 v4, s[16:19], s50 offen nt lds
    v_mfma_f32_16x16x32_bf16 v[52:55], a[76:79], a[112:115], v[52:55]
    ds_read_b64_tr_b16 a[4:5], v11 offset:0
    v_mfma_f32_16x16x32_bf16 v[56:59], a[80:83], a[112:115], v[56:59]
    ds_read_b64_tr_b16 a[6:7], v11 offset:1024
    v_mfma_f32_16x16x32_bf16 v[56:59], a[108:111], a[116:119], v[56:59]
    buffer_store_dwordx4 a[176:179], v3, s[24:27], s74 offen sc1
    v_mfma_f32_16x16x32_bf16 v[84:87], a[80:83], a[120:123], v[84:87]
    ds_read_b64_tr_b16 a[8:9], v12 offset:0
    v_mfma_f32_16x16x32_bf16 v[84:87], a[108:111], a[124:127], v[84:87]
    ds_read_b64_tr_b16 a[10:11], v12 offset:1024
    s_add_u32 m0, s42, 66048
    v_mfma_f32_16x16x32_bf16 v[80:83], a[104:107], a[124:127], v[80:83]
    buffer_load_dwordx4 v3, s[12:15], s40 offen offset:0 sc1 lds
    v_mfma_f32_16x16x32_bf16 v[80:83], a[76:79], a[120:123], v[80:83]
    ds_read_b64_tr_b16 a[12:13], v10 offset:8208
    v_mfma_f32_16x16x32_bf16 v[76:79], a[72:75], a[120:123], v[76:79]
    ds_read_b64_tr_b16 a[14:15], v10 offset:9232
    v_mfma_f32_16x16x32_bf16 v[76:79], a[100:103], a[124:127], v[76:79]
    v_mfma_f32_16x16x32_bf16 v[72:75], a[96:99], a[124:127], v[72:75]
    ds_read_b64_tr_b16 a[16:17], v11 offset:8208
    v_mfma_f32_16x16x32_bf16 v[72:75], a[68:71], a[120:123], v[72:75]
    ds_read_b64_tr_b16 a[18:19], v11 offset:9232
    v_mfma_f32_16x16x32_bf16 v[68:71], a[64:67], a[120:123], v[68:71]
    buffer_load_dwordx4 v3, s[12:15], s40 offen offset:1024 sc1 lds
    v_mfma_f32_16x16x32_bf16 v[68:71], a[92:95], a[124:127], v[68:71]
    ds_read_b64_tr_b16 a[20:21], v12 offset:8208
    v_mfma_f32_16x16x32_bf16 v[64:67], a[88:91], a[124:127], v[64:67]
    ds_read_b64_tr_b16 a[22:23], v12 offset:9232
    v_mfma_f32_16x16x32_bf16 v[64:67], a[60:63], a[120:123], v[64:67]
    v_mfma_f32_16x16x32_bf16 v[60:63], a[56:59], a[120:123], v[60:63]
    ds_read_b64_tr_b16 a[24:25], v13 offset:0
    v_mfma_f32_16x16x32_bf16 v[60:63], a[84:87], a[124:127], v[60:63]
    ds_read_b64_tr_b16 a[26:27], v13 offset:1024
    v_mfma_f32_16x16x32_bf16 v[88:91], a[56:59], a[128:131], v[88:91]
    buffer_load_dwordx4 v3, s[12:15], s40 offen offset:2048 sc1 lds
    v_mfma_f32_16x16x32_bf16 v[88:91], a[84:87], a[132:135], v[88:91]
    ds_read_b64_tr_b16 a[28:29], v10 offset:33024
    v_mfma_f32_16x16x32_bf16 v[92:95], a[88:91], a[132:135], v[92:95]
    ds_read_b64_tr_b16 a[30:31], v10 offset:34048
    v_mfma_f32_16x16x32_bf16 v[92:95], a[60:63], a[128:131], v[92:95]
    v_mfma_f32_16x16x32_bf16 v[96:99], a[64:67], a[128:131], v[96:99]
    ds_read_b64_tr_b16 a[32:33], v11 offset:33024
    v_mfma_f32_16x16x32_bf16 v[96:99], a[92:95], a[132:135], v[96:99]
    ds_read_b64_tr_b16 a[34:35], v11 offset:34048
    v_mfma_f32_16x16x32_bf16 v[100:103], a[96:99], a[132:135], v[100:103]
    buffer_load_dwordx4 v3, s[12:15], s40 offen offset:3072 sc1 lds
    v_mfma_f32_16x16x32_bf16 v[100:103], a[68:71], a[128:131], v[100:103]
    ds_read_b64_tr_b16 a[36:37], v12 offset:33024
    s_add_u32 s40, s40, 16384
    v_mfma_f32_16x16x32_bf16 v[104:107], a[72:75], a[128:131], v[104:107]
    ds_read_b64_tr_b16 a[38:39], v12 offset:34048
    v_mfma_f32_16x16x32_bf16 v[104:107], a[100:103], a[132:135], v[104:107]
iw_d14:
    s_cbranch_execz iw_ret2
    v_mfma_f32_16x16x32_bf16 v[108:111], a[104:107], a[132:135], v[108:111]
    ds_read_b64_tr_b16 a[40:41], v10 offset:41232
    v_mfma_f32_16x16x32_bf16 v[108:111], a[76:79], a[128:131], v[108:111]
    ds_read_b64_tr_b16 a[42:43], v10 offset:42256
    s_add_u32 m0, s42, 99072
    v_mfma_f32_16x16x32_bf16 v[112:115], a[80:83], a[128:131], v[112:115]
    buffer_load_dwordx4 v3, s[12:15], s40 offen offset:0 sc1 lds
    v_mfma_f32_16x16x32_bf16 v[112:115], a[108:111], a[132:135], v[112:115]
    ds_read_b64_tr_b16 a[44:45], v11 offset:41232
    v_mfma_f32_16x16x32_bf16 v[140:143], a[80:83], a[136:139], v[140:143]
    ds_read_b64_tr_b16 a[46:47], v11 offset:42256
    v_mfma_f32_16x16x32_bf16 v[140:143], a[108:111], a[140:143], v[140:143]
    v_mfma_f32_16x16x32_bf16 v[136:139], a[104:107], a[140:143], v[136:139]
    ds_read_b64_tr_b16 a[48:49], v12 offset:41232
    v_mfma_f32_16x16x32_bf16 v[136:139], a[76:79], a[136:139], v[136:139]
    ds_read_b64_tr_b16 a[50:51], v12 offset:42256
    v_mfma_f32_16x16x32_bf16 v[132:135], a[72:75], a[136:139], v[132:135]
    buffer_load_dwordx4 v3, s[12:15], s40 offen offset:1024 sc1 lds
    v_mfma_f32_16x16x32_bf16 v[132:135], a[100:103], a[140:143], v[132:135]
    ds_read_b64_tr_b16 a[52:53], v13 offset:33024
    v_mfma_f32_16x16x32_bf16 v[128:131], a[96:99], a[140:143], v[128:131]
    ds_read_b64_tr_b16 a[54:55], v13 offset:34048
    v_mfma_f32_16x16x32_bf16 v[128:131], a[68:71], a[136:139], v[128:131]
    v_mfma_f32_16x16x32_bf16 v[124:127], a[64:67], a[136:139], v[124:127]
    v_mfma_f32_16x16x32_bf16 v[124:127], a[92:95], a[140:143], v[124:127]
    v_mfma_f32_16x16x32_bf16 v[120:123], a[88:91], a[140:143], v[120:123]
    buffer_load_dwordx4 v3, s[12:15], s40 offen offset:2048 sc1 lds
    v_mfma_f32_16x16x32_bf16 v[120:123], a[60:63], a[136:139], v[120:123]
    v_mfma_f32_16x16x32_bf16 v[116:119], a[56:59], a[136:139], v[116:119]
    v_mfma_f32_16x16x32_bf16 v[116:119], a[84:87], a[140:143], v[116:119]
    v_mfma_f32_16x16x32_bf16 v[144:147], a[56:59], a[144:147], v[144:147]
    v_mfma_f32_16x16x32_bf16 v[144:147], a[84:87], a[148:151], v[144:147]
    v_mfma_f32_16x16x32_bf16 v[148:151], a[88:91], a[148:151], v[148:151]
    buffer_load_dwordx4 v3, s[12:15], s40 offen offset:3072 sc1 lds
    v_mfma_f32_16x16x32_bf16 v[148:151], a[60:63], a[144:147], v[148:151]
    s_add_u32 s40, s40, 16384
    v_mfma_f32_16x16x32_bf16 v[152:155], a[64:67], a[144:147], v[152:155]
    v_mfma_f32_16x16x32_bf16 v[152:155], a[92:95], a[148:151], v[152:155]
    v_mfma_f32_16x16x32_bf16 v[156:159], a[96:99], a[148:151], v[156:159]
    s_waitcnt vmcnt(18) lgkmcnt(0)
    v_mfma_f32_16x16x32_bf16 v[156:159], a[68:71], a[144:147], v[156:159]
    s_barrier
    v_mfma_f32_16x16x32_bf16 v[160:163], a[72:75], a[144:147], v[160:163]
    v_mfma_f32_16x16x32_bf16 v[160:163], a[100:103], a[148:151], v[160:163]
    ds_read_b128 a[112:115], v8 offset:0
    v_mfma_f32_16x16x32_bf16 v[164:167], a[104:107], a[148:151], v[164:167]
    ds_read_b128 a[116:119], v8 offset:33024
    s_add_u32 m0, s43, 0
    v_mfma_f32_16x16x32_bf16 v[164:167], a[76:79], a[144:147], v[164:167]
    buffer_load_dwordx4 v19, s[8:11], s41 offen offset:0 lds
    v_mfma_f32_16x16x32_bf16 v[168:171], a[80:83], a[144:147], v[168:171]
    ds_read_b128 a[120:123], v8 offset:1024
    v_mfma_f32_16x16x32_bf16 v[168:171], a[108:111], a[148:151], v[168:171]
    ds_read_b128 a[124:127], v8 offset:34048
    v_mfma_f32_16x16x32_bf16 v[196:199], a[80:83], a[152:155], v[196:199]
    v_mfma_f32_16x16x32_bf16 v[196:199], a[108:111], a[156:159], v[196:199]
    ds_read_b128 a[128:131], v8 offset:2048
    v_mfma_f32_16x16x32_bf16 v[192:195], a[104:107], a[156:159], v[192:195]
    ds_read_b128 a[132:135], v8 offset:35072
    buffer_load_dwordx4 v20, s[8:11], s41 offen offset:1024 lds
    v_mfma_f32_16x16x32_bf16 v[192:195], a[76:79], a[152:155], v[192:195]
    v_mfma_f32_16x16x32_bf16 v[188:191], a[72:75], a[152:155], v[188:191]
    ds_read_b128 a[136:139], v8 offset:3072
    v_mfma_f32_16x16x32_bf16 v[188:191], a[100:103], a[156:159], v[188:191]
    ds_read_b128 a[140:143], v8 offset:36096
    v_mfma_f32_16x16x32_bf16 v[184:187], a[96:99], a[156:159], v[184:187]
    v_mfma_f32_16x16x32_bf16 v[184:187], a[68:71], a[152:155], v[184:187]
    ds_read_b128 a[144:147], v8 offset:4096
    buffer_load_dwordx4 v21, s[8:11], s41 offen offset:2048 lds
    v_mfma_f32_16x16x32_bf16 v[180:183], a[64:67], a[152:155], v[180:183]
    ds_read_b128 a[148:151], v8 offset:37120
    v_mfma_f32_16x16x32_bf16 v[180:183], a[92:95], a[156:159], v[180:183]
    v_mfma_f32_16x16x32_bf16 v[176:179], a[88:91], a[156:159], v[176:179]
    v_mfma_f32_16x16x32_bf16 v[176:179], a[60:63], a[152:155], v[176:179]
    v_mfma_f32_16x16x32_bf16 v[172:175], a[56:59], a[152:155], v[172:175]
    buffer_load_dwordx4 v22, s[8:11], s41 offen offset:3072 lds
    v_mfma_f32_16x16x32_bf16 v[172:175], a[84:87], a[156:159], v[172:175]
    ds_read_b128 a[152:155], v8 offset:5120
    s_add_u32 s41, s41, 229376
    v_mfma_f32_16x16x32_bf16 v[200:203], a[56:59], a[160:163], v[200:203]
    ds_read_b128 a[156:159], v8 offset:38144
    v_mfma_f32_16x16x32_bf16 v[200:203], a[84:87], a[164:167], v[200:203]
    v_mfma_f32_16x16x32_bf16 v[204:207], a[88:91], a[164:167], v[204:207]
    s_add_u32 m0, s43, 33024
    v_mfma_f32_16x16x32_bf16 v[204:207], a[60:63], a[160:163], v[204:207]
    buffer_load_dwordx4 v19, s[8:11], s41 offen offset:0 lds
    v_mfma_f32_16x16x32_bf16 v[208:211], a[64:67], a[160:163], v[208:211]
    v_mfma_f32_16x16x32_bf16 v[208:211], a[92:95], a[164:167], v[208:211]
    v_mfma_f32_16x16x32_bf16 v[212:215], a[96:99], a[164:167], v[212:215]
    v_mfma_f32_16x16x32_bf16 v[212:215], a[68:71], a[160:163], v[212:215]
    v_mfma_f32_16x16x32_bf16 v[216:219], a[72:75], a[160:163], v[216:219]
    buffer_load_dwordx4 v20, s[8:11], s41 offen offset:1024 lds
    v_mfma_f32_16x16x32_bf16 v[216:219], a[100:103], a[164:167], v[216:219]
    ds_read_b64_tr_b16 a[176:177], v6 offset:0
    v_mfma_f32_16x16x32_bf16 v[220:223], a[104:107], a[164:167], v[220:223]
    ds_read_b64_tr_b16 a[178:179], v6 offset:512
    v_mfma_f32_16x16x32_bf16 v[220:223], a[76:79], a[160:163], v[220:223]
    v_mfma_f32_16x16x32_bf16 v[224:227], a[80:83], a[160:163], v[224:227]
    v_mfma_f32_16x16x32_bf16 v[224:227], a[108:111], a[164:167], v[224:227]
    ds_read_b128 a[160:163], v8 offset:6144
    buffer_load_dwordx4 v21, s[8:11], s41 offen offset:2048 lds
    v_mfma_f32_16x16x32_bf16 v[252:255], a[80:83], a[168:171], v[252:255]
    ds_read_b128 a[164:167], v8 offset:39168
    v_mfma_f32_16x16x32_bf16 v[252:255], a[108:111], a[172:175], v[252:255]
    v_mfma_f32_16x16x32_bf16 v[248:251], a[104:107], a[172:175], v[248:251]
    v_mfma_f32_16x16x32_bf16 v[248:251], a[76:79], a[168:171], v[248:251]
    v_mfma_f32_16x16x32_bf16 v[244:247], a[72:75], a[168:171], v[244:247]
    buffer_load_dwordx4 v22, s[8:11], s41 offen offset:3072 lds
    v_mfma_f32_16x16x32_bf16 v[244:247], a[100:103], a[172:175], v[244:247]
    s_add_u32 s41, s41, 229376
    v_mfma_f32_16x16x32_bf16 v[240:243], a[96:99], a[172:175], v[240:243]
    v_mfma_f32_16x16x32_bf16 v[240:243], a[68:71], a[168:171], v[240:243]
    buffer_load_dword v27, v18, s[8:11], 0 offen
    v_mfma_f32_16x16x32_bf16 v[236:239], a[64:67], a[168:171], v[236:239]
    v_add_u32 v18, 917504, v18
    v_mfma_f32_16x16x32_bf16 v[236:239], a[92:95], a[172:175], v[236:239]
    v_mfma_f32_16x16x32_bf16 v[232:235], a[88:91], a[172:175], v[232:235]
    v_mfma_f32_16x16x32_bf16 v[232:235], a[60:63], a[168:171], v[232:235]
    v_mfma_f32_16x16x32_bf16 v[228:231], a[56:59], a[168:171], v[228:231]
    ds_read_b128 a[168:171], v8 offset:7168
    s_cmp_lg_u32 s47, 2
    v_mfma_f32_16x16x32_bf16 v[228:231], a[84:87], a[172:175], v[228:231]
    ds_read_b128 a[172:175], v8 offset:40192
    s_cbranch_scc1 interl_g1b50
    s_branch interl_g1l45
interl_g1b51:
    s_waitcnt lgkmcnt(2)
    v_mfma_f32_16x16x32_bf16 v[32:35], a[0:3], a[112:115], v[32:35]
iw_c15:
    s_cbranch_execz iw_ret
    v_lshl_add_u32 v4, v1, s65, v5
    v_mfma_f32_16x16x32_bf16 v[32:35], a[28:31], a[116:119], v[32:35]
    s_and_b32 s50, s65, 0xffffff80
    s_add_u32 m0, s72, 0
    v_mfma_f32_16x16x32_bf16 v[36:39], a[32:35], a[116:119], v[36:39]
    s_sub_u32 s47, s47, 1
    v_mfma_f32_16x16x32_bf16 v[36:39], a[4:7], a[112:115], v[36:39]
    s_cmp_lg_u32 s65, 0
    s_cselect_b32 s18, 7340032, 0
    v_mfma_f32_16x16x32_bf16 v[40:43], a[8:11], a[112:115], v[40:43]
    s_cmp_lg_u32 s75, 0
    s_cselect_b32 s26, s14, 0
    v_mfma_f32_16x16x32_bf16 v[40:43], a[36:39], a[116:119], v[40:43]
    v_mfma_f32_16x16x32_bf16 v[44:47], a[40:43], a[116:119], v[44:47]
    s_waitcnt vmcnt(19) lgkmcnt(0)
    v_mfma_f32_16x16x32_bf16 v[44:47], a[12:15], a[112:115], v[44:47]
    s_barrier
    v_mfma_f32_16x16x32_bf16 v[48:51], a[16:19], a[112:115], v[48:51]
    ds_read_b64_tr_b16 a[56:57], v14 offset:0
    buffer_load_dwordx4 v4, s[16:19], s50 offen nt lds
    v_mfma_f32_16x16x32_bf16 v[48:51], a[44:47], a[116:119], v[48:51]
    ds_read_b64_tr_b16 a[58:59], v14 offset:1024
    v_mfma_f32_16x16x32_bf16 v[52:55], a[48:51], a[116:119], v[52:55]
    v_mfma_f32_16x16x32_bf16 v[52:55], a[20:23], a[112:115], v[52:55]
    ds_read_b64_tr_b16 a[60:61], v15 offset:0
    v_mfma_f32_16x16x32_bf16 v[56:59], a[24:27], a[112:115], v[56:59]
    ds_read_b64_tr_b16 a[62:63], v15 offset:1024
    s_add_u32 m0, s42, 0
    v_mfma_f32_16x16x32_bf16 v[56:59], a[52:55], a[116:119], v[56:59]
    buffer_load_dwordx4 v3, s[12:15], s40 offen offset:0 sc1 lds
    v_mfma_f32_16x16x32_bf16 v[84:87], a[24:27], a[120:123], v[84:87]
    ds_read_b64_tr_b16 a[64:65], v16 offset:0
    v_mfma_f32_16x16x32_bf16 v[84:87], a[52:55], a[124:127], v[84:87]
    ds_read_b64_tr_b16 a[66:67], v16 offset:1024
    v_mfma_f32_16x16x32_bf16 v[80:83], a[48:51], a[124:127], v[80:83]
    buffer_store_dwordx4 a[176:179], v3, s[24:27], s75 offen sc1
    v_mfma_f32_16x16x32_bf16 v[80:83], a[20:23], a[120:123], v[80:83]
    ds_read_b64_tr_b16 a[68:69], v14 offset:8208
    v_mfma_f32_16x16x32_bf16 v[76:79], a[16:19], a[120:123], v[76:79]
    ds_read_b64_tr_b16 a[70:71], v14 offset:9232
    v_mfma_f32_16x16x32_bf16 v[76:79], a[44:47], a[124:127], v[76:79]
    buffer_load_dwordx4 v3, s[12:15], s40 offen offset:1024 sc1 lds
    v_mfma_f32_16x16x32_bf16 v[72:75], a[40:43], a[124:127], v[72:75]
    ds_read_b64_tr_b16 a[72:73], v15 offset:8208
    v_mfma_f32_16x16x32_bf16 v[72:75], a[12:15], a[120:123], v[72:75]
    ds_read_b64_tr_b16 a[74:75], v15 offset:9232
    v_mfma_f32_16x16x32_bf16 v[68:71], a[8:11], a[120:123], v[68:71]
    v_mfma_f32_16x16x32_bf16 v[68:71], a[36:39], a[124:127], v[68:71]
    ds_read_b64_tr_b16 a[76:77], v16 offset:8208
    v_mfma_f32_16x16x32_bf16 v[64:67], a[32:35], a[124:127], v[64:67]
    ds_read_b64_tr_b16 a[78:79], v16 offset:9232
    v_mfma_f32_16x16x32_bf16 v[64:67], a[4:7], a[120:123], v[64:67]
    buffer_load_dwordx4 v3, s[12:15], s40 offen offset:2048 sc1 lds
    v_mfma_f32_16x16x32_bf16 v[60:63], a[0:3], a[120:123], v[60:63]
    ds_read_b64_tr_b16 a[80:81], v17 offset:0
    v_mfma_f32_16x16x32_bf16 v[60:63], a[28:31], a[124:127], v[60:63]
    ds_read_b64_tr_b16 a[82:83], v17 offset:1024
    v_mfma_f32_16x16x32_bf16 v[88:91], a[0:3], a[128:131], v[88:91]
    v_mfma_f32_16x16x32_bf16 v[88:91], a[28:31], a[132:135], v[88:91]
    ds_read_b64_tr_b16 a[84:85], v14 offset:33024
    v_mfma_f32_16x16x32_bf16 v[92:95], a[32:35], a[132:135], v[92:95]
    ds_read_b64_tr_b16 a[86:87], v14 offset:34048
    v_mfma_f32_16x16x32_bf16 v[92:95], a[4:7], a[128:131], v[92:95]
    buffer_load_dwordx4 v3, s[12:15], s40 offen offset:3072 sc1 lds
    v_mfma_f32_16x16x32_bf16 v[96:99], a[8:11], a[128:131], v[96:99]
    ds_read_b64_tr_b16 a[88:89], v15 offset:33024
    s_add_u32 s40, s40, 16384
    v_mfma_f32_16x16x32_bf16 v[96:99], a[36:39], a[132:135], v[96:99]
    ds_read_b64_tr_b16 a[90:91], v15 offset:34048
    v_mfma_f32_16x16x32_bf16 v[100:103], a[40:43], a[132:135], v[100:103]
    v_mfma_f32_16x16x32_bf16 v[100:103], a[12:15], a[128:131], v[100:103]
    ds_read_b64_tr_b16 a[92:93], v16 offset:33024
    v_mfma_f32_16x16x32_bf16 v[104:107], a[16:19], a[128:131], v[104:107]
    ds_read_b64_tr_b16 a[94:95], v16 offset:34048
    s_add_u32 m0, s42, 33024
    v_mfma_f32_16x16x32_bf16 v[104:107], a[44:47], a[132:135], v[104:107]
    buffer_load_dwordx4 v3, s[12:15], s40 offen offset:0 sc1 lds
    v_mfma_f32_16x16x32_bf16 v[108:111], a[48:51], a[132:135], v[108:111]
    ds_read_b64_tr_b16 a[96:97], v14 offset:41232
    v_mfma_f32_16x16x32_bf16 v[108:111], a[20:23], a[128:131], v[108:111]
    ds_read_b64_tr_b16 a[98:99], v14 offset:42256
    v_mfma_f32_16x16x32_bf16 v[112:115], a[24:27], a[128:131], v[112:115]
    v_mfma_f32_16x16x32_bf16 v[112:115], a[52:55], a[132:135], v[112:115]
    ds_read_b64_tr_b16 a[100:101], v15 offset:41232
    v_mfma_f32_16x16x32_bf16 v[140:143], a[24:27], a[136:139], v[140:143]
    ds_read_b64_tr_b16 a[102:103], v15 offset:42256
    v_mfma_f32_16x16x32_bf16 v[140:143], a[52:55], a[140:143], v[140:143]
    buffer_load_dwordx4 v3, s[12:15], s40 offen offset:1024 sc1 lds
    v_mfma_f32_16x16x32_bf16 v[136:139], a[48:51], a[140:143], v[136:139]
    ds_read_b64_tr_b16 a[104:105], v16 offset:41232
    v_mfma_f32_16x16x32_bf16 v[136:139], a[20:23], a[136:139], v[136:139]
    ds_read_b64_tr_b16 a[106:107], v16 offset:42256
    v_mfma_f32_16x16x32_bf16 v[132:135], a[16:19], a[136:139], v[132:135]
    v_mfma_f32_16x16x32_bf16 v[132:135], a[44:47], a[140:143], v[132:135]
    ds_read_b64_tr_b16 a[108:109], v17 offset:33024
    v_mfma_f32_16x16x32_bf16 v[128:131], a[40:43], a[140:143], v[128:131]
    ds_read_b64_tr_b16 a[110:111], v17 offset:34048
    v_mfma_f32_16x16x32_bf16 v[128:131], a[12:15], a[136:139], v[128:131]
    buffer_load_dwordx4 v3, s[12:15], s40 offen offset:2048 sc1 lds
    v_mfma_f32_16x16x32_bf16 v[124:127], a[8:11], a[136:139], v[124:127]
    s_mov_b64 s[64:65], s[66:67]
    v_mfma_f32_16x16x32_bf16 v[124:127], a[36:39], a[140:143], v[124:127]
    s_mov_b64 s[66:67], s[68:69]
    v_mfma_f32_16x16x32_bf16 v[120:123], a[32:35], a[140:143], v[120:123]
    v_mfma_f32_16x16x32_bf16 v[120:123], a[4:7], a[136:139], v[120:123]
    s_mov_b64 s[68:69], s[70:71]
    v_mfma_f32_16x16x32_bf16 v[116:119], a[0:3], a[136:139], v[116:119]
    s_mov_b64 s[74:75], s[76:77]
    v_mfma_f32_16x16x32_bf16 v[116:119], a[28:31], a[140:143], v[116:119]
    buffer_load_dwordx4 v3, s[12:15], s40 offen offset:3072 sc1 lds
    v_mfma_f32_16x16x32_bf16 v[144:147], a[0:3], a[144:147], v[144:147]
    s_add_u32 s40, s40, 16384
    s_mov_b64 s[76:77], s[78:79]
    v_mfma_f32_16x16x32_bf16 v[144:147], a[28:31], a[148:151], v[144:147]
    s_mov_b64 s[78:79], s[80:81]
    v_mfma_f32_16x16x32_bf16 v[148:151], a[32:35], a[148:151], v[148:151]
    v_mfma_f32_16x16x32_bf16 v[148:151], a[4:7], a[144:147], v[148:151]
    v_mfma_f32_16x16x32_bf16 v[152:155], a[8:11], a[144:147], v[152:155]
    s_mov_b64 s[80:81], s[82:83]
    v_mfma_f32_16x16x32_bf16 v[152:155], a[36:39], a[148:151], v[152:155]
    s_mov_b64 s[70:71], 0
    v_mfma_f32_16x16x32_bf16 v[156:159], a[40:43], a[148:151], v[156:159]
    s_waitcnt vmcnt(19) lgkmcnt(0)
    v_mfma_f32_16x16x32_bf16 v[156:159], a[12:15], a[144:147], v[156:159]
    s_barrier
    v_mfma_f32_16x16x32_bf16 v[160:163], a[16:19], a[144:147], v[160:163]
    v_mfma_f32_16x16x32_bf16 v[160:163], a[44:47], a[148:151], v[160:163]
    ds_read_b128 a[112:115], v9 offset:0
    v_mfma_f32_16x16x32_bf16 v[164:167], a[48:51], a[148:151], v[164:167]
    ds_read_b128 a[116:119], v9 offset:33024
    v_mfma_f32_16x16x32_bf16 v[164:167], a[20:23], a[144:147], v[164:167]
    v_mfma_f32_16x16x32_bf16 v[168:171], a[24:27], a[144:147], v[168:171]
    ds_read_b128 a[120:123], v9 offset:1024
    v_mfma_f32_16x16x32_bf16 v[168:171], a[52:55], a[148:151], v[168:171]
    ds_read_b128 a[124:127], v9 offset:34048
    s_add_u32 m0, s43, 66048
    v_mfma_f32_16x16x32_bf16 v[196:199], a[24:27], a[152:155], v[196:199]
iw_d15:
    s_cbranch_execz iw_ret2
    buffer_load_dwordx4 v19, s[8:11], s41 offen offset:0 lds
    v_mfma_f32_16x16x32_bf16 v[196:199], a[52:55], a[156:159], v[196:199]
    ds_read_b128 a[128:131], v9 offset:2048
    v_mfma_f32_16x16x32_bf16 v[192:195], a[48:51], a[156:159], v[192:195]
    ds_read_b128 a[132:135], v9 offset:35072
    v_mfma_f32_16x16x32_bf16 v[192:195], a[20:23], a[152:155], v[192:195]
    v_mfma_f32_16x16x32_bf16 v[188:191], a[16:19], a[152:155], v[188:191]
    ds_read_b128 a[136:139], v9 offset:3072
    v_mfma_f32_16x16x32_bf16 v[188:191], a[44:47], a[156:159], v[188:191]
    ds_read_b128 a[140:143], v9 offset:36096
    buffer_load_dwordx4 v20, s[8:11], s41 offen offset:1024 lds
    v_mfma_f32_16x16x32_bf16 v[184:187], a[40:43], a[156:159], v[184:187]
    v_mfma_f32_16x16x32_bf16 v[184:187], a[12:15], a[152:155], v[184:187]
    ds_read_b128 a[144:147], v9 offset:4096
    v_mfma_f32_16x16x32_bf16 v[180:183], a[8:11], a[152:155], v[180:183]
    ds_read_b128 a[148:151], v9 offset:37120
    v_mfma_f32_16x16x32_bf16 v[180:183], a[36:39], a[156:159], v[180:183]
    v_mfma_f32_16x16x32_bf16 v[176:179], a[32:35], a[156:159], v[176:179]
    buffer_load_dwordx4 v21, s[8:11], s41 offen offset:2048 lds
    v_mfma_f32_16x16x32_bf16 v[176:179], a[4:7], a[152:155], v[176:179]
    v_mfma_f32_16x16x32_bf16 v[172:175], a[0:3], a[152:155], v[172:175]
    v_mfma_f32_16x16x32_bf16 v[172:175], a[28:31], a[156:159], v[172:175]
    ds_read_b128 a[152:155], v9 offset:5120
    v_mfma_f32_16x16x32_bf16 v[200:203], a[0:3], a[160:163], v[200:203]
    ds_read_b128 a[156:159], v9 offset:38144
    v_mfma_f32_16x16x32_bf16 v[200:203], a[28:31], a[164:167], v[200:203]
    buffer_load_dwordx4 v22, s[8:11], s41 offen offset:3072 lds
    v_mfma_f32_16x16x32_bf16 v[204:207], a[32:35], a[164:167], v[204:207]
    s_add_u32 s41, s41, 229376
    v_mfma_f32_16x16x32_bf16 v[204:207], a[4:7], a[160:163], v[204:207]
    v_mfma_f32_16x16x32_bf16 v[208:211], a[8:11], a[160:163], v[208:211]
    v_mfma_f32_16x16x32_bf16 v[208:211], a[36:39], a[164:167], v[208:211]
    s_add_u32 m0, s43, 99072
    v_mfma_f32_16x16x32_bf16 v[212:215], a[40:43], a[164:167], v[212:215]
    buffer_load_dwordx4 v19, s[8:11], s41 offen offset:0 lds
    v_mfma_f32_16x16x32_bf16 v[212:215], a[12:15], a[160:163], v[212:215]
    v_mfma_f32_16x16x32_bf16 v[216:219], a[16:19], a[160:163], v[216:219]
    v_mfma_f32_16x16x32_bf16 v[216:219], a[44:47], a[164:167], v[216:219]
    ds_read_b64_tr_b16 a[176:177], v6 offset:4096
    v_mfma_f32_16x16x32_bf16 v[220:223], a[48:51], a[164:167], v[220:223]
    ds_read_b64_tr_b16 a[178:179], v6 offset:4608
    v_mfma_f32_16x16x32_bf16 v[220:223], a[20:23], a[160:163], v[220:223]
    buffer_load_dwordx4 v20, s[8:11], s41 offen offset:1024 lds
    v_mfma_f32_16x16x32_bf16 v[224:227], a[24:27], a[160:163], v[224:227]
    v_mfma_f32_16x16x32_bf16 v[224:227], a[52:55], a[164:167], v[224:227]
    ds_read_b128 a[160:163], v9 offset:6144
    v_mfma_f32_16x16x32_bf16 v[252:255], a[24:27], a[168:171], v[252:255]
    ds_read_b128 a[164:167], v9 offset:39168
    v_mfma_f32_16x16x32_bf16 v[252:255], a[52:55], a[172:175], v[252:255]
    v_mfma_f32_16x16x32_bf16 v[248:251], a[48:51], a[172:175], v[248:251]
    buffer_load_dwordx4 v21, s[8:11], s41 offen offset:2048 lds
    v_mfma_f32_16x16x32_bf16 v[248:251], a[20:23], a[168:171], v[248:251]
    v_mfma_f32_16x16x32_bf16 v[244:247], a[16:19], a[168:171], v[244:247]
    v_mfma_f32_16x16x32_bf16 v[244:247], a[44:47], a[172:175], v[244:247]
    v_mfma_f32_16x16x32_bf16 v[240:243], a[40:43], a[172:175], v[240:243]
    v_mfma_f32_16x16x32_bf16 v[240:243], a[12:15], a[168:171], v[240:243]
    buffer_load_dwordx4 v22, s[8:11], s41 offen offset:3072 lds
    v_mfma_f32_16x16x32_bf16 v[236:239], a[8:11], a[168:171], v[236:239]
    s_add_u32 s41, s41, 229376
    v_mfma_f32_16x16x32_bf16 v[236:239], a[36:39], a[172:175], v[236:239]
    v_mfma_f32_16x16x32_bf16 v[232:235], a[32:35], a[172:175], v[232:235]
    v_mfma_f32_16x16x32_bf16 v[232:235], a[4:7], a[168:171], v[232:235]
    v_mfma_f32_16x16x32_bf16 v[228:231], a[0:3], a[168:171], v[228:231]
    ds_read_b128 a[168:171], v9 offset:7168
    v_mfma_f32_16x16x32_bf16 v[228:231], a[28:31], a[172:175], v[228:231]
    ds_read_b128 a[172:175], v9 offset:40192
interl_g1a49:
    s_waitcnt lgkmcnt(2)
    v_mfma_f32_16x16x32_bf16 v[32:35], a[56:59], a[112:115], v[32:35]
    v_lshl_add_u32 v4, v1, s64, v5
    v_mfma_f32_16x16x32_bf16 v[32:35], a[84:87], a[116:119], v[32:35]
    s_and_b32 s50, s64, 0xffffff80
    s_add_u32 m0, s72, 4096
    v_mfma_f32_16x16x32_bf16 v[36:39], a[88:91], a[116:119], v[36:39]
    v_mfma_f32_16x16x32_bf16 v[36:39], a[60:63], a[112:115], v[36:39]
    s_cmp_lg_u32 s64, 0
    s_cselect_b32 s18, 7340032, 0
    v_mfma_f32_16x16x32_bf16 v[40:43], a[64:67], a[112:115], v[40:43]
    s_cmp_lg_u32 s74, 0
    s_cselect_b32 s26, s14, 0
    v_mfma_f32_16x16x32_bf16 v[40:43], a[92:95], a[116:119], v[40:43]
    v_mfma_f32_16x16x32_bf16 v[44:47], a[96:99], a[116:119], v[44:47]
    s_waitcnt vmcnt(19) lgkmcnt(0)
    v_mfma_f32_16x16x32_bf16 v[44:47], a[68:71], a[112:115], v[44:47]
    s_barrier
    v_mfma_f32_16x16x32_bf16 v[48:51], a[72:75], a[112:115], v[48:51]
    ds_read_b64_tr_b16 a[0:1], v10 offset:0
    buffer_load_dwordx4 v4, s[16:19], s50 offen nt lds
    v_mfma_f32_16x16x32_bf16 v[48:51], a[100:103], a[116:119], v[48:51]
    ds_read_b64_tr_b16 a[2:3], v10 offset:1024
    v_mfma_f32_16x16x32_bf16 v[52:55], a[104:107], a[116:119], v[52:55]
    v_mfma_f32_16x16x32_bf16 v[52:55], a[76:79], a[112:115], v[52:55]
    ds_read_b64_tr_b16 a[4:5], v11 offset:0
    v_mfma_f32_16x16x32_bf16 v[56:59], a[80:83], a[112:115], v[56:59]
    ds_read_b64_tr_b16 a[6:7], v11 offset:1024
    s_add_u32 m0, s42, 66048
    v_mfma_f32_16x16x32_bf16 v[56:59], a[108:111], a[116:119], v[56:59]
    buffer_load_dwordx4 v3, s[12:15], s40 offen offset:0 sc1 lds
    v_mfma_f32_16x16x32_bf16 v[84:87], a[80:83], a[120:123], v[84:87]
    ds_read_b64_tr_b16 a[8:9], v12 offset:0
    v_mfma_f32_16x16x32_bf16 v[84:87], a[108:111], a[124:127], v[84:87]
    ds_read_b64_tr_b16 a[10:11], v12 offset:1024
    v_mfma_f32_16x16x32_bf16 v[80:83], a[104:107], a[124:127], v[80:83]
    buffer_store_dwordx4 a[176:179], v3, s[24:27], s74 offen sc1
    v_mfma_f32_16x16x32_bf16 v[80:83], a[76:79], a[120:123], v[80:83]
    ds_read_b64_tr_b16 a[12:13], v10 offset:8208
    v_mfma_f32_16x16x32_bf16 v[76:79], a[72:75], a[120:123], v[76:79]
    ds_read_b64_tr_b16 a[14:15], v10 offset:9232
    v_mfma_f32_16x16x32_bf16 v[76:79], a[100:103], a[124:127], v[76:79]
    buffer_load_dwordx4 v3, s[12:15], s40 offen offset:1024 sc1 lds
    v_mfma_f32_16x16x32_bf16 v[72:75], a[96:99], a[124:127], v[72:75]
    ds_read_b64_tr_b16 a[16:17], v11 offset:8208
    v_mfma_f32_16x16x32_bf16 v[72:75], a[68:71], a[120:123], v[72:75]
    ds_read_b64_tr_b16 a[18:19], v11 offset:9232
    v_mfma_f32_16x16x32_bf16 v[68:71], a[64:67], a[120:123], v[68:71]
    v_mfma_f32_16x16x32_bf16 v[68:71], a[92:95], a[124:127], v[68:71]
    ds_read_b64_tr_b16 a[20:21], v12 offset:8208
    v_mfma_f32_16x16x32_bf16 v[64:67], a[88:91], a[124:127], v[64:67]
    ds_read_b64_tr_b16 a[22:23], v12 offset:9232
    v_mfma_f32_16x16x32_bf16 v[64:67], a[60:63], a[120:123], v[64:67]
    buffer_load_dwordx4 v3, s[12:15], s40 offen offset:2048 sc1 lds
    v_mfma_f32_16x16x32_bf16 v[60:63], a[56:59], a[120:123], v[60:63]
    ds_read_b64_tr_b16 a[24:25], v13 offset:0
    v_mfma_f32_16x16x32_bf16 v[60:63], a[84:87], a[124:127], v[60:63]
    ds_read_b64_tr_b16 a[26:27], v13 offset:1024
    v_mfma_f32_16x16x32_bf16 v[88:91], a[56:59], a[128:131], v[88:91]
    v_mfma_f32_16x16x32_bf16 v[88:91], a[84:87], a[132:135], v[88:91]
    ds_read_b64_tr_b16 a[28:29], v10 offset:33024
    v_mfma_f32_16x16x32_bf16 v[92:95], a[88:91], a[132:135], v[92:95]
iw_c16:
    s_cbranch_execz iw_ret
    ds_read_b64_tr_b16 a[30:31], v10 offset:34048
    v_mfma_f32_16x16x32_bf16 v[92:95], a[60:63], a[128:131], v[92:95]
    buffer_load_dwordx4 v3, s[12:15], s40 offen offset:3072 sc1 lds
    v_mfma_f32_16x16x32_bf16 v[96:99], a[64:67], a[128:131], v[96:99]
    ds_read_b64_tr_b16 a[32:33], v11 offset:33024
    s_add_u32 s40, s40, 16384
    v_mfma_f32_16x16x32_bf16 v[96:99], a[92:95], a[132:135], v[96:99]
    ds_read_b64_tr_b16 a[34:35], v11 offset:34048
    v_mfma_f32_16x16x32_bf16 v[100:103], a[96:99], a[132:135], v[100:103]
    v_mfma_f32_16x16x32_bf16 v[100:103], a[68:71], a[128:131], v[100:103]
    ds_read_b64_tr_b16 a[36:37], v12 offset:33024
    v_mfma_f32_16x16x32_bf16 v[104:107], a[72:75], a[128:131], v[104:107]
    ds_read_b64_tr_b16 a[38:39], v12 offset:34048
    s_add_u32 m0, s42, 99072
    v_mfma_f32_16x16x32_bf16 v[104:107], a[100:103], a[132:135], v[104:107]
    buffer_load_dwordx4 v3, s[12:15], s40 offen offset:0 sc1 lds
    v_mfma_f32_16x16x32_bf16 v[108:111], a[104:107], a[132:135], v[108:111]
    ds_read_b64_tr_b16 a[40:41], v10 offset:41232
    v_mfma_f32_16x16x32_bf16 v[108:111], a[76:79], a[128:131], v[108:111]
    ds_read_b64_tr_b16 a[42:43], v10 offset:42256
    v_mfma_f32_16x16x32_bf16 v[112:115], a[80:83], a[128:131], v[112:115]
    v_mfma_f32_16x16x32_bf16 v[112:115], a[108:111], a[132:135], v[112:115]
    ds_read_b64_tr_b16 a[44:45], v11 offset:41232
    v_mfma_f32_16x16x32_bf16 v[140:143], a[80:83], a[136:139], v[140:143]
    ds_read_b64_tr_b16 a[46:47], v11 offset:42256
    v_mfma_f32_16x16x32_bf16 v[140:143], a[108:111], a[140:143], v[140:143]
    buffer_load_dwordx4 v3, s[12:15], s40 offen offset:1024 sc1 lds
    v_mfma_f32_16x16x32_bf16 v[136:139], a[104:107], a[140:143], v[136:139]
    ds_read_b64_tr_b16 a[48:49], v12 offset:41232
    v_mfma_f32_16x16x32_bf16 v[136:139], a[76:79], a[136:139], v[136:139]
    ds_read_b64_tr_b16 a[50:51], v12 offset:42256
    v_mfma_f32_16x16x32_bf16 v[132:135], a[72:75], a[136:139], v[132:135]
    v_mfma_f32_16x16x32_bf16 v[132:135], a[100:103], a[140:143], v[132:135]
    ds_read_b64_tr_b16 a[52:53], v13 offset:33024
    v_mfma_f32_16x16x32_bf16 v[128:131], a[96:99], a[140:143], v[128:131]
    ds_read_b64_tr_b16 a[54:55], v13 offset:34048
    v_mfma_f32_16x16x32_bf16 v[128:131], a[68:71], a[136:139], v[128:131]
    buffer_load_dwordx4 v3, s[12:15], s40 offen offset:2048 sc1 lds
    v_mfma_f32_16x16x32_bf16 v[124:127], a[64:67], a[136:139], v[124:127]
    v_mfma_f32_16x16x32_bf16 v[124:127], a[92:95], a[140:143], v[124:127]
    v_mfma_f32_16x16x32_bf16 v[120:123], a[88:91], a[140:143], v[120:123]
    v_mfma_f32_16x16x32_bf16 v[120:123], a[60:63], a[136:139], v[120:123]
    v_mfma_f32_16x16x32_bf16 v[116:119], a[56:59], a[136:139], v[116:119]
    v_mfma_f32_16x16x32_bf16 v[116:119], a[84:87], a[140:143], v[116:119]
    buffer_load_dwordx4 v3, s[12:15], s40 offen offset:3072 sc1 lds
    v_mfma_f32_16x16x32_bf16 v[144:147], a[56:59], a[144:147], v[144:147]
    s_add_u32 s40, s40, 16384
    v_mfma_f32_16x16x32_bf16 v[144:147], a[84:87], a[148:151], v[144:147]
    v_mfma_f32_16x16x32_bf16 v[148:151], a[88:91], a[148:151], v[148:151]
    v_mfma_f32_16x16x32_bf16 v[148:151], a[60:63], a[144:147], v[148:151]
    v_mfma_f32_16x16x32_bf16 v[152:155], a[64:67], a[144:147], v[152:155]
    v_mfma_f32_16x16x32_bf16 v[152:155], a[92:95], a[148:151], v[152:155]
    v_mfma_f32_16x16x32_bf16 v[156:159], a[96:99], a[148:151], v[156:159]
    s_waitcnt vmcnt(18) lgkmcnt(0)
    v_mfma_f32_16x16x32_bf16 v[156:159], a[68:71], a[144:147], v[156:159]
    s_barrier
    v_mfma_f32_16x16x32_bf16 v[160:163], a[72:75], a[144:147], v[160:163]
    v_mfma_f32_16x16x32_bf16 v[160:163], a[100:103], a[148:151], v[160:163]
    ds_read_b128 a[112:115], v8 offset:0
    v_mfma_f32_16x16x32_bf16 v[164:167], a[104:107], a[148:151], v[164:167]
    ds_read_b128 a[116:119], v8 offset:33024
    v_mfma_f32_16x16x32_bf16 v[164:167], a[76:79], a[144:147], v[164:167]
    v_mfma_f32_16x16x32_bf16 v[168:171], a[80:83], a[144:147], v[168:171]
    ds_read_b128 a[120:123], v8 offset:1024
    v_mfma_f32_16x16x32_bf16 v[168:171], a[108:111], a[148:151], v[168:171]
    ds_read_b128 a[124:127], v8 offset:34048
    s_add_u32 m0, s43, 0
    v_mfma_f32_16x16x32_bf16 v[196:199], a[80:83], a[152:155], v[196:199]
    buffer_load_dwordx4 v19, s[8:11], s41 offen offset:0 lds
    v_mfma_f32_16x16x32_bf16 v[196:199], a[108:111], a[156:159], v[196:199]
    ds_read_b128 a[128:131], v8 offset:2048
    v_mfma_f32_16x16x32_bf16 v[192:195], a[104:107], a[156:159], v[192:195]
    ds_read_b128 a[132:135], v8 offset:35072
    v_mfma_f32_16x16x32_bf16 v[192:195], a[76:79], a[152:155], v[192:195]
    v_mfma_f32_16x16x32_bf16 v[188:191], a[72:75], a[152:155], v[188:191]
    ds_read_b128 a[136:139], v8 offset:3072
    v_mfma_f32_16x16x32_bf16 v[188:191], a[100:103], a[156:159], v[188:191]
    ds_read_b128 a[140:143], v8 offset:36096
    buffer_load_dwordx4 v20, s[8:11], s41 offen offset:1024 lds
    v_mfma_f32_16x16x32_bf16 v[184:187], a[96:99], a[156:159], v[184:187]
    v_mfma_f32_16x16x32_bf16 v[184:187], a[68:71], a[152:155], v[184:187]
    ds_read_b128 a[144:147], v8 offset:4096
    v_mfma_f32_16x16x32_bf16 v[180:183], a[64:67], a[152:155], v[180:183]
    ds_read_b128 a[148:151], v8 offset:37120
    v_mfma_f32_16x16x32_bf16 v[180:183], a[92:95], a[156:159], v[180:183]
    v_mfma_f32_16x16x32_bf16 v[176:179], a[88:91], a[156:159], v[176:179]
    buffer_load_dwordx4 v21, s[8:11], s41 offen offset:2048 lds
    v_mfma_f32_16x16x32_bf16 v[176:179], a[60:63], a[152:155], v[176:179]
    v_mfma_f32_16x16x32_bf16 v[172:175], a[56:59], a[152:155], v[172:175]
    v_mfma_f32_16x16x32_bf16 v[172:175], a[84:87], a[156:159], v[172:175]
    ds_read_b128 a[152:155], v8 offset:5120
    v_mfma_f32_16x16x32_bf16 v[200:203], a[56:59], a[160:163], v[200:203]
    ds_read_b128 a[156:159], v8 offset:38144
    v_mfma_f32_16x16x32_bf16 v[200:203], a[84:87], a[164:167], v[200:203]
    buffer_load_dwordx4 v22, s[8:11], s41 offen offset:3072 lds
    v_mfma_f32_16x16x32_bf16 v[204:207], a[88:91], a[164:167], v[204:207]
    s_add_u32 s41, s41, 229376
    v_mfma_f32_16x16x32_bf16 v[204:207], a[60:63], a[160:163], v[204:207]
    v_mfma_f32_16x16x32_bf16 v[208:211], a[64:67], a[160:163], v[208:211]
    v_mfma_f32_16x16x32_bf16 v[208:211], a[92:95], a[164:167], v[208:211]
    s_add_u32 m0, s43, 33024
    v_mfma_f32_16x16x32_bf16 v[212:215], a[96:99], a[164:167], v[212:215]
    buffer_load_dwordx4 v19, s[8:11], s41 offen offset:0 lds
    v_mfma_f32_16x16x32_bf16 v[212:215], a[68:71], a[160:163], v[212:215]
    v_mfma_f32_16x16x32_bf16 v[216:219], a[72:75], a[160:163], v[216:219]
    v_mfma_f32_16x16x32_bf16 v[216:219], a[100:103], a[164:167], v[216:219]
    ds_read_b64_tr_b16 a[176:177], v6 offset:0
    v_mfma_f32_16x16x32_bf16 v[220:223], a[104:107], a[164:167], v[220:223]
    ds_read_b64_tr_b16 a[178:179], v6 offset:512
    v_mfma_f32_16x16x32_bf16 v[220:223], a[76:79], a[160:163], v[220:223]
    buffer_load_dwordx4 v20, s[8:11], s41 offen offset:1024 lds
    v_mfma_f32_16x16x32_bf16 v[224:227], a[80:83], a[160:163], v[224:227]
    v_mfma_f32_16x16x32_bf16 v[224:227], a[108:111], a[164:167], v[224:227]
    ds_read_b128 a[160:163], v8 offset:6144
    v_mfma_f32_16x16x32_bf16 v[252:255], a[80:83], a[168:171], v[252:255]
    ds_read_b128 a[164:167], v8 offset:39168
    v_mfma_f32_16x16x32_bf16 v[252:255], a[108:111], a[172:175], v[252:255]
    v_mfma_f32_16x16x32_bf16 v[248:251], a[104:107], a[172:175], v[248:251]
    buffer_load_dwordx4 v21, s[8:11], s41 offen offset:2048 lds
    v_mfma_f32_16x16x32_bf16 v[248:251], a[76:79], a[168:171], v[248:251]
    v_mfma_f32_16x16x32_bf16 v[244:247], a[72:75], a[168:171], v[244:247]
    v_mfma_f32_16x16x32_bf16 v[244:247], a[100:103], a[172:175], v[244:247]
    v_mfma_f32_16x16x32_bf16 v[240:243], a[96:99], a[172:175], v[240:243]
    v_mfma_f32_16x16x32_bf16 v[240:243], a[68:71], a[168:171], v[240:243]
    buffer_load_dwordx4 v22, s[8:11], s41 offen offset:3072 lds
    v_mfma_f32_16x16x32_bf16 v[236:239], a[64:67], a[168:171], v[236:239]
    s_add_u32 s41, s41, 229376
    v_mfma_f32_16x16x32_bf16 v[236:239], a[92:95], a[172:175], v[236:239]
    v_mfma_f32_16x16x32_bf16 v[232:235], a[88:91], a[172:175], v[232:235]
iw_d16:
    s_cbranch_execz iw_ret2
    buffer_load_dword v27, v18, s[8:11], 0 offen
    v_mfma_f32_16x16x32_bf16 v[232:235], a[60:63], a[168:171], v[232:235]
    v_add_u32 v18, 917504, v18
    v_mfma_f32_16x16x32_bf16 v[228:231], a[56:59], a[168:171], v[228:231]
    ds_read_b128 a[168:171], v8 offset:7168
    s_cmp_lg_u32 s47, 2
    v_mfma_f32_16x16x32_bf16 v[228:231], a[84:87], a[172:175], v[228:231]
    ds_read_b128 a[172:175], v8 offset:40192
    s_cbranch_scc1 interl_g1b51
    s_branch interl_g1l46
interl_g1s52:
    s_add_u32 s63, s63, 1
    s_lshl_b32 s33, s3, 29
    v_mov_b32 v5, s63
    v_mov_b32 v4, s33
    buffer_store_dword v5, v4, s[12:15], s94 offen sc1
    s_branch interl_g1t53
interl_g1s54:
    s_add_u32 s63, s63, 1
    s_lshl_b32 s33, s3, 29
    v_mov_b32 v5, s63
    v_mov_b32 v4, s33
    buffer_store_dword v5, v4, s[12:15], s94 offen sc1
    s_branch interl_g1t55
interl_g2f63:
    s_cmp_eq_u32 s56, 6
    s_waitcnt vmcnt(12)
    s_cbranch_scc1 interl_g2b64
    s_mov_b32 s62, 4000000
interl_poll65:
    buffer_load_dword v7, v9, s[12:15], s95 offen sc1
    s_sub_u32 s62, s62, 1
    s_cbranch_scc1 interl_pd66
    s_waitcnt vmcnt(0)
    v_cmp_gt_u32 vcc, s63, v7
    s_cbranch_vccnz interl_poll65
interl_pd66:
    s_mov_b64 exec, -1
    s_branch interl_g2b64
interleave_layers__ssm_conv_h3__glu_gated_bilinear__prompt_kernel_last:
    s_endpgm
.section .rodata,"a"
.p2align 6
.amdhsa_kernel interleave_layers__ssm_conv_h3__glu_gated_bilinear__prompt_kernel
  .amdhsa_next_free_vgpr 512
  .amdhsa_next_free_sgpr 102
  .amdhsa_accum_offset 256
  .amdhsa_group_segment_fixed_size 0
  .amdhsa_kernarg_size 104
  .amdhsa_user_sgpr_count 2
  .amdhsa_user_sgpr_kernarg_segment_ptr 1
  .amdhsa_system_sgpr_workgroup_id_x 1
  .amdhsa_float_denorm_mode_32 3
  .amdhsa_float_denorm_mode_16_64 3
.end_amdhsa_kernel
```
